```python
import torch

def _softmax(x, axis=-1):
    return torch.softmax(x, dim=axis)

def _gelu(x):
    return torch.nn.functional.gelu(x, approximate='tanh')

def _silu(x):
    return torch.nn.functional.silu(x)

def _sigmoid(x):
    return torch.sigmoid(x)

def _layernorm(x, axis=-1, eps=1e-05):
    m = x.mean(dim=axis, keepdim=True)
    v = x.var(dim=axis, keepdim=True, unbiased=False)
    return (x - m) / torch.sqrt(v + eps)

def _scatter_add(tgt, idx, src, axis=0):
    return tgt.clone().index_add_(axis, idx, src)

def _segment_sum(src, seg, n):
    out = torch.zeros((n,) + src.shape[1:], dtype=src.dtype)
    return out.index_add_(0, seg, src)

def _pad(x, pw):
    flat = tuple((v for pair in reversed(pw) for v in pair))
    return torch.nn.functional.pad(x, flat)
kernel_name = 'adaLN_cond__memory_aug_recurrent_mem_tr__glu_gated_bilinear__prompt'

def setup_inputs():

    _w = lambda a: (lambda t: t.to(torch.bfloat16) if t.is_floating_point() else t)(torch.as_tensor(a))

    def _A_setup():
        B, S, Dm = (1, 2048, 576)
        H, Dh = (32, 128)
        M, seg = (8, 32)
        seg = min(seg, S)
        S = S // seg * seg
        return {'x': _w((lambda *s: torch.randn(*s, dtype=torch.bfloat16) * 0.05)(B, S, Dm)), 'mem0': _w((lambda *s: torch.randn(*s, dtype=torch.bfloat16) * 0.8)(B, M, Dm)), 'Wq': _w((lambda *s: torch.randn(*s, dtype=torch.bfloat16) * 1.6)(Dm, H, Dh) * Dm ** (-0.5)), 'Wk': _w((lambda *s: torch.randn(*s, dtype=torch.bfloat16) * 1.6)(Dm, H, Dh) * Dm ** (-0.5)), 'Wv': _w((lambda *s: torch.randn(*s, dtype=torch.bfloat16) * 0.8)(Dm, H, Dh) * Dm ** (-0.5)), 'Wo': _w((lambda *s: torch.randn(*s, dtype=torch.bfloat16) * 0.8)(H, Dh, Dm) * (H * Dh) ** (-0.5)), 'seg_len': seg}
    _A_in = _A_setup()

    def _B_setup():
        B, S, D, F = (1, 2048, 576, 4608)
        return {'x': _w((lambda *s: torch.randn(*s, dtype=torch.bfloat16) * 0.05)(B, S, D)), 'w_gate': _w((lambda *s: torch.randn(*s, dtype=torch.bfloat16) * 0.8)(D, F) * D ** (-0.5)), 'w_up': _w((lambda *s: torch.randn(*s, dtype=torch.bfloat16) * 0.8)(D, F) * D ** (-0.5)), 'w_down': _w((lambda *s: torch.randn(*s, dtype=torch.bfloat16) * 0.8)(F, D) * F ** (-0.5))}
    _B_in = _B_setup()
    return {'A_x': _A_in['x'], 'A_mem0': _A_in['mem0'], 'A_Wq': _A_in['Wq'], 'A_Wk': _A_in['Wk'], 'A_Wv': _A_in['Wv'], 'A_Wo': _A_in['Wo'], 'A_seg_len': _A_in['seg_len'], 'B_x': _B_in['x'], 'B_w_gate': _B_in['w_gate'], 'B_w_up': _B_in['w_up'], 'B_w_down': _B_in['w_down'], 'c': _w((lambda *s: torch.randn(*s, dtype=torch.bfloat16) * 0.1)(1, 576) * 8.0), 'w_mod': _w((lambda *s: torch.randn(*s, dtype=torch.bfloat16) * 0.1)(576, 6 * 576) * 576 ** (-0.5) * 8.0)}

def reference(A_x, A_mem0, A_Wq, A_Wk, A_Wv, A_Wo, A_seg_len, B_x, B_w_gate, B_w_up, B_w_down, c, w_mod):

    def _A_ref(x, mem0, Wq, Wk, Wv, Wo, seg_len):
        B, S, Dm = x.shape
        H, Dh = (Wq.shape[1], Wq.shape[2])
        M = mem0.shape[1]
        scale = Dh ** (-0.5)
        n_seg = S // seg_len
        L = M + seg_len
        idx = torch.arange(L)
        mask = (idx[:, None] < M) | (idx[:, None] >= idx[None, :])
        mem = mem0
        outs = []
        for s in range(n_seg):
            xs = x[:, s * seg_len:(s + 1) * seg_len, :].clone()
            h = torch.concatenate([mem, xs], axis=1)
            q = torch.einsum('btd,dhe->bhte', h, Wq)
            k = torch.einsum('btd,dhe->bhte', h, Wk)
            v = torch.einsum('btd,dhe->bhte', h, Wv)
            scores = torch.einsum('bhqe,bhke->bhqk', q, k) * scale
            scores = torch.where(mask[None, None], scores, -1000000000.0)
            p = _softmax(scores, axis=-1)
            o = torch.einsum('bhqk,bhke->bhqe', p, v)
            o = torch.einsum('bhte,hed->btd', o, Wo)
            mem = o[:, :M, :].clone()
            outs.append(o[:, M:, :])
        return torch.concatenate(outs, axis=1)

    def _B_ref(x, w_gate, w_up, w_down):
        g = torch.einsum('bsd,df->bsf', x, w_gate)
        u = torch.einsum('bsd,df->bsf', x, w_up)
        h = g * u
        return torch.einsum('bsf,fd->bsd', h, w_down)
    x = A_x
    mod = (_silu(c) @ w_mod).reshape(c.shape[0], 6, 1, -1)
    sa, ca, ga, sb, cb, gb = (mod[:, 0].clone(), mod[:, 1].clone(), mod[:, 2].clone(), mod[:, 3].clone(), mod[:, 4].clone(), mod[:, 5].clone())
    h = _layernorm(x, axis=-1) * (1 + ca) + sa
    x = x + ga * _A_ref(h, A_mem0, A_Wq, A_Wk, A_Wv, A_Wo, A_seg_len)
    h = _layernorm(x, axis=-1) * (1 + cb) + sb
    x = x + gb * _B_ref(h, B_w_gate, B_w_up, B_w_down)
    return x
```

```asm
; @launch grid=(256,1,1) block=(256,1,1) lds=163840
.amdgcn_target "amdgcn-amd-amdhsa--gfx950"
.text
.globl adaLN_cond__memory_aug_recurrent_mem_tr__glu_gated_bilinear__prompt_kernel
.p2align 8
.type adaLN_cond__memory_aug_recurrent_mem_tr__glu_gated_bilinear__prompt_kernel,@function
adaLN_cond__memory_aug_recurrent_mem_tr__glu_gated_bilinear__prompt_kernel:
    s_cmp_ge_u32 s2, 256
    s_cbranch_scc1 L_exit
    s_load_dwordx2 s[8:9], s[0:1], 120
    s_load_dwordx2 s[12:13], s[0:1], 112
    s_mov_b32 s10, 0x10000000
    s_mov_b32 s11, 0x20000
    s_mov_b32 s14, 256
    s_mov_b32 s15, 0x20000
    s_getreg_b32 s5, hwreg(HW_REG_XCC_ID)
    s_and_b32 s5, s5, 15
    s_xor_b32 s5, s5, 3
    v_lshrrev_b32 v1, 6, v0
    s_nop 0
    v_readfirstlane_b32 s4, v1
    v_mov_b32 v2, 0
    s_waitcnt lgkmcnt(0)
    s_cmp_lg_u32 s4, 0
    s_cbranch_scc1 L_tk_wait
    s_mov_b64 exec, 1
    s_mov_b32 s6, 2
    s_cmp_eq_u32 s5, 1
    s_cselect_b32 s6, 1, s6
    s_cmp_eq_u32 s5, 0
    s_cselect_b32 s6, 0, s6
    s_mov_b32 s16, 3
L_tk_try:
    s_lshl_b32 s17, s6, 3
    s_lshr_b32 s7, 0xc02020, s17
    s_and_b32 s7, s7, 0xff
    s_lshr_b32 s17, 0x88808400, s17
    s_and_b32 s17, s17, 0xff
    v_mov_b32 v1, 1
    buffer_atomic_add v1, off, s[12:15], s17 sc0
    s_waitcnt vmcnt(0)
    v_readfirstlane_b32 s3, v1
    s_nop 0
    s_cmp_lt_u32 s3, s7
    s_cbranch_scc1 L_tk_have
    s_add_u32 s6, s6, 1
    s_cmp_eq_u32 s6, 3
    s_cselect_b32 s6, 0, s6
    s_sub_u32 s16, s16, 1
    s_cmp_lg_u32 s16, 0
    s_cbranch_scc1 L_tk_try
    s_mov_b32 s3, 256
L_tk_have:
    s_lshl_b32 s17, s6, 3
    s_lshr_b32 s7, 0xa020e000, s17
    s_and_b32 s7, s7, 0xff
    s_add_u32 s3, s3, s7
    v_mov_b32 v1, s3
    ds_write_b32 v2, v1
    s_waitcnt lgkmcnt(0)
    s_mov_b64 exec, -1
L_tk_wait:
    s_barrier
    ds_read_b32 v1, v2
    s_waitcnt lgkmcnt(0)
    v_readfirstlane_b32 s3, v1
    s_barrier
    s_cmp_lt_u32 s3, 32
    s_cbranch_scc1 R_entry
    s_cmp_ge_u32 s3, 256
    s_cbranch_scc1 L_exit
    s_sub_u32 s6, s3, 32
    s_cmp_ge_u32 s3, 224
    s_cbranch_scc1 L_late
    s_lshr_b32 s7, s6, 2
    s_lshl_b32 s7, s7, 1
    s_and_b32 s3, s6, 1
    s_add_u32 s28, s7, s3
    s_add_u32 s3, s28, 32
    s_and_b32 s7, s6, 0x82
    s_cmp_eq_u32 s7, 0
    s_cbranch_scc1 A1_entry
    s_sub_u32 s7, s6, 64
    s_cmp_lt_u32 s6, 128
    s_cselect_b32 s28, s28, s7
    s_mul_i32 s3, s28, 37
    s_and_b32 s3, s3, 127
    s_add_u32 s3, s3, 96
AUX_entry:
    s_load_dwordx2 s[16:17], s[0:1], 96
    s_mov_b32 s18, 0x3cc000
    s_mov_b32 s19, 0x20000
    s_load_dwordx2 s[20:21], s[0:1], 88
    s_mov_b32 s22, 0x480
    s_mov_b32 s23, 0x20000
    s_load_dwordx2 s[24:25], s[0:1], 0
    s_mov_b32 s26, 0x240000
    s_mov_b32 s27, 0x20000
    s_load_dwordx4 s[52:55], s[0:1], 16
    s_load_dwordx4 s[56:59], s[0:1], 32
    s_mov_b32 s45, 0xffff0000
    s_mov_b32 s33, 400000
    s_mov_b32 s41, 1
    v_lshrrev_b32 v1, 2, v0
    v_and_b32 v2, 3, v0
    v_mul_u32_u24 v3, 6912, v1
    v_lshl_add_u32 v3, v2, 4, v3
    s_lshl_b32 s37, s28, 6
    s_cmp_lt_u32 s28, 108
    s_cselect_b32 s37, s37, 0x20000000
    v_add_u32 v3, s37, v3
    v_lshlrev_b32 v4, 1, v1
    v_and_b32 v5, 63, v0
    v_lshlrev_b32 v6, 3, v5
    v_mov_b32 v8, 0x20000000
    v_cmp_gt_u32 s[46:47], 16, v5
    s_nop 1
    v_cndmask_b32 v7, v8, v6, s[46:47]
    s_lshl_b32 s30, s28, 2
    s_add_u32 s30, s30, s4
    s_mul_i32 s30, s30, 4608
    s_cmp_lt_u32 s28, 128
    s_cselect_b32 s30, s30, 0x20000000
    s_waitcnt lgkmcnt(0)
    s_bitcmp1_b32 s4, 0
    s_cselect_b64 s[52:53], s[54:55], s[52:53]
    s_cselect_b64 s[56:57], s[58:59], s[56:57]
    s_bitcmp1_b32 s4, 1
    s_cselect_b64 s[52:53], s[56:57], s[52:53]
    s_mov_b32 s54, 4718592
    s_mov_b32 s55, 0x20000
    v_mov_b32 v60, 0
    v_mov_b32 v61, 0
    v_mov_b32 v62, 0
    v_mov_b32 v63, 0
    v_lshlrev_b32 v9, 4, v0
    s_mul_i32 s36, s28, 5760
    s_add_u32 s36, s36, 0x144000
    buffer_store_dwordx4 v[60:63], v9, s[8:11], s36 offen sc1
    v_cmp_gt_u32 vcc, 104, v0
    s_nop 1
    v_cndmask_b32 v9, v8, v9, vcc
    s_add_u32 s36, s36, 4096
    buffer_store_dwordx4 v[60:63], v9, s[8:11], s36 offen sc1
    buffer_load_ushort v10, v4, s[20:23], 0 offen offset:0
    buffer_load_ushort v11, v4, s[20:23], 0 offen offset:128
    buffer_load_ushort v12, v4, s[20:23], 0 offen offset:256
    buffer_load_ushort v13, v4, s[20:23], 0 offen offset:384
    buffer_load_ushort v14, v4, s[20:23], 0 offen offset:512
    buffer_load_ushort v15, v4, s[20:23], 0 offen offset:640
    buffer_load_ushort v16, v4, s[20:23], 0 offen offset:768
    buffer_load_ushort v17, v4, s[20:23], 0 offen offset:896
    buffer_load_ushort v18, v4, s[20:23], 0 offen offset:1024
    s_mov_b32 s36, 0
    buffer_load_dwordx4 v[20:23], v3, s[16:19], s36 offen
    s_mov_b32 s36, 442368
    buffer_load_dwordx4 v[24:27], v3, s[16:19], s36 offen
    s_mov_b32 s36, 884736
    buffer_load_dwordx4 v[28:31], v3, s[16:19], s36 offen
    s_mov_b32 s36, 1327104
    buffer_load_dwordx4 v[32:35], v3, s[16:19], s36 offen
    s_mov_b32 s36, 1769472
    buffer_load_dwordx4 v[36:39], v3, s[16:19], s36 offen
    s_mov_b32 s36, 2211840
    buffer_load_dwordx4 v[40:43], v3, s[16:19], s36 offen
    s_mov_b32 s36, 2654208
    buffer_load_dwordx4 v[44:47], v3, s[16:19], s36 offen
    s_mov_b32 s36, 3096576
    buffer_load_dwordx4 v[48:51], v3, s[16:19], s36 offen
    s_mov_b32 s36, 3538944
    buffer_load_dwordx4 v[52:55], v3, s[16:19], s36 offen
    buffer_load_dwordx2 v[100:101], v6, s[24:27], s30 offen offset:0
    buffer_load_dwordx2 v[102:103], v6, s[24:27], s30 offen offset:512
    buffer_load_dwordx2 v[104:105], v7, s[24:27], s30 offen offset:1024
    buffer_load_dwordx2 v[106:107], v6, s[24:27], s30 offen offset:1152
    buffer_load_dwordx2 v[108:109], v6, s[24:27], s30 offen offset:1664
    buffer_load_dwordx2 v[110:111], v7, s[24:27], s30 offen offset:2176
    buffer_load_dwordx2 v[112:113], v6, s[24:27], s30 offen offset:2304
    buffer_load_dwordx2 v[114:115], v6, s[24:27], s30 offen offset:2816
    buffer_load_dwordx2 v[116:117], v7, s[24:27], s30 offen offset:3328
    buffer_load_dwordx2 v[118:119], v6, s[24:27], s30 offen offset:3456
    buffer_load_dwordx2 v[120:121], v6, s[24:27], s30 offen offset:3968
    s_add_u32 s36, s30, 1024
    buffer_load_dwordx2 v[122:123], v7, s[24:27], s36 offen offset:3456
    s_waitcnt vmcnt(30)
    s_barrier
    v_mov_b32 v66, 1
    s_cmp_eq_u32 s4, 3
    s_cselect_b32 s36, 0, 0x1000
    s_mov_b64 exec, 1
    buffer_atomic_add v66, off, s[12:15], s36 offset:192 sc0
    s_mov_b64 exec, -1
    s_cbranch_scc0 AUX_arrived
    s_waitcnt vmcnt(0)
    v_readfirstlane_b32 s36, v66
    s_nop 0
    s_cmp_lg_u32 s36, 127
    s_cbranch_scc1 AUX_arrived
    v_mov_b32 v66, 128
    s_mov_b64 exec, 1
    buffer_store_dword v66, off, s[12:15], 0 offset:64 sc1
    s_mov_b64 exec, -1
AUX_arrived:
    s_cmp_ge_u32 s28, 108
    s_cbranch_scc1 AUX_nomod
    s_waitcnt vmcnt(22)
    v_lshlrev_b32 v10, 16, v10
    v_mul_f32 v64, 0xbfb8aa3b, v10
    v_exp_f32 v64, v64
    s_nop 0
    v_add_f32 v64, 1.0, v64
    v_rcp_f32 v64, v64
    s_nop 0
    v_mul_f32 v10, v10, v64
    v_cvt_pk_bf16_f32 v10, v10, v10
    v_lshlrev_b32 v10, 16, v10
    v_lshlrev_b32 v11, 16, v11
    v_mul_f32 v64, 0xbfb8aa3b, v11
    v_exp_f32 v64, v64
    s_nop 0
    v_add_f32 v64, 1.0, v64
    v_rcp_f32 v64, v64
    s_nop 0
    v_mul_f32 v11, v11, v64
    v_cvt_pk_bf16_f32 v11, v11, v11
    v_lshlrev_b32 v11, 16, v11
    v_lshlrev_b32 v12, 16, v12
    v_mul_f32 v64, 0xbfb8aa3b, v12
    v_exp_f32 v64, v64
    s_nop 0
    v_add_f32 v64, 1.0, v64
    v_rcp_f32 v64, v64
    s_nop 0
    v_mul_f32 v12, v12, v64
    v_cvt_pk_bf16_f32 v12, v12, v12
    v_lshlrev_b32 v12, 16, v12
    v_lshlrev_b32 v13, 16, v13
    v_mul_f32 v64, 0xbfb8aa3b, v13
    v_exp_f32 v64, v64
    s_nop 0
    v_add_f32 v64, 1.0, v64
    v_rcp_f32 v64, v64
    s_nop 0
    v_mul_f32 v13, v13, v64
    v_cvt_pk_bf16_f32 v13, v13, v13
    v_lshlrev_b32 v13, 16, v13
    v_lshlrev_b32 v14, 16, v14
    v_mul_f32 v64, 0xbfb8aa3b, v14
    v_exp_f32 v64, v64
    s_nop 0
    v_add_f32 v64, 1.0, v64
    v_rcp_f32 v64, v64
    s_nop 0
    v_mul_f32 v14, v14, v64
    v_cvt_pk_bf16_f32 v14, v14, v14
    v_lshlrev_b32 v14, 16, v14
    v_lshlrev_b32 v15, 16, v15
    v_mul_f32 v64, 0xbfb8aa3b, v15
    v_exp_f32 v64, v64
    s_nop 0
    v_add_f32 v64, 1.0, v64
    v_rcp_f32 v64, v64
    s_nop 0
    v_mul_f32 v15, v15, v64
    v_cvt_pk_bf16_f32 v15, v15, v15
    v_lshlrev_b32 v15, 16, v15
    v_lshlrev_b32 v16, 16, v16
    v_mul_f32 v64, 0xbfb8aa3b, v16
    v_exp_f32 v64, v64
    s_nop 0
    v_add_f32 v64, 1.0, v64
    v_rcp_f32 v64, v64
    s_nop 0
    v_mul_f32 v16, v16, v64
    v_cvt_pk_bf16_f32 v16, v16, v16
    v_lshlrev_b32 v16, 16, v16
    v_lshlrev_b32 v17, 16, v17
    v_mul_f32 v64, 0xbfb8aa3b, v17
    v_exp_f32 v64, v64
    s_nop 0
    v_add_f32 v64, 1.0, v64
    v_rcp_f32 v64, v64
    s_nop 0
    v_mul_f32 v17, v17, v64
    v_cvt_pk_bf16_f32 v17, v17, v17
    v_lshlrev_b32 v17, 16, v17
    v_lshlrev_b32 v18, 16, v18
    v_mul_f32 v64, 0xbfb8aa3b, v18
    v_exp_f32 v64, v64
    s_nop 0
    v_add_f32 v64, 1.0, v64
    v_rcp_f32 v64, v64
    s_nop 0
    v_mul_f32 v18, v18, v64
    v_cvt_pk_bf16_f32 v18, v18, v18
    v_lshlrev_b32 v18, 16, v18
    v_mov_b32 v68, 0
    v_mov_b32 v69, 0
    v_mov_b32 v70, 0
    v_mov_b32 v71, 0
    v_mov_b32 v72, 0
    v_mov_b32 v73, 0
    v_mov_b32 v74, 0
    v_mov_b32 v75, 0
    s_waitcnt vmcnt(21)
    v_lshlrev_b32 v64, 16, v20
    v_and_b32 v65, s45, v20
    v_fmac_f32 v68, v64, v10
    v_fmac_f32 v69, v65, v10
    v_lshlrev_b32 v64, 16, v21
    v_and_b32 v65, s45, v21
    v_fmac_f32 v70, v64, v10
    v_fmac_f32 v71, v65, v10
    v_lshlrev_b32 v64, 16, v22
    v_and_b32 v65, s45, v22
    v_fmac_f32 v72, v64, v10
    v_fmac_f32 v73, v65, v10
    v_lshlrev_b32 v64, 16, v23
    v_and_b32 v65, s45, v23
    v_fmac_f32 v74, v64, v10
    v_fmac_f32 v75, v65, v10
    s_waitcnt vmcnt(20)
    v_lshlrev_b32 v64, 16, v24
    v_and_b32 v65, s45, v24
    v_fmac_f32 v68, v64, v11
    v_fmac_f32 v69, v65, v11
    v_lshlrev_b32 v64, 16, v25
    v_and_b32 v65, s45, v25
    v_fmac_f32 v70, v64, v11
    v_fmac_f32 v71, v65, v11
    v_lshlrev_b32 v64, 16, v26
    v_and_b32 v65, s45, v26
    v_fmac_f32 v72, v64, v11
    v_fmac_f32 v73, v65, v11
    v_lshlrev_b32 v64, 16, v27
    v_and_b32 v65, s45, v27
    v_fmac_f32 v74, v64, v11
    v_fmac_f32 v75, v65, v11
    s_waitcnt vmcnt(19)
    v_lshlrev_b32 v64, 16, v28
    v_and_b32 v65, s45, v28
    v_fmac_f32 v68, v64, v12
    v_fmac_f32 v69, v65, v12
    v_lshlrev_b32 v64, 16, v29
    v_and_b32 v65, s45, v29
    v_fmac_f32 v70, v64, v12
    v_fmac_f32 v71, v65, v12
    v_lshlrev_b32 v64, 16, v30
    v_and_b32 v65, s45, v30
    v_fmac_f32 v72, v64, v12
    v_fmac_f32 v73, v65, v12
    v_lshlrev_b32 v64, 16, v31
    v_and_b32 v65, s45, v31
    v_fmac_f32 v74, v64, v12
    v_fmac_f32 v75, v65, v12
    s_waitcnt vmcnt(18)
    v_lshlrev_b32 v64, 16, v32
    v_and_b32 v65, s45, v32
    v_fmac_f32 v68, v64, v13
    v_fmac_f32 v69, v65, v13
    v_lshlrev_b32 v64, 16, v33
    v_and_b32 v65, s45, v33
    v_fmac_f32 v70, v64, v13
    v_fmac_f32 v71, v65, v13
    v_lshlrev_b32 v64, 16, v34
    v_and_b32 v65, s45, v34
    v_fmac_f32 v72, v64, v13
    v_fmac_f32 v73, v65, v13
    v_lshlrev_b32 v64, 16, v35
    v_and_b32 v65, s45, v35
    v_fmac_f32 v74, v64, v13
    v_fmac_f32 v75, v65, v13
    s_waitcnt vmcnt(17)
    v_lshlrev_b32 v64, 16, v36
    v_and_b32 v65, s45, v36
    v_fmac_f32 v68, v64, v14
    v_fmac_f32 v69, v65, v14
    v_lshlrev_b32 v64, 16, v37
    v_and_b32 v65, s45, v37
    v_fmac_f32 v70, v64, v14
    v_fmac_f32 v71, v65, v14
    v_lshlrev_b32 v64, 16, v38
    v_and_b32 v65, s45, v38
    v_fmac_f32 v72, v64, v14
    v_fmac_f32 v73, v65, v14
    v_lshlrev_b32 v64, 16, v39
    v_and_b32 v65, s45, v39
    v_fmac_f32 v74, v64, v14
    v_fmac_f32 v75, v65, v14
    s_waitcnt vmcnt(16)
    v_lshlrev_b32 v64, 16, v40
    v_and_b32 v65, s45, v40
    v_fmac_f32 v68, v64, v15
    v_fmac_f32 v69, v65, v15
    v_lshlrev_b32 v64, 16, v41
    v_and_b32 v65, s45, v41
    v_fmac_f32 v70, v64, v15
    v_fmac_f32 v71, v65, v15
    v_lshlrev_b32 v64, 16, v42
    v_and_b32 v65, s45, v42
    v_fmac_f32 v72, v64, v15
    v_fmac_f32 v73, v65, v15
    v_lshlrev_b32 v64, 16, v43
    v_and_b32 v65, s45, v43
    v_fmac_f32 v74, v64, v15
    v_fmac_f32 v75, v65, v15
    s_waitcnt vmcnt(15)
    v_lshlrev_b32 v64, 16, v44
    v_and_b32 v65, s45, v44
    v_fmac_f32 v68, v64, v16
    v_fmac_f32 v69, v65, v16
    v_lshlrev_b32 v64, 16, v45
    v_and_b32 v65, s45, v45
    v_fmac_f32 v70, v64, v16
    v_fmac_f32 v71, v65, v16
    v_lshlrev_b32 v64, 16, v46
    v_and_b32 v65, s45, v46
    v_fmac_f32 v72, v64, v16
    v_fmac_f32 v73, v65, v16
    v_lshlrev_b32 v64, 16, v47
    v_and_b32 v65, s45, v47
    v_fmac_f32 v74, v64, v16
    v_fmac_f32 v75, v65, v16
    s_waitcnt vmcnt(14)
    v_lshlrev_b32 v64, 16, v48
    v_and_b32 v65, s45, v48
    v_fmac_f32 v68, v64, v17
    v_fmac_f32 v69, v65, v17
    v_lshlrev_b32 v64, 16, v49
    v_and_b32 v65, s45, v49
    v_fmac_f32 v70, v64, v17
    v_fmac_f32 v71, v65, v17
    v_lshlrev_b32 v64, 16, v50
    v_and_b32 v65, s45, v50
    v_fmac_f32 v72, v64, v17
    v_fmac_f32 v73, v65, v17
    v_lshlrev_b32 v64, 16, v51
    v_and_b32 v65, s45, v51
    v_fmac_f32 v74, v64, v17
    v_fmac_f32 v75, v65, v17
    s_waitcnt vmcnt(13)
    v_lshlrev_b32 v64, 16, v52
    v_and_b32 v65, s45, v52
    v_fmac_f32 v68, v64, v18
    v_fmac_f32 v69, v65, v18
    v_lshlrev_b32 v64, 16, v53
    v_and_b32 v65, s45, v53
    v_fmac_f32 v70, v64, v18
    v_fmac_f32 v71, v65, v18
    v_lshlrev_b32 v64, 16, v54
    v_and_b32 v65, s45, v54
    v_fmac_f32 v72, v64, v18
    v_fmac_f32 v73, v65, v18
    v_lshlrev_b32 v64, 16, v55
    v_and_b32 v65, s45, v55
    v_fmac_f32 v74, v64, v18
    v_fmac_f32 v75, v65, v18
    v_mul_u32_u24 v9, 144, v1
    v_lshl_add_u32 v9, v2, 5, v9
    ds_write_b128 v9, v[68:71]
    ds_write_b128 v9, v[72:75] offset:16
    s_waitcnt lgkmcnt(0)
    s_barrier
    s_cmp_lg_u32 s4, 0
    s_cbranch_scc1 AUX_modst
    v_lshrrev_b32 v9, 5, v0
    v_mul_u32_u24 v9, 4608, v9
    v_and_b32 v64, 31, v0
    v_lshl_add_u32 v9, v64, 2, v9
    ds_read_b32 v20, v9 offset:0
    ds_read_b32 v21, v9 offset:144
    ds_read_b32 v22, v9 offset:288
    ds_read_b32 v23, v9 offset:432
    ds_read_b32 v24, v9 offset:576
    ds_read_b32 v25, v9 offset:720
    ds_read_b32 v26, v9 offset:864
    ds_read_b32 v27, v9 offset:1008
    ds_read_b32 v28, v9 offset:1152
    ds_read_b32 v29, v9 offset:1296
    ds_read_b32 v30, v9 offset:1440
    ds_read_b32 v31, v9 offset:1584
    ds_read_b32 v32, v9 offset:1728
    ds_read_b32 v33, v9 offset:1872
    ds_read_b32 v34, v9 offset:2016
    ds_read_b32 v35, v9 offset:2160
    ds_read_b32 v36, v9 offset:2304
    ds_read_b32 v37, v9 offset:2448
    ds_read_b32 v38, v9 offset:2592
    ds_read_b32 v39, v9 offset:2736
    ds_read_b32 v40, v9 offset:2880
    ds_read_b32 v41, v9 offset:3024
    ds_read_b32 v42, v9 offset:3168
    ds_read_b32 v43, v9 offset:3312
    ds_read_b32 v44, v9 offset:3456
    ds_read_b32 v45, v9 offset:3600
    ds_read_b32 v46, v9 offset:3744
    ds_read_b32 v47, v9 offset:3888
    ds_read_b32 v48, v9 offset:4032
    ds_read_b32 v49, v9 offset:4176
    ds_read_b32 v50, v9 offset:4320
    ds_read_b32 v51, v9 offset:4464
    s_waitcnt lgkmcnt(0)
    v_add_f32 v20, v20, v36
    v_add_f32 v21, v21, v37
    v_add_f32 v22, v22, v38
    v_add_f32 v23, v23, v39
    v_add_f32 v24, v24, v40
    v_add_f32 v25, v25, v41
    v_add_f32 v26, v26, v42
    v_add_f32 v27, v27, v43
    v_add_f32 v28, v28, v44
    v_add_f32 v29, v29, v45
    v_add_f32 v30, v30, v46
    v_add_f32 v31, v31, v47
    v_add_f32 v32, v32, v48
    v_add_f32 v33, v33, v49
    v_add_f32 v34, v34, v50
    v_add_f32 v35, v35, v51
    v_add_f32 v20, v20, v28
    v_add_f32 v21, v21, v29
    v_add_f32 v22, v22, v30
    v_add_f32 v23, v23, v31
    v_add_f32 v24, v24, v32
    v_add_f32 v25, v25, v33
    v_add_f32 v26, v26, v34
    v_add_f32 v27, v27, v35
    v_add_f32 v20, v20, v24
    v_add_f32 v21, v21, v25
    v_add_f32 v22, v22, v26
    v_add_f32 v23, v23, v27
    v_add_f32 v20, v20, v22
    v_add_f32 v21, v21, v23
    v_add_f32 v20, v20, v21
    v_mov_b32 v21, v20
    s_nop 1
    v_permlane32_swap_b32 v20, v21
    v_add_f32 v20, v20, v21
    v_cvt_pk_bf16_f32 v20, v20, v20
    v_lshlrev_b32 v20, 16, v20
    v_lshlrev_b32 v64, 2, v64
    s_lshl_b32 s36, s28, 7
    s_add_u32 s36, s36, 0x140000
    s_mov_b32 exec_hi, 0
    buffer_store_dword v20, v64, s[8:11], s36 offen sc1
    s_mov_b64 exec, -1
    s_cmp_lg_u32 s4, 0
    s_cbranch_scc1 dwok_2
dw_1:
    buffer_load_dword v65, off, s[12:15], 0 offset:64 sc1
    s_waitcnt vmcnt(0)
    v_readfirstlane_b32 s37, v65
    s_nop 0
    s_cmp_ge_u32 s37, 128
    s_cbranch_scc1 dwok_2
    s_sleep 1
    s_sub_u32 s33, s33, 1
    s_cmp_gt_i32 s33, 0
    s_cbranch_scc1 dw_1
dwok_2:
    s_lshl_b32 s36, s28, 7
    s_add_u32 s36, s36, 0x1ee000
    v_mov_b32 v65, s41
    s_mov_b64 exec, 1
    buffer_store_dword v65, off, s[8:11], s36 sc1
    s_mov_b64 exec, -1
AUX_modst:
AUX_nomod:
    s_cmp_ge_u32 s28, 128
    s_cbranch_scc1 AUX_noln
    s_waitcnt vmcnt(1)
    v_lshlrev_b32 v10, 16, v100
    v_and_b32 v11, s45, v100
    v_lshlrev_b32 v12, 16, v101
    v_and_b32 v13, s45, v101
    v_lshlrev_b32 v14, 16, v102
    v_and_b32 v15, s45, v102
    v_lshlrev_b32 v16, 16, v103
    v_and_b32 v17, s45, v103
    v_lshlrev_b32 v18, 16, v104
    v_and_b32 v19, s45, v104
    v_lshlrev_b32 v20, 16, v105
    v_and_b32 v21, s45, v105
    v_add_f32 v48, v10, v11
    v_add_f32 v48, v48, v12
    v_add_f32 v48, v48, v13
    v_add_f32 v48, v48, v14
    v_add_f32 v48, v48, v15
    v_add_f32 v48, v48, v16
    v_add_f32 v48, v48, v17
    v_add_f32 v48, v48, v18
    v_add_f32 v48, v48, v19
    v_add_f32 v48, v48, v20
    v_add_f32 v48, v48, v21
    s_nop 1
    v_add_f32_dpp v48, v48, v48 row_ror:8 row_mask:0xf bank_mask:0xf
    s_nop 1
    v_add_f32_dpp v48, v48, v48 row_ror:4 row_mask:0xf bank_mask:0xf
    s_nop 1
    v_add_f32_dpp v48, v48, v48 row_ror:2 row_mask:0xf bank_mask:0xf
    s_nop 1
    v_add_f32_dpp v48, v48, v48 row_ror:1 row_mask:0xf bank_mask:0xf
    v_mov_b32 v9, v48
    s_nop 1
    v_permlane16_swap_b32 v48, v9
    v_add_f32 v48, v48, v9
    v_mov_b32 v9, v48
    s_nop 1
    v_permlane32_swap_b32 v48, v9
    v_add_f32 v48, v48, v9
    v_mul_f32 v49, 0x3ae38e39, v48
    v_sub_f32 v128, v10, v49
    v_sub_f32 v129, v11, v49
    v_sub_f32 v130, v12, v49
    v_sub_f32 v131, v13, v49
    v_sub_f32 v132, v14, v49
    v_sub_f32 v133, v15, v49
    v_sub_f32 v134, v16, v49
    v_sub_f32 v135, v17, v49
    v_sub_f32 v136, v18, v49
    v_sub_f32 v137, v19, v49
    v_sub_f32 v138, v20, v49
    v_sub_f32 v139, v21, v49
    v_mul_f32 v48, v136, v136
    v_fmac_f32 v48, v137, v137
    v_fmac_f32 v48, v138, v138
    v_fmac_f32 v48, v139, v139
    v_cndmask_b32 v48, 0, v48, s[46:47]
    v_fmac_f32 v48, v128, v128
    v_fmac_f32 v48, v129, v129
    v_fmac_f32 v48, v130, v130
    v_fmac_f32 v48, v131, v131
    v_fmac_f32 v48, v132, v132
    v_fmac_f32 v48, v133, v133
    v_fmac_f32 v48, v134, v134
    v_fmac_f32 v48, v135, v135
    s_nop 1
    v_add_f32_dpp v48, v48, v48 row_ror:8 row_mask:0xf bank_mask:0xf
    s_nop 1
    v_add_f32_dpp v48, v48, v48 row_ror:4 row_mask:0xf bank_mask:0xf
    s_nop 1
    v_add_f32_dpp v48, v48, v48 row_ror:2 row_mask:0xf bank_mask:0xf
    s_nop 1
    v_add_f32_dpp v48, v48, v48 row_ror:1 row_mask:0xf bank_mask:0xf
    v_mov_b32 v9, v48
    s_nop 1
    v_permlane16_swap_b32 v48, v9
    v_add_f32 v48, v48, v9
    v_mov_b32 v9, v48
    s_nop 1
    v_permlane32_swap_b32 v48, v9
    v_add_f32 v48, v48, v9
    v_cvt_pk_bf16_f32 v49, v49, v49
    v_lshlrev_b32 v49, 16, v49
    v_sub_f32 v128, v10, v49
    v_sub_f32 v129, v11, v49
    v_sub_f32 v130, v12, v49
    v_sub_f32 v131, v13, v49
    v_sub_f32 v132, v14, v49
    v_sub_f32 v133, v15, v49
    v_sub_f32 v134, v16, v49
    v_sub_f32 v135, v17, v49
    v_sub_f32 v136, v18, v49
    v_sub_f32 v137, v19, v49
    v_sub_f32 v138, v20, v49
    v_sub_f32 v139, v21, v49
    v_mul_f32 v48, 0x3ae38e39, v48
    v_cvt_pk_bf16_f32 v48, v48, v48
    v_lshlrev_b32 v48, 16, v48
    v_add_f32 v48, 0x3727c5ac, v48
    v_cvt_pk_bf16_f32 v48, v48, v48
    v_lshlrev_b32 v48, 16, v48
    v_sqrt_f32 v48, v48
    s_nop 0
    v_cvt_pk_bf16_f32 v48, v48, v48
    v_lshlrev_b32 v48, 16, v48
    v_rcp_f32 v48, v48
    v_cvt_pk_bf16_f32 v50, v128, v129
    v_lshlrev_b32 v128, 16, v50
    v_and_b32 v129, s45, v50
    v_cvt_pk_bf16_f32 v50, v130, v131
    v_lshlrev_b32 v130, 16, v50
    v_and_b32 v131, s45, v50
    v_cvt_pk_bf16_f32 v50, v132, v133
    v_lshlrev_b32 v132, 16, v50
    v_and_b32 v133, s45, v50
    v_cvt_pk_bf16_f32 v50, v134, v135
    v_lshlrev_b32 v134, 16, v50
    v_and_b32 v135, s45, v50
    v_cvt_pk_bf16_f32 v50, v136, v137
    v_lshlrev_b32 v136, 16, v50
    v_and_b32 v137, s45, v50
    v_cvt_pk_bf16_f32 v50, v138, v139
    v_lshlrev_b32 v138, 16, v50
    v_and_b32 v139, s45, v50
    v_mul_f32 v128, v128, v48
    v_mul_f32 v129, v129, v48
    v_mul_f32 v130, v130, v48
    v_mul_f32 v131, v131, v48
    v_mul_f32 v132, v132, v48
    v_mul_f32 v133, v133, v48
    v_mul_f32 v134, v134, v48
    v_mul_f32 v135, v135, v48
    v_mul_f32 v136, v136, v48
    v_mul_f32 v137, v137, v48
    v_mul_f32 v138, v138, v48
    v_mul_f32 v139, v139, v48
    v_cvt_pk_bf16_f32 v50, v128, v129
    v_lshlrev_b32 v128, 16, v50
    v_and_b32 v129, s45, v50
    v_cvt_pk_bf16_f32 v50, v130, v131
    v_lshlrev_b32 v130, 16, v50
    v_and_b32 v131, s45, v50
    v_cvt_pk_bf16_f32 v50, v132, v133
    v_lshlrev_b32 v132, 16, v50
    v_and_b32 v133, s45, v50
    v_cvt_pk_bf16_f32 v50, v134, v135
    v_lshlrev_b32 v134, 16, v50
    v_and_b32 v135, s45, v50
    v_cvt_pk_bf16_f32 v50, v136, v137
    v_lshlrev_b32 v136, 16, v50
    v_and_b32 v137, s45, v50
    v_cvt_pk_bf16_f32 v50, v138, v139
    v_lshlrev_b32 v138, 16, v50
    v_and_b32 v139, s45, v50
    v_lshlrev_b32 v10, 16, v106
    v_and_b32 v11, s45, v106
    v_lshlrev_b32 v12, 16, v107
    v_and_b32 v13, s45, v107
    v_lshlrev_b32 v14, 16, v108
    v_and_b32 v15, s45, v108
    v_lshlrev_b32 v16, 16, v109
    v_and_b32 v17, s45, v109
    v_lshlrev_b32 v18, 16, v110
    v_and_b32 v19, s45, v110
    v_lshlrev_b32 v20, 16, v111
    v_and_b32 v21, s45, v111
    v_add_f32 v48, v10, v11
    v_add_f32 v48, v48, v12
    v_add_f32 v48, v48, v13
    v_add_f32 v48, v48, v14
    v_add_f32 v48, v48, v15
    v_add_f32 v48, v48, v16
    v_add_f32 v48, v48, v17
    v_add_f32 v48, v48, v18
    v_add_f32 v48, v48, v19
    v_add_f32 v48, v48, v20
    v_add_f32 v48, v48, v21
    s_nop 1
    v_add_f32_dpp v48, v48, v48 row_ror:8 row_mask:0xf bank_mask:0xf
    s_nop 1
    v_add_f32_dpp v48, v48, v48 row_ror:4 row_mask:0xf bank_mask:0xf
    s_nop 1
    v_add_f32_dpp v48, v48, v48 row_ror:2 row_mask:0xf bank_mask:0xf
    s_nop 1
    v_add_f32_dpp v48, v48, v48 row_ror:1 row_mask:0xf bank_mask:0xf
    v_mov_b32 v9, v48
    s_nop 1
    v_permlane16_swap_b32 v48, v9
    v_add_f32 v48, v48, v9
    v_mov_b32 v9, v48
    s_nop 1
    v_permlane32_swap_b32 v48, v9
    v_add_f32 v48, v48, v9
    v_mul_f32 v49, 0x3ae38e39, v48
    v_sub_f32 v140, v10, v49
    v_sub_f32 v141, v11, v49
    v_sub_f32 v142, v12, v49
    v_sub_f32 v143, v13, v49
    v_sub_f32 v144, v14, v49
    v_sub_f32 v145, v15, v49
    v_sub_f32 v146, v16, v49
    v_sub_f32 v147, v17, v49
    v_sub_f32 v148, v18, v49
    v_sub_f32 v149, v19, v49
    v_sub_f32 v150, v20, v49
    v_sub_f32 v151, v21, v49
    v_mul_f32 v48, v148, v148
    v_fmac_f32 v48, v149, v149
    v_fmac_f32 v48, v150, v150
    v_fmac_f32 v48, v151, v151
    v_cndmask_b32 v48, 0, v48, s[46:47]
    v_fmac_f32 v48, v140, v140
    v_fmac_f32 v48, v141, v141
    v_fmac_f32 v48, v142, v142
    v_fmac_f32 v48, v143, v143
    v_fmac_f32 v48, v144, v144
    v_fmac_f32 v48, v145, v145
    v_fmac_f32 v48, v146, v146
    v_fmac_f32 v48, v147, v147
    s_nop 1
    v_add_f32_dpp v48, v48, v48 row_ror:8 row_mask:0xf bank_mask:0xf
    s_nop 1
    v_add_f32_dpp v48, v48, v48 row_ror:4 row_mask:0xf bank_mask:0xf
    s_nop 1
    v_add_f32_dpp v48, v48, v48 row_ror:2 row_mask:0xf bank_mask:0xf
    s_nop 1
    v_add_f32_dpp v48, v48, v48 row_ror:1 row_mask:0xf bank_mask:0xf
    v_mov_b32 v9, v48
    s_nop 1
    v_permlane16_swap_b32 v48, v9
    v_add_f32 v48, v48, v9
    v_mov_b32 v9, v48
    s_nop 1
    v_permlane32_swap_b32 v48, v9
    v_add_f32 v48, v48, v9
    v_cvt_pk_bf16_f32 v49, v49, v49
    v_lshlrev_b32 v49, 16, v49
    v_sub_f32 v140, v10, v49
    v_sub_f32 v141, v11, v49
    v_sub_f32 v142, v12, v49
    v_sub_f32 v143, v13, v49
    v_sub_f32 v144, v14, v49
    v_sub_f32 v145, v15, v49
    v_sub_f32 v146, v16, v49
    v_sub_f32 v147, v17, v49
    v_sub_f32 v148, v18, v49
    v_sub_f32 v149, v19, v49
    v_sub_f32 v150, v20, v49
    v_sub_f32 v151, v21, v49
    v_mul_f32 v48, 0x3ae38e39, v48
    v_cvt_pk_bf16_f32 v48, v48, v48
    v_lshlrev_b32 v48, 16, v48
    v_add_f32 v48, 0x3727c5ac, v48
    v_cvt_pk_bf16_f32 v48, v48, v48
    v_lshlrev_b32 v48, 16, v48
    v_sqrt_f32 v48, v48
    s_nop 0
    v_cvt_pk_bf16_f32 v48, v48, v48
    v_lshlrev_b32 v48, 16, v48
    v_rcp_f32 v48, v48
    v_cvt_pk_bf16_f32 v50, v140, v141
    v_lshlrev_b32 v140, 16, v50
    v_and_b32 v141, s45, v50
    v_cvt_pk_bf16_f32 v50, v142, v143
    v_lshlrev_b32 v142, 16, v50
    v_and_b32 v143, s45, v50
    v_cvt_pk_bf16_f32 v50, v144, v145
    v_lshlrev_b32 v144, 16, v50
    v_and_b32 v145, s45, v50
    v_cvt_pk_bf16_f32 v50, v146, v147
    v_lshlrev_b32 v146, 16, v50
    v_and_b32 v147, s45, v50
    v_cvt_pk_bf16_f32 v50, v148, v149
    v_lshlrev_b32 v148, 16, v50
    v_and_b32 v149, s45, v50
    v_cvt_pk_bf16_f32 v50, v150, v151
    v_lshlrev_b32 v150, 16, v50
    v_and_b32 v151, s45, v50
    v_mul_f32 v140, v140, v48
    v_mul_f32 v141, v141, v48
    v_mul_f32 v142, v142, v48
    v_mul_f32 v143, v143, v48
    v_mul_f32 v144, v144, v48
    v_mul_f32 v145, v145, v48
    v_mul_f32 v146, v146, v48
    v_mul_f32 v147, v147, v48
    v_mul_f32 v148, v148, v48
    v_mul_f32 v149, v149, v48
    v_mul_f32 v150, v150, v48
    v_mul_f32 v151, v151, v48
    v_cvt_pk_bf16_f32 v50, v140, v141
    v_lshlrev_b32 v140, 16, v50
    v_and_b32 v141, s45, v50
    v_cvt_pk_bf16_f32 v50, v142, v143
    v_lshlrev_b32 v142, 16, v50
    v_and_b32 v143, s45, v50
    v_cvt_pk_bf16_f32 v50, v144, v145
    v_lshlrev_b32 v144, 16, v50
    v_and_b32 v145, s45, v50
    v_cvt_pk_bf16_f32 v50, v146, v147
    v_lshlrev_b32 v146, 16, v50
    v_and_b32 v147, s45, v50
    v_cvt_pk_bf16_f32 v50, v148, v149
    v_lshlrev_b32 v148, 16, v50
    v_and_b32 v149, s45, v50
    v_cvt_pk_bf16_f32 v50, v150, v151
    v_lshlrev_b32 v150, 16, v50
    v_and_b32 v151, s45, v50
    v_lshlrev_b32 v10, 16, v112
    v_and_b32 v11, s45, v112
    v_lshlrev_b32 v12, 16, v113
    v_and_b32 v13, s45, v113
    v_lshlrev_b32 v14, 16, v114
    v_and_b32 v15, s45, v114
    v_lshlrev_b32 v16, 16, v115
    v_and_b32 v17, s45, v115
    v_lshlrev_b32 v18, 16, v116
    v_and_b32 v19, s45, v116
    v_lshlrev_b32 v20, 16, v117
    v_and_b32 v21, s45, v117
    v_add_f32 v48, v10, v11
    v_add_f32 v48, v48, v12
    v_add_f32 v48, v48, v13
    v_add_f32 v48, v48, v14
    v_add_f32 v48, v48, v15
    v_add_f32 v48, v48, v16
    v_add_f32 v48, v48, v17
    v_add_f32 v48, v48, v18
    v_add_f32 v48, v48, v19
    v_add_f32 v48, v48, v20
    v_add_f32 v48, v48, v21
    s_nop 1
    v_add_f32_dpp v48, v48, v48 row_ror:8 row_mask:0xf bank_mask:0xf
    s_nop 1
    v_add_f32_dpp v48, v48, v48 row_ror:4 row_mask:0xf bank_mask:0xf
    s_nop 1
    v_add_f32_dpp v48, v48, v48 row_ror:2 row_mask:0xf bank_mask:0xf
    s_nop 1
    v_add_f32_dpp v48, v48, v48 row_ror:1 row_mask:0xf bank_mask:0xf
    v_mov_b32 v9, v48
    s_nop 1
    v_permlane16_swap_b32 v48, v9
    v_add_f32 v48, v48, v9
    v_mov_b32 v9, v48
    s_nop 1
    v_permlane32_swap_b32 v48, v9
    v_add_f32 v48, v48, v9
    v_mul_f32 v49, 0x3ae38e39, v48
    v_sub_f32 v152, v10, v49
    v_sub_f32 v153, v11, v49
    v_sub_f32 v154, v12, v49
    v_sub_f32 v155, v13, v49
    v_sub_f32 v156, v14, v49
    v_sub_f32 v157, v15, v49
    v_sub_f32 v158, v16, v49
    v_sub_f32 v159, v17, v49
    v_sub_f32 v160, v18, v49
    v_sub_f32 v161, v19, v49
    v_sub_f32 v162, v20, v49
    v_sub_f32 v163, v21, v49
    v_mul_f32 v48, v160, v160
    v_fmac_f32 v48, v161, v161
    v_fmac_f32 v48, v162, v162
    v_fmac_f32 v48, v163, v163
    v_cndmask_b32 v48, 0, v48, s[46:47]
    v_fmac_f32 v48, v152, v152
    v_fmac_f32 v48, v153, v153
    v_fmac_f32 v48, v154, v154
    v_fmac_f32 v48, v155, v155
    v_fmac_f32 v48, v156, v156
    v_fmac_f32 v48, v157, v157
    v_fmac_f32 v48, v158, v158
    v_fmac_f32 v48, v159, v159
    s_nop 1
    v_add_f32_dpp v48, v48, v48 row_ror:8 row_mask:0xf bank_mask:0xf
    s_nop 1
    v_add_f32_dpp v48, v48, v48 row_ror:4 row_mask:0xf bank_mask:0xf
    s_nop 1
    v_add_f32_dpp v48, v48, v48 row_ror:2 row_mask:0xf bank_mask:0xf
    s_nop 1
    v_add_f32_dpp v48, v48, v48 row_ror:1 row_mask:0xf bank_mask:0xf
    v_mov_b32 v9, v48
    s_nop 1
    v_permlane16_swap_b32 v48, v9
    v_add_f32 v48, v48, v9
    v_mov_b32 v9, v48
    s_nop 1
    v_permlane32_swap_b32 v48, v9
    v_add_f32 v48, v48, v9
    v_cvt_pk_bf16_f32 v49, v49, v49
    v_lshlrev_b32 v49, 16, v49
    v_sub_f32 v152, v10, v49
    v_sub_f32 v153, v11, v49
    v_sub_f32 v154, v12, v49
    v_sub_f32 v155, v13, v49
    v_sub_f32 v156, v14, v49
    v_sub_f32 v157, v15, v49
    v_sub_f32 v158, v16, v49
    v_sub_f32 v159, v17, v49
    v_sub_f32 v160, v18, v49
    v_sub_f32 v161, v19, v49
    v_sub_f32 v162, v20, v49
    v_sub_f32 v163, v21, v49
    v_mul_f32 v48, 0x3ae38e39, v48
    v_cvt_pk_bf16_f32 v48, v48, v48
    v_lshlrev_b32 v48, 16, v48
    v_add_f32 v48, 0x3727c5ac, v48
    v_cvt_pk_bf16_f32 v48, v48, v48
    v_lshlrev_b32 v48, 16, v48
    v_sqrt_f32 v48, v48
    s_nop 0
    v_cvt_pk_bf16_f32 v48, v48, v48
    v_lshlrev_b32 v48, 16, v48
    v_rcp_f32 v48, v48
    v_cvt_pk_bf16_f32 v50, v152, v153
    v_lshlrev_b32 v152, 16, v50
    v_and_b32 v153, s45, v50
    v_cvt_pk_bf16_f32 v50, v154, v155
    v_lshlrev_b32 v154, 16, v50
    v_and_b32 v155, s45, v50
    v_cvt_pk_bf16_f32 v50, v156, v157
    v_lshlrev_b32 v156, 16, v50
    v_and_b32 v157, s45, v50
    v_cvt_pk_bf16_f32 v50, v158, v159
    v_lshlrev_b32 v158, 16, v50
    v_and_b32 v159, s45, v50
    v_cvt_pk_bf16_f32 v50, v160, v161
    v_lshlrev_b32 v160, 16, v50
    v_and_b32 v161, s45, v50
    v_cvt_pk_bf16_f32 v50, v162, v163
    v_lshlrev_b32 v162, 16, v50
    v_and_b32 v163, s45, v50
    v_mul_f32 v152, v152, v48
    v_mul_f32 v153, v153, v48
    v_mul_f32 v154, v154, v48
    v_mul_f32 v155, v155, v48
    v_mul_f32 v156, v156, v48
    v_mul_f32 v157, v157, v48
    v_mul_f32 v158, v158, v48
    v_mul_f32 v159, v159, v48
    v_mul_f32 v160, v160, v48
    v_mul_f32 v161, v161, v48
    v_mul_f32 v162, v162, v48
    v_mul_f32 v163, v163, v48
    v_cvt_pk_bf16_f32 v50, v152, v153
    v_lshlrev_b32 v152, 16, v50
    v_and_b32 v153, s45, v50
    v_cvt_pk_bf16_f32 v50, v154, v155
    v_lshlrev_b32 v154, 16, v50
    v_and_b32 v155, s45, v50
    v_cvt_pk_bf16_f32 v50, v156, v157
    v_lshlrev_b32 v156, 16, v50
    v_and_b32 v157, s45, v50
    v_cvt_pk_bf16_f32 v50, v158, v159
    v_lshlrev_b32 v158, 16, v50
    v_and_b32 v159, s45, v50
    v_cvt_pk_bf16_f32 v50, v160, v161
    v_lshlrev_b32 v160, 16, v50
    v_and_b32 v161, s45, v50
    v_cvt_pk_bf16_f32 v50, v162, v163
    v_lshlrev_b32 v162, 16, v50
    v_and_b32 v163, s45, v50
    v_lshlrev_b32 v10, 16, v118
    v_and_b32 v11, s45, v118
    v_lshlrev_b32 v12, 16, v119
    v_and_b32 v13, s45, v119
    v_lshlrev_b32 v14, 16, v120
    v_and_b32 v15, s45, v120
    v_lshlrev_b32 v16, 16, v121
    v_and_b32 v17, s45, v121
    v_lshlrev_b32 v18, 16, v122
    v_and_b32 v19, s45, v122
    v_lshlrev_b32 v20, 16, v123
    v_and_b32 v21, s45, v123
    v_add_f32 v48, v10, v11
    v_add_f32 v48, v48, v12
    v_add_f32 v48, v48, v13
    v_add_f32 v48, v48, v14
    v_add_f32 v48, v48, v15
    v_add_f32 v48, v48, v16
    v_add_f32 v48, v48, v17
    v_add_f32 v48, v48, v18
    v_add_f32 v48, v48, v19
    v_add_f32 v48, v48, v20
    v_add_f32 v48, v48, v21
    s_nop 1
    v_add_f32_dpp v48, v48, v48 row_ror:8 row_mask:0xf bank_mask:0xf
    s_nop 1
    v_add_f32_dpp v48, v48, v48 row_ror:4 row_mask:0xf bank_mask:0xf
    s_nop 1
    v_add_f32_dpp v48, v48, v48 row_ror:2 row_mask:0xf bank_mask:0xf
    s_nop 1
    v_add_f32_dpp v48, v48, v48 row_ror:1 row_mask:0xf bank_mask:0xf
    v_mov_b32 v9, v48
    s_nop 1
    v_permlane16_swap_b32 v48, v9
    v_add_f32 v48, v48, v9
    v_mov_b32 v9, v48
    s_nop 1
    v_permlane32_swap_b32 v48, v9
    v_add_f32 v48, v48, v9
    v_mul_f32 v49, 0x3ae38e39, v48
    v_sub_f32 v164, v10, v49
    v_sub_f32 v165, v11, v49
    v_sub_f32 v166, v12, v49
    v_sub_f32 v167, v13, v49
    v_sub_f32 v168, v14, v49
    v_sub_f32 v169, v15, v49
    v_sub_f32 v170, v16, v49
    v_sub_f32 v171, v17, v49
    v_sub_f32 v172, v18, v49
    v_sub_f32 v173, v19, v49
    v_sub_f32 v174, v20, v49
    v_sub_f32 v175, v21, v49
    v_mul_f32 v48, v172, v172
    v_fmac_f32 v48, v173, v173
    v_fmac_f32 v48, v174, v174
    v_fmac_f32 v48, v175, v175
    v_cndmask_b32 v48, 0, v48, s[46:47]
    v_fmac_f32 v48, v164, v164
    v_fmac_f32 v48, v165, v165
    v_fmac_f32 v48, v166, v166
    v_fmac_f32 v48, v167, v167
    v_fmac_f32 v48, v168, v168
    v_fmac_f32 v48, v169, v169
    v_fmac_f32 v48, v170, v170
    v_fmac_f32 v48, v171, v171
    s_nop 1
    v_add_f32_dpp v48, v48, v48 row_ror:8 row_mask:0xf bank_mask:0xf
    s_nop 1
    v_add_f32_dpp v48, v48, v48 row_ror:4 row_mask:0xf bank_mask:0xf
    s_nop 1
    v_add_f32_dpp v48, v48, v48 row_ror:2 row_mask:0xf bank_mask:0xf
    s_nop 1
    v_add_f32_dpp v48, v48, v48 row_ror:1 row_mask:0xf bank_mask:0xf
    v_mov_b32 v9, v48
    s_nop 1
    v_permlane16_swap_b32 v48, v9
    v_add_f32 v48, v48, v9
    v_mov_b32 v9, v48
    s_nop 1
    v_permlane32_swap_b32 v48, v9
    v_add_f32 v48, v48, v9
    v_cvt_pk_bf16_f32 v49, v49, v49
    v_lshlrev_b32 v49, 16, v49
    v_sub_f32 v164, v10, v49
    v_sub_f32 v165, v11, v49
    v_sub_f32 v166, v12, v49
    v_sub_f32 v167, v13, v49
    v_sub_f32 v168, v14, v49
    v_sub_f32 v169, v15, v49
    v_sub_f32 v170, v16, v49
    v_sub_f32 v171, v17, v49
    v_sub_f32 v172, v18, v49
    v_sub_f32 v173, v19, v49
    v_sub_f32 v174, v20, v49
    v_sub_f32 v175, v21, v49
    v_mul_f32 v48, 0x3ae38e39, v48
    v_cvt_pk_bf16_f32 v48, v48, v48
    v_lshlrev_b32 v48, 16, v48
    v_add_f32 v48, 0x3727c5ac, v48
    v_cvt_pk_bf16_f32 v48, v48, v48
    v_lshlrev_b32 v48, 16, v48
    v_sqrt_f32 v48, v48
    s_nop 0
    v_cvt_pk_bf16_f32 v48, v48, v48
    v_lshlrev_b32 v48, 16, v48
    v_rcp_f32 v48, v48
    v_cvt_pk_bf16_f32 v50, v164, v165
    v_lshlrev_b32 v164, 16, v50
    v_and_b32 v165, s45, v50
    v_cvt_pk_bf16_f32 v50, v166, v167
    v_lshlrev_b32 v166, 16, v50
    v_and_b32 v167, s45, v50
    v_cvt_pk_bf16_f32 v50, v168, v169
    v_lshlrev_b32 v168, 16, v50
    v_and_b32 v169, s45, v50
    v_cvt_pk_bf16_f32 v50, v170, v171
    v_lshlrev_b32 v170, 16, v50
    v_and_b32 v171, s45, v50
    v_cvt_pk_bf16_f32 v50, v172, v173
    v_lshlrev_b32 v172, 16, v50
    v_and_b32 v173, s45, v50
    v_cvt_pk_bf16_f32 v50, v174, v175
    v_lshlrev_b32 v174, 16, v50
    v_and_b32 v175, s45, v50
    v_mul_f32 v164, v164, v48
    v_mul_f32 v165, v165, v48
    v_mul_f32 v166, v166, v48
    v_mul_f32 v167, v167, v48
    v_mul_f32 v168, v168, v48
    v_mul_f32 v169, v169, v48
    v_mul_f32 v170, v170, v48
    v_mul_f32 v171, v171, v48
    v_mul_f32 v172, v172, v48
    v_mul_f32 v173, v173, v48
    v_mul_f32 v174, v174, v48
    v_mul_f32 v175, v175, v48
    v_cvt_pk_bf16_f32 v50, v164, v165
    v_lshlrev_b32 v164, 16, v50
    v_and_b32 v165, s45, v50
    v_cvt_pk_bf16_f32 v50, v166, v167
    v_lshlrev_b32 v166, 16, v50
    v_and_b32 v167, s45, v50
    v_cvt_pk_bf16_f32 v50, v168, v169
    v_lshlrev_b32 v168, 16, v50
    v_and_b32 v169, s45, v50
    v_cvt_pk_bf16_f32 v50, v170, v171
    v_lshlrev_b32 v170, 16, v50
    v_and_b32 v171, s45, v50
    v_cvt_pk_bf16_f32 v50, v172, v173
    v_lshlrev_b32 v172, 16, v50
    v_and_b32 v173, s45, v50
    v_cvt_pk_bf16_f32 v50, v174, v175
    v_lshlrev_b32 v174, 16, v50
    v_and_b32 v175, s45, v50
    s_cmp_lg_u32 s4, 0
    s_cbranch_scc1 dwok_4
dw_3:
    buffer_load_dword v65, off, s[12:15], 0 offset:64 sc1
    s_waitcnt vmcnt(0)
    v_readfirstlane_b32 s37, v65
    s_nop 0
    s_cmp_ge_u32 s37, 128
    s_cbranch_scc1 dwok_4
    s_sleep 1
    s_sub_u32 s33, s33, 1
    s_cmp_gt_i32 s33, 0
    s_cbranch_scc1 dw_3
dwok_4:
    s_barrier
    v_lshlrev_b32 v1, 4, v5
    s_mov_b32 s38, 0x1ee000
    v_lshlrev_b32 v65, 3, v1
    s_mov_b32 exec_lo, 0xffffffff
    s_mov_b32 exec_hi, 0xf
poll_5:
    buffer_load_dword v64, v65, s[8:11], s38 offen sc1
    s_waitcnt vmcnt(0)
    v_cmp_gt_u32 vcc, s41, v64
    s_cbranch_vccz pollok_6
    s_sleep 1
    s_sub_u32 s33, s33, 1
    s_cmp_gt_i32 s33, 0
    s_cbranch_scc1 poll_5
pollok_6:
    s_mov_b64 exec, -1
    s_mov_b32 s36, 0x140000
    s_mov_b32 s37, 0x140900
    v_lshlrev_b32 v9, 1, v7
    buffer_load_dwordx4 v[36:39], v1, s[8:11], s36 offen offset:0 sc1
    buffer_load_dwordx4 v[24:27], v1, s[8:11], s37 offen offset:0 sc1
    buffer_load_dwordx4 v[40:43], v1, s[8:11], s36 offen offset:1024 sc1
    buffer_load_dwordx4 v[28:31], v1, s[8:11], s37 offen offset:1024 sc1
    buffer_load_dwordx4 v[44:47], v9, s[8:11], s36 offen offset:2048 sc1
    buffer_load_dwordx4 v[32:35], v9, s[8:11], s37 offen offset:2048 sc1
    s_waitcnt vmcnt(0)
    v_add_f32 v24, 1.0, v24
    v_add_f32 v25, 1.0, v25
    v_add_f32 v26, 1.0, v26
    v_add_f32 v27, 1.0, v27
    v_add_f32 v28, 1.0, v28
    v_add_f32 v29, 1.0, v29
    v_add_f32 v30, 1.0, v30
    v_add_f32 v31, 1.0, v31
    v_add_f32 v32, 1.0, v32
    v_add_f32 v33, 1.0, v33
    v_add_f32 v34, 1.0, v34
    v_add_f32 v35, 1.0, v35
    v_cvt_pk_bf16_f32 v9, v24, v25
    v_lshlrev_b32 v24, 16, v9
    v_and_b32 v25, s45, v9
    v_cvt_pk_bf16_f32 v9, v26, v27
    v_lshlrev_b32 v26, 16, v9
    v_and_b32 v27, s45, v9
    v_cvt_pk_bf16_f32 v9, v28, v29
    v_lshlrev_b32 v28, 16, v9
    v_and_b32 v29, s45, v9
    v_cvt_pk_bf16_f32 v9, v30, v31
    v_lshlrev_b32 v30, 16, v9
    v_and_b32 v31, s45, v9
    v_cvt_pk_bf16_f32 v9, v32, v33
    v_lshlrev_b32 v32, 16, v9
    v_and_b32 v33, s45, v9
    v_cvt_pk_bf16_f32 v9, v34, v35
    v_lshlrev_b32 v34, 16, v9
    v_and_b32 v35, s45, v9
    s_add_u32 s30, s30, 0x200000
    v_mul_f32 v128, v128, v24
    v_mul_f32 v129, v129, v25
    v_mul_f32 v130, v130, v26
    v_mul_f32 v131, v131, v27
    v_mul_f32 v132, v132, v28
    v_mul_f32 v133, v133, v29
    v_mul_f32 v134, v134, v30
    v_mul_f32 v135, v135, v31
    v_mul_f32 v136, v136, v32
    v_mul_f32 v137, v137, v33
    v_mul_f32 v138, v138, v34
    v_mul_f32 v139, v139, v35
    v_cvt_pk_bf16_f32 v9, v128, v129
    v_lshlrev_b32 v128, 16, v9
    v_and_b32 v129, s45, v9
    v_cvt_pk_bf16_f32 v9, v130, v131
    v_lshlrev_b32 v130, 16, v9
    v_and_b32 v131, s45, v9
    v_cvt_pk_bf16_f32 v9, v132, v133
    v_lshlrev_b32 v132, 16, v9
    v_and_b32 v133, s45, v9
    v_cvt_pk_bf16_f32 v9, v134, v135
    v_lshlrev_b32 v134, 16, v9
    v_and_b32 v135, s45, v9
    v_cvt_pk_bf16_f32 v9, v136, v137
    v_lshlrev_b32 v136, 16, v9
    v_and_b32 v137, s45, v9
    v_cvt_pk_bf16_f32 v9, v138, v139
    v_lshlrev_b32 v138, 16, v9
    v_and_b32 v139, s45, v9
    v_add_f32 v128, v128, v36
    v_add_f32 v129, v129, v37
    v_add_f32 v130, v130, v38
    v_add_f32 v131, v131, v39
    v_add_f32 v132, v132, v40
    v_add_f32 v133, v133, v41
    v_add_f32 v134, v134, v42
    v_add_f32 v135, v135, v43
    v_add_f32 v136, v136, v44
    v_add_f32 v137, v137, v45
    v_add_f32 v138, v138, v46
    v_add_f32 v139, v139, v47
    v_cvt_pk_bf16_f32 v100, v128, v129
    v_cvt_pk_bf16_f32 v101, v130, v131
    v_cvt_pk_bf16_f32 v102, v132, v133
    v_cvt_pk_bf16_f32 v103, v134, v135
    v_cvt_pk_bf16_f32 v104, v136, v137
    v_cvt_pk_bf16_f32 v105, v138, v139
    buffer_store_dwordx2 v[100:101], v6, s[8:11], s30 offen offset:0 sc1
    buffer_store_dwordx2 v[102:103], v6, s[8:11], s30 offen offset:512 sc1
    buffer_store_dwordx2 v[104:105], v7, s[8:11], s30 offen offset:1024 sc1
    v_mul_f32 v140, v140, v24
    v_mul_f32 v141, v141, v25
    v_mul_f32 v142, v142, v26
    v_mul_f32 v143, v143, v27
    v_mul_f32 v144, v144, v28
    v_mul_f32 v145, v145, v29
    v_mul_f32 v146, v146, v30
    v_mul_f32 v147, v147, v31
    v_mul_f32 v148, v148, v32
    v_mul_f32 v149, v149, v33
    v_mul_f32 v150, v150, v34
    v_mul_f32 v151, v151, v35
    v_cvt_pk_bf16_f32 v9, v140, v141
    v_lshlrev_b32 v140, 16, v9
    v_and_b32 v141, s45, v9
    v_cvt_pk_bf16_f32 v9, v142, v143
    v_lshlrev_b32 v142, 16, v9
    v_and_b32 v143, s45, v9
    v_cvt_pk_bf16_f32 v9, v144, v145
    v_lshlrev_b32 v144, 16, v9
    v_and_b32 v145, s45, v9
    v_cvt_pk_bf16_f32 v9, v146, v147
    v_lshlrev_b32 v146, 16, v9
    v_and_b32 v147, s45, v9
    v_cvt_pk_bf16_f32 v9, v148, v149
    v_lshlrev_b32 v148, 16, v9
    v_and_b32 v149, s45, v9
    v_cvt_pk_bf16_f32 v9, v150, v151
    v_lshlrev_b32 v150, 16, v9
    v_and_b32 v151, s45, v9
    v_add_f32 v140, v140, v36
    v_add_f32 v141, v141, v37
    v_add_f32 v142, v142, v38
    v_add_f32 v143, v143, v39
    v_add_f32 v144, v144, v40
    v_add_f32 v145, v145, v41
    v_add_f32 v146, v146, v42
    v_add_f32 v147, v147, v43
    v_add_f32 v148, v148, v44
    v_add_f32 v149, v149, v45
    v_add_f32 v150, v150, v46
    v_add_f32 v151, v151, v47
    v_cvt_pk_bf16_f32 v106, v140, v141
    v_cvt_pk_bf16_f32 v107, v142, v143
    v_cvt_pk_bf16_f32 v108, v144, v145
    v_cvt_pk_bf16_f32 v109, v146, v147
    v_cvt_pk_bf16_f32 v110, v148, v149
    v_cvt_pk_bf16_f32 v111, v150, v151
    buffer_store_dwordx2 v[106:107], v6, s[8:11], s30 offen offset:1152 sc1
    buffer_store_dwordx2 v[108:109], v6, s[8:11], s30 offen offset:1664 sc1
    buffer_store_dwordx2 v[110:111], v7, s[8:11], s30 offen offset:2176 sc1
    v_mul_f32 v152, v152, v24
    v_mul_f32 v153, v153, v25
    v_mul_f32 v154, v154, v26
    v_mul_f32 v155, v155, v27
    v_mul_f32 v156, v156, v28
    v_mul_f32 v157, v157, v29
    v_mul_f32 v158, v158, v30
    v_mul_f32 v159, v159, v31
    v_mul_f32 v160, v160, v32
    v_mul_f32 v161, v161, v33
    v_mul_f32 v162, v162, v34
    v_mul_f32 v163, v163, v35
    v_cvt_pk_bf16_f32 v9, v152, v153
    v_lshlrev_b32 v152, 16, v9
    v_and_b32 v153, s45, v9
    v_cvt_pk_bf16_f32 v9, v154, v155
    v_lshlrev_b32 v154, 16, v9
    v_and_b32 v155, s45, v9
    v_cvt_pk_bf16_f32 v9, v156, v157
    v_lshlrev_b32 v156, 16, v9
    v_and_b32 v157, s45, v9
    v_cvt_pk_bf16_f32 v9, v158, v159
    v_lshlrev_b32 v158, 16, v9
    v_and_b32 v159, s45, v9
    v_cvt_pk_bf16_f32 v9, v160, v161
    v_lshlrev_b32 v160, 16, v9
    v_and_b32 v161, s45, v9
    v_cvt_pk_bf16_f32 v9, v162, v163
    v_lshlrev_b32 v162, 16, v9
    v_and_b32 v163, s45, v9
    v_add_f32 v152, v152, v36
    v_add_f32 v153, v153, v37
    v_add_f32 v154, v154, v38
    v_add_f32 v155, v155, v39
    v_add_f32 v156, v156, v40
    v_add_f32 v157, v157, v41
    v_add_f32 v158, v158, v42
    v_add_f32 v159, v159, v43
    v_add_f32 v160, v160, v44
    v_add_f32 v161, v161, v45
    v_add_f32 v162, v162, v46
    v_add_f32 v163, v163, v47
    v_cvt_pk_bf16_f32 v112, v152, v153
    v_cvt_pk_bf16_f32 v113, v154, v155
    v_cvt_pk_bf16_f32 v114, v156, v157
    v_cvt_pk_bf16_f32 v115, v158, v159
    v_cvt_pk_bf16_f32 v116, v160, v161
    v_cvt_pk_bf16_f32 v117, v162, v163
    buffer_store_dwordx2 v[112:113], v6, s[8:11], s30 offen offset:2304 sc1
    buffer_store_dwordx2 v[114:115], v6, s[8:11], s30 offen offset:2816 sc1
    buffer_store_dwordx2 v[116:117], v7, s[8:11], s30 offen offset:3328 sc1
    v_mul_f32 v164, v164, v24
    v_mul_f32 v165, v165, v25
    v_mul_f32 v166, v166, v26
    v_mul_f32 v167, v167, v27
    v_mul_f32 v168, v168, v28
    v_mul_f32 v169, v169, v29
    v_mul_f32 v170, v170, v30
    v_mul_f32 v171, v171, v31
    v_mul_f32 v172, v172, v32
    v_mul_f32 v173, v173, v33
    v_mul_f32 v174, v174, v34
    v_mul_f32 v175, v175, v35
    v_cvt_pk_bf16_f32 v9, v164, v165
    v_lshlrev_b32 v164, 16, v9
    v_and_b32 v165, s45, v9
    v_cvt_pk_bf16_f32 v9, v166, v167
    v_lshlrev_b32 v166, 16, v9
    v_and_b32 v167, s45, v9
    v_cvt_pk_bf16_f32 v9, v168, v169
    v_lshlrev_b32 v168, 16, v9
    v_and_b32 v169, s45, v9
    v_cvt_pk_bf16_f32 v9, v170, v171
    v_lshlrev_b32 v170, 16, v9
    v_and_b32 v171, s45, v9
    v_cvt_pk_bf16_f32 v9, v172, v173
    v_lshlrev_b32 v172, 16, v9
    v_and_b32 v173, s45, v9
    v_cvt_pk_bf16_f32 v9, v174, v175
    v_lshlrev_b32 v174, 16, v9
    v_and_b32 v175, s45, v9
    v_add_f32 v164, v164, v36
    v_add_f32 v165, v165, v37
    v_add_f32 v166, v166, v38
    v_add_f32 v167, v167, v39
    v_add_f32 v168, v168, v40
    v_add_f32 v169, v169, v41
    v_add_f32 v170, v170, v42
    v_add_f32 v171, v171, v43
    v_add_f32 v172, v172, v44
    v_add_f32 v173, v173, v45
    v_add_f32 v174, v174, v46
    v_add_f32 v175, v175, v47
    v_cvt_pk_bf16_f32 v118, v164, v165
    v_cvt_pk_bf16_f32 v119, v166, v167
    v_cvt_pk_bf16_f32 v120, v168, v169
    v_cvt_pk_bf16_f32 v121, v170, v171
    v_cvt_pk_bf16_f32 v122, v172, v173
    v_cvt_pk_bf16_f32 v123, v174, v175
    buffer_store_dwordx2 v[118:119], v6, s[8:11], s30 offen offset:3456 sc1
    buffer_store_dwordx2 v[120:121], v6, s[8:11], s30 offen offset:3968 sc1
    s_add_u32 s30, s30, 1024
    buffer_store_dwordx2 v[122:123], v7, s[8:11], s30 offen offset:3456 sc1
    s_lshl_b32 s38, s28, 7
    s_add_u32 s38, s38, 0x1f2000
    s_waitcnt vmcnt(0)
    s_barrier
    s_cmp_lg_u32 s4, 0
    s_cbranch_scc1 nosig_7
    v_mov_b32 v9, s41
    s_mov_b64 exec, 1
    buffer_store_dword v9, off, s[8:11], s38 sc1
    s_mov_b64 exec, -1
nosig_7:
AUX_noln:
L_late:
    s_sub_u32 s28, s3, 96
    s_cmp_lt_u32 s3, 144
    s_cbranch_scc1 A2_entry
    s_sub_u32 s28, s3, 144
    s_cmp_lt_u32 s3, 216
    s_cbranch_scc1 DE_entry
    s_sub_u32 s28, s3, 216
    s_cmp_lt_u32 s3, 256
    s_cbranch_scc1 CF_entry
L_exit:
    s_endpgm
R_entry:
    s_mov_b32 s28, s3
    s_mov_b32 s86, 0
R_common:
    v_and_b32 v20, 63, v0
    v_and_b32 v21, 15, v20
    v_lshrrev_b32 v22, 4, v20
    v_lshlrev_b32 v1, 4, v20
    v_lshrrev_b32 v23, 2, v21
    v_and_b32 v24, 1, v21
    v_lshl_add_u32 v23, v23, 1, v24
    v_mov_b32 v26, 0x4444
    v_mov_b32 v27, 0xeeee
    v_cmp_eq_u32 vcc, 1, v24
    s_nop 1
    v_cndmask_b32 v0, v26, v27, vcc
    v_lshrrev_b32 v25, 1, v21
    v_mul_u32_u24 v26, 288, v25
    v_lshl_add_u32 v28, v22, 4, v26
    v_add_u32 v8, 160000, v28
    v_mul_u32_u24 v26, 288, v23
    s_lshl_b32 s54, s4, 6
    v_lshl_add_u32 v28, v22, 4, v26
    v_add_u32 v28, s54, v28
    v_add_u32 v7, 160000, v28
    v_mul_u32_u24 v26, 272, v21
    v_lshl_add_u32 v26, v22, 4, v26
    v_add_u32 v6, 155648, v26
    s_cmp_lt_u32 s4, 2
    s_cselect_b32 s54, 544, 0
    s_and_b32 s55, s4, 1
    s_lshl_b32 s55, s55, 7
    s_add_u32 s54, s54, s55
    s_add_u32 s54, s54, 155648
    v_mul_u32_u24 v26, 1088, v22
    v_lshl_add_u32 v26, v21, 3, v26
    v_add_u32 v5, s54, v26
    s_mul_i32 s54, s4, 36864
    v_add_u32 v9, s54, v1
    v_lshrrev_b32 v27, 3, v21
    v_lshl_add_u32 v27, v22, 1, v27
    s_and_b32 s55, s4, 1
    s_lshl_b32 s55, s55, 3
    s_xor_b32 s55, s55, s28
    v_xor_b32 v30, s55, v27
    s_lshl_b32 s54, s4, 4
    v_add_u32 v27, s54, v27
    v_lshlrev_b32 v27, 12, v27
    v_and_b32 v28, 7, v21
    v_lshl_add_u32 v27, v28, 4, v27
    v_lshl_add_u32 v2, v30, 7, v27
    s_lshr_b32 s54, s4, 1
    s_add_u32 s54, s54, 64
    s_lshl_b32 s54, s54, 12
    s_and_b32 s55, s4, 1
    s_lshl_b32 s55, s55, 6
    s_add_u32 s54, s54, s55
    v_lshlrev_b32 v30, 1, v22
    v_xor_b32 v30, s28, v30
    v_lshlrev_b32 v26, 13, v22
    v_lshl_add_u32 v26, v21, 2, v26
    v_lshl_add_u32 v26, v30, 7, v26
    v_add_u32 v3, s54, v26
    s_lshl_b32 s40, s4, 5
    s_xor_b32 s54, s28, 24
    s_cmp_eq_u32 s4, 2
    s_cselect_b32 s54, s54, s28
    s_add_u32 s40, s40, s54
    s_lshl_b32 s54, s40, 12
    s_lshr_b32 s55, s40, 3
    s_lshl_b32 s57, s55, 7
    s_and_b32 s56, s55, 1
    s_lshl_b32 s56, s56, 2
    s_lshr_b32 s58, s55, 1
    s_add_u32 s56, s56, s58
    s_cmp_eq_u32 s55, 8
    s_cselect_b32 s55, 8, s56
    s_cmp_ge_u32 s55, 9
    s_cselect_b32 s7, 1, 0
    s_lshl_b32 s55, s55, 10
    s_and_b32 s56, s40, 1
    s_lshl_b32 s58, s56, 9
    s_add_u32 s55, s55, s58
    s_lshl_b32 s58, s56, 6
    s_add_u32 s57, s57, s58
    s_and_b32 s56, s40, 6
    s_lshl_b32 s58, s56, 5
    s_add_u32 s55, s55, s58
    s_mul_i32 s58, s56, 1152
    s_add_u32 s57, s57, s58
    s_cmp_lt_u32 s40, 72
    s_cselect_b32 s59, s54, 0x20000000
    s_cselect_b32 s55, s55, 0x20000000
    v_bfe_u32 v26, v21, 2, 1
    v_lshlrev_b32 v26, 8, v26
    v_and_b32 v30, 1, v22
    v_lshl_add_u32 v26, v30, 5, v26
    v_and_b32 v27, 3, v21
    v_lshl_add_u32 v26, v27, 3, v26
    v_add_u32 v26, s55, v26
    v_lshrrev_b32 v27, 3, v21
    v_and_b32 v28, 2, v22
    v_add_u32 v27, v27, v28
    v_mul_u32_u24 v28, 9344, v27
    v_add_u32 v26, v26, v28
    v_mov_b32 v28, 0x20000000
    v_cmp_gt_u32 vcc, 4, v27
    s_nop 1
    v_cndmask_b32 v4, v28, v26, vcc
    s_and_b32 s100, s4, 3
    s_mul_i32 s100, s100, 9344
    v_mul_u32_u24 v29, 1152, v30
    v_and_b32 v27, 7, v21
    v_lshl_add_u32 v29, v27, 3, v29
    v_add_u32 v29, s57, v29
    s_load_dwordx2 s[64:65], s[0:1], 8
    s_mov_b32 s66, 0x2400
    s_mov_b32 s67, 0x20000
    s_mov_b32 s42, 0xcccccccc
    s_mov_b32 s43, 0xcccccccc
    s_cmp_lt_u32 s40, 64
    s_cselect_b32 s90, 4, 6
    s_mov_b32 s54, 0x11111111
    s_cselect_b32 s44, 0x3030303, s54
    s_mov_b32 s45, s44
    s_mov_b32 s54, 0x22222222
    s_cselect_b32 s46, 0xc0c0c0c, s54
    s_mov_b32 s47, s46
    s_mov_b32 s54, 0x44444444
    s_cselect_b32 s48, 0x30303030, s54
    s_mov_b32 s49, s48
    s_mov_b32 s54, 0x88888888
    s_cselect_b32 s50, 0xc0c0c0c0, s54
    s_mov_b32 s51, s50
    s_mov_b32 s52, 0x05040100
    s_mov_b32 s53, 0x07060302
    s_mov_b32 s39, 0x3e0293ee
    s_mov_b32 s41, 200000
    s_cmp_lg_u32 s86, 0
    s_mov_b32 s58, 0x0
    s_cselect_b32 s58, 0xb0000, s58
    s_add_u32 s32, s59, s58
    s_load_dwordx2 s[16:17], s[0:1], 40
    s_mov_b32 s18, 0x480000
    s_mov_b32 s19, 0x20000
    s_load_dwordx2 s[20:21], s[0:1], 16
    s_load_dwordx2 s[56:57], s[0:1], 24
    s_mov_b32 s22, 0x480000
    s_mov_b32 s23, 0x20000
    s_load_dwordx2 s[24:25], s[0:1], 32
    s_mov_b32 s26, 0x480000
    s_mov_b32 s27, 0x20000
    v_lshrrev_b32 v26, 1, v22
    v_lshlrev_b32 v26, 4, v26
    v_and_b32 v27, 1, v22
    v_lshl_add_u32 v26, v27, 2, v26
    s_lshl_b32 s54, s28, 7
    v_lshlrev_b32 v27, 2, v22
    v_add_u32 v27, s54, v27
    v_mul_u32_u24 v27, 1152, v27
    s_lshl_b32 s54, s4, 8
    v_lshl_add_u32 v28, v21, 3, v27
    v_add_u32 v12, s54, v28
    s_lshl_b32 s54, s4, 5
    s_add_u32 s54, s54, 1024
    v_lshl_add_u32 v28, v21, 1, v27
    v_add_u32 v13, s54, v28
    v_lshlrev_b32 v27, 13, v26
    s_lshl_b32 s54, s28, 8
    v_add_u32 v27, s54, v27
    s_and_b32 s54, s4, 1
    s_lshl_b32 s54, s54, 7
    v_lshl_add_u32 v28, v21, 3, v27
    v_add_u32 v14, s54, v28
    s_lshl_b32 s54, s4, 6
    v_lshl_add_u32 v28, v21, 2, v27
    v_add_u32 v15, s54, v28
    s_waitcnt lgkmcnt(0)
    s_cmp_lt_u32 s4, 2
    s_cselect_b32 s20, s20, s56
    s_cselect_b32 s21, s21, s57
    s_lshl_b32 s92, s28, 7
    s_add_u32 s92, s92, 0x144000
    buffer_load_dwordx2 v[74:75], v29, s[64:67], 0 offen
    v_mov_b32 v76, -1
    v_mov_b32 v77, -1
    v_mov_b32 v78, -1
    v_mov_b32 v79, -1
    buffer_store_dwordx4 v[76:79], v1, s[8:11], s32 offen offset:0 sc1
    buffer_store_dwordx4 v[76:79], v1, s[8:11], s32 offen offset:1024 sc1
    buffer_store_dwordx4 v[76:79], v1, s[8:11], s32 offen offset:2048 sc1
    buffer_store_dwordx4 v[76:79], v1, s[8:11], s32 offen offset:3072 sc1
    s_cmp_lg_u32 s86, 0
    s_mov_b32 s54, 0x20000000
    s_cselect_b32 s54, 0x20000000, s54
    buffer_store_dwordx2 v[76:77], v4, s[8:11], s54 offen sc1
    s_mov_b32 s54, 0x90000
    s_cselect_b32 s54, 0x60000, s54
    buffer_store_dwordx2 v[76:77], v4, s[8:11], s54 offen sc1
    s_mov_b32 s54, 0xa0000
    s_cselect_b32 s54, 0x20000000, s54
    buffer_store_dwordx2 v[76:77], v4, s[8:11], s54 offen sc1
    s_mov_b32 s54, 0
    buffer_load_dwordx2 v[128:129], v12, s[16:19], s54 offen offset:0 nt
    buffer_load_dwordx2 v[130:131], v12, s[16:19], s54 offen offset:128 nt
    buffer_load_dwordx2 v[132:133], v12, s[16:19], s54 offen offset:1152 nt
    buffer_load_dwordx2 v[134:135], v12, s[16:19], s54 offen offset:1280 nt
    buffer_load_dwordx2 v[136:137], v12, s[16:19], s54 offen offset:2304 nt
    buffer_load_dwordx2 v[138:139], v12, s[16:19], s54 offen offset:2432 nt
    buffer_load_dwordx2 v[140:141], v12, s[16:19], s54 offen offset:3456 nt
    buffer_load_dwordx2 v[142:143], v12, s[16:19], s54 offen offset:3584 nt
    s_mov_b32 s54, 18432
    buffer_load_dwordx2 v[144:145], v12, s[16:19], s54 offen offset:0 nt
    buffer_load_dwordx2 v[146:147], v12, s[16:19], s54 offen offset:128 nt
    buffer_load_dwordx2 v[148:149], v12, s[16:19], s54 offen offset:1152 nt
    buffer_load_dwordx2 v[150:151], v12, s[16:19], s54 offen offset:1280 nt
    buffer_load_dwordx2 v[152:153], v12, s[16:19], s54 offen offset:2304 nt
    buffer_load_dwordx2 v[154:155], v12, s[16:19], s54 offen offset:2432 nt
    buffer_load_dwordx2 v[156:157], v12, s[16:19], s54 offen offset:3456 nt
    buffer_load_dwordx2 v[158:159], v12, s[16:19], s54 offen offset:3584 nt
    s_mov_b32 s54, 36864
    buffer_load_dwordx2 v[160:161], v12, s[16:19], s54 offen offset:0 nt
    buffer_load_dwordx2 v[162:163], v12, s[16:19], s54 offen offset:128 nt
    buffer_load_dwordx2 v[164:165], v12, s[16:19], s54 offen offset:1152 nt
    buffer_load_dwordx2 v[166:167], v12, s[16:19], s54 offen offset:1280 nt
    buffer_load_dwordx2 v[168:169], v12, s[16:19], s54 offen offset:2304 nt
    buffer_load_dwordx2 v[170:171], v12, s[16:19], s54 offen offset:2432 nt
    buffer_load_dwordx2 v[172:173], v12, s[16:19], s54 offen offset:3456 nt
    buffer_load_dwordx2 v[174:175], v12, s[16:19], s54 offen offset:3584 nt
    s_mov_b32 s54, 55296
    buffer_load_dwordx2 v[176:177], v12, s[16:19], s54 offen offset:0 nt
    buffer_load_dwordx2 v[178:179], v12, s[16:19], s54 offen offset:128 nt
    buffer_load_dwordx2 v[180:181], v12, s[16:19], s54 offen offset:1152 nt
    buffer_load_dwordx2 v[182:183], v12, s[16:19], s54 offen offset:1280 nt
    buffer_load_dwordx2 v[184:185], v12, s[16:19], s54 offen offset:2304 nt
    buffer_load_dwordx2 v[186:187], v12, s[16:19], s54 offen offset:2432 nt
    buffer_load_dwordx2 v[188:189], v12, s[16:19], s54 offen offset:3456 nt
    buffer_load_dwordx2 v[190:191], v12, s[16:19], s54 offen offset:3584 nt
    s_mov_b32 s54, 73728
    buffer_load_dwordx2 v[192:193], v12, s[16:19], s54 offen offset:0 nt
    buffer_load_dwordx2 v[194:195], v12, s[16:19], s54 offen offset:128 nt
    buffer_load_dwordx2 v[196:197], v12, s[16:19], s54 offen offset:1152 nt
    buffer_load_dwordx2 v[198:199], v12, s[16:19], s54 offen offset:1280 nt
    buffer_load_dwordx2 v[200:201], v12, s[16:19], s54 offen offset:2304 nt
    buffer_load_dwordx2 v[202:203], v12, s[16:19], s54 offen offset:2432 nt
    buffer_load_dwordx2 v[204:205], v12, s[16:19], s54 offen offset:3456 nt
    buffer_load_dwordx2 v[206:207], v12, s[16:19], s54 offen offset:3584 nt
    s_mov_b32 s54, 92160
    buffer_load_dwordx2 v[208:209], v12, s[16:19], s54 offen offset:0 nt
    buffer_load_dwordx2 v[210:211], v12, s[16:19], s54 offen offset:128 nt
    buffer_load_dwordx2 v[212:213], v12, s[16:19], s54 offen offset:1152 nt
    buffer_load_dwordx2 v[214:215], v12, s[16:19], s54 offen offset:1280 nt
    buffer_load_dwordx2 v[216:217], v12, s[16:19], s54 offen offset:2304 nt
    buffer_load_dwordx2 v[218:219], v12, s[16:19], s54 offen offset:2432 nt
    buffer_load_dwordx2 v[220:221], v12, s[16:19], s54 offen offset:3456 nt
    buffer_load_dwordx2 v[222:223], v12, s[16:19], s54 offen offset:3584 nt
    s_waitcnt vmcnt(48)
    s_cmp_lg_u32 s86, 0
    s_mov_b32 s54, 0x80000
    s_cselect_b32 s54, 0x50000, s54
    buffer_store_dwordx2 v[74:75], v4, s[8:11], s54 offen sc1
    s_waitcnt vmcnt(33)
    v_perm_b32 v48, v132, v128, s52
    v_perm_b32 v49, v132, v128, s53
    v_perm_b32 v50, v140, v136, s52
    v_perm_b32 v51, v140, v136, s53
    ds_write_b128 v9, v[48:51] offset:18432
    v_perm_b32 v52, v148, v144, s52
    v_perm_b32 v53, v148, v144, s53
    v_perm_b32 v54, v156, v152, s52
    v_perm_b32 v55, v156, v152, s53
    ds_write_b128 v9, v[52:55] offset:19456
    v_perm_b32 v56, v133, v129, s52
    v_perm_b32 v57, v133, v129, s53
    v_perm_b32 v58, v141, v137, s52
    v_perm_b32 v59, v141, v137, s53
    ds_write_b128 v9, v[56:59] offset:22528
    v_perm_b32 v60, v149, v145, s52
    v_perm_b32 v61, v149, v145, s53
    v_perm_b32 v62, v157, v153, s52
    v_perm_b32 v63, v157, v153, s53
    ds_write_b128 v9, v[60:63] offset:23552
    v_perm_b32 v48, v134, v130, s52
    v_perm_b32 v49, v134, v130, s53
    v_perm_b32 v50, v142, v138, s52
    v_perm_b32 v51, v142, v138, s53
    ds_write_b128 v9, v[48:51] offset:26624
    v_perm_b32 v52, v150, v146, s52
    v_perm_b32 v53, v150, v146, s53
    v_perm_b32 v54, v158, v154, s52
    v_perm_b32 v55, v158, v154, s53
    ds_write_b128 v9, v[52:55] offset:27648
    v_perm_b32 v56, v135, v131, s52
    v_perm_b32 v57, v135, v131, s53
    v_perm_b32 v58, v143, v139, s52
    v_perm_b32 v59, v143, v139, s53
    ds_write_b128 v9, v[56:59] offset:30720
    v_perm_b32 v60, v151, v147, s52
    v_perm_b32 v61, v151, v147, s53
    v_perm_b32 v62, v159, v155, s52
    v_perm_b32 v63, v159, v155, s53
    ds_write_b128 v9, v[60:63] offset:31744
    s_mov_b32 s54, 110592
    buffer_load_dwordx2 v[224:225], v12, s[16:19], s54 offen offset:0 nt
    buffer_load_dwordx2 v[226:227], v12, s[16:19], s54 offen offset:128 nt
    buffer_load_dwordx2 v[228:229], v12, s[16:19], s54 offen offset:1152 nt
    buffer_load_dwordx2 v[230:231], v12, s[16:19], s54 offen offset:1280 nt
    buffer_load_dwordx2 v[232:233], v12, s[16:19], s54 offen offset:2304 nt
    buffer_load_dwordx2 v[234:235], v12, s[16:19], s54 offen offset:2432 nt
    buffer_load_dwordx2 v[236:237], v12, s[16:19], s54 offen offset:3456 nt
    buffer_load_dwordx2 v[238:239], v12, s[16:19], s54 offen offset:3584 nt
    s_mov_b32 s54, 129024
    buffer_load_dwordx2 v[240:241], v12, s[16:19], s54 offen offset:0 nt
    buffer_load_dwordx2 v[242:243], v12, s[16:19], s54 offen offset:128 nt
    buffer_load_dwordx2 v[244:245], v12, s[16:19], s54 offen offset:1152 nt
    buffer_load_dwordx2 v[246:247], v12, s[16:19], s54 offen offset:1280 nt
    buffer_load_dwordx2 v[248:249], v12, s[16:19], s54 offen offset:2304 nt
    buffer_load_dwordx2 v[250:251], v12, s[16:19], s54 offen offset:2432 nt
    buffer_load_dwordx2 v[252:253], v12, s[16:19], s54 offen offset:3456 nt
    buffer_load_dwordx2 v[254:255], v12, s[16:19], s54 offen offset:3584 nt
    s_waitcnt vmcnt(33)
    v_perm_b32 v48, v164, v160, s52
    v_perm_b32 v49, v164, v160, s53
    v_perm_b32 v50, v172, v168, s52
    v_perm_b32 v51, v172, v168, s53
    v_accvgpr_write_b32 a216, v48
    v_accvgpr_write_b32 a217, v49
    v_accvgpr_write_b32 a218, v50
    v_accvgpr_write_b32 a219, v51
    v_perm_b32 v52, v180, v176, s52
    v_perm_b32 v53, v180, v176, s53
    v_perm_b32 v54, v188, v184, s52
    v_perm_b32 v55, v188, v184, s53
    v_accvgpr_write_b32 a220, v52
    v_accvgpr_write_b32 a221, v53
    v_accvgpr_write_b32 a222, v54
    v_accvgpr_write_b32 a223, v55
    v_perm_b32 v56, v165, v161, s52
    v_perm_b32 v57, v165, v161, s53
    v_perm_b32 v58, v173, v169, s52
    v_perm_b32 v59, v173, v169, s53
    v_accvgpr_write_b32 a232, v56
    v_accvgpr_write_b32 a233, v57
    v_accvgpr_write_b32 a234, v58
    v_accvgpr_write_b32 a235, v59
    v_perm_b32 v60, v181, v177, s52
    v_perm_b32 v61, v181, v177, s53
    v_perm_b32 v62, v189, v185, s52
    v_perm_b32 v63, v189, v185, s53
    v_accvgpr_write_b32 a236, v60
    v_accvgpr_write_b32 a237, v61
    v_accvgpr_write_b32 a238, v62
    v_accvgpr_write_b32 a239, v63
    v_perm_b32 v48, v166, v162, s52
    v_perm_b32 v49, v166, v162, s53
    v_perm_b32 v50, v174, v170, s52
    v_perm_b32 v51, v174, v170, s53
    v_accvgpr_write_b32 a248, v48
    v_accvgpr_write_b32 a249, v49
    v_accvgpr_write_b32 a250, v50
    v_accvgpr_write_b32 a251, v51
    v_perm_b32 v52, v182, v178, s52
    v_perm_b32 v53, v182, v178, s53
    v_perm_b32 v54, v190, v186, s52
    v_perm_b32 v55, v190, v186, s53
    v_accvgpr_write_b32 a252, v52
    v_accvgpr_write_b32 a253, v53
    v_accvgpr_write_b32 a254, v54
    v_accvgpr_write_b32 a255, v55
    v_perm_b32 v56, v167, v163, s52
    v_perm_b32 v57, v167, v163, s53
    v_perm_b32 v58, v175, v171, s52
    v_perm_b32 v59, v175, v171, s53
    v_mov_b32 v88, v56
    v_mov_b32 v89, v57
    v_mov_b32 v90, v58
    v_mov_b32 v91, v59
    v_perm_b32 v60, v183, v179, s52
    v_perm_b32 v61, v183, v179, s53
    v_perm_b32 v62, v191, v187, s52
    v_perm_b32 v63, v191, v187, s53
    v_mov_b32 v92, v60
    v_mov_b32 v93, v61
    v_mov_b32 v94, v62
    v_mov_b32 v95, v63
    s_mov_b32 s54, 0
    buffer_load_ushort v16, v13, s[16:19], s54 offen offset:0
    buffer_load_ushort v17, v13, s[16:19], s54 offen offset:1152
    s_mov_b32 s54, 36864
    buffer_load_ushort v18, v13, s[16:19], s54 offen offset:0
    buffer_load_ushort v19, v13, s[16:19], s54 offen offset:1152
    s_mov_b32 s54, 2304
    buffer_load_ushort v20, v13, s[16:19], s54 offen offset:0
    buffer_load_ushort v21, v13, s[16:19], s54 offen offset:1152
    s_mov_b32 s54, 39168
    buffer_load_ushort v22, v13, s[16:19], s54 offen offset:0
    buffer_load_ushort v23, v13, s[16:19], s54 offen offset:1152
    s_mov_b32 s54, 18432
    buffer_load_ushort v24, v13, s[16:19], s54 offen offset:0
    buffer_load_ushort v25, v13, s[16:19], s54 offen offset:1152
    s_mov_b32 s54, 55296
    buffer_load_ushort v26, v13, s[16:19], s54 offen offset:0
    buffer_load_ushort v27, v13, s[16:19], s54 offen offset:1152
    s_mov_b32 s54, 20736
    buffer_load_ushort v28, v13, s[16:19], s54 offen offset:0
    buffer_load_ushort v29, v13, s[16:19], s54 offen offset:1152
    s_mov_b32 s54, 57600
    buffer_load_ushort v30, v13, s[16:19], s54 offen offset:0
    buffer_load_ushort v31, v13, s[16:19], s54 offen offset:1152
    s_waitcnt vmcnt(33)
    v_perm_b32 v48, v196, v192, s52
    v_perm_b32 v49, v196, v192, s53
    v_perm_b32 v50, v204, v200, s52
    v_perm_b32 v51, v204, v200, s53
    ds_write_b128 v9, v[48:51] offset:20480
    v_perm_b32 v52, v212, v208, s52
    v_perm_b32 v53, v212, v208, s53
    v_perm_b32 v54, v220, v216, s52
    v_perm_b32 v55, v220, v216, s53
    ds_write_b128 v9, v[52:55] offset:21504
    v_perm_b32 v56, v197, v193, s52
    v_perm_b32 v57, v197, v193, s53
    v_perm_b32 v58, v205, v201, s52
    v_perm_b32 v59, v205, v201, s53
    ds_write_b128 v9, v[56:59] offset:24576
    v_perm_b32 v60, v213, v209, s52
    v_perm_b32 v61, v213, v209, s53
    v_perm_b32 v62, v221, v217, s52
    v_perm_b32 v63, v221, v217, s53
    ds_write_b128 v9, v[60:63] offset:25600
    v_perm_b32 v48, v198, v194, s52
    v_perm_b32 v49, v198, v194, s53
    v_perm_b32 v50, v206, v202, s52
    v_perm_b32 v51, v206, v202, s53
    ds_write_b128 v9, v[48:51] offset:28672
    v_perm_b32 v52, v214, v210, s52
    v_perm_b32 v53, v214, v210, s53
    v_perm_b32 v54, v222, v218, s52
    v_perm_b32 v55, v222, v218, s53
    ds_write_b128 v9, v[52:55] offset:29696
    v_perm_b32 v56, v199, v195, s52
    v_perm_b32 v57, v199, v195, s53
    v_perm_b32 v58, v207, v203, s52
    v_perm_b32 v59, v207, v203, s53
    ds_write_b128 v9, v[56:59] offset:32768
    v_perm_b32 v60, v215, v211, s52
    v_perm_b32 v61, v215, v211, s53
    v_perm_b32 v62, v223, v219, s52
    v_perm_b32 v63, v223, v219, s53
    ds_write_b128 v9, v[60:63] offset:33792
    s_mov_b32 s54, 73728
    buffer_load_ushort v32, v13, s[16:19], s54 offen offset:0
    buffer_load_ushort v33, v13, s[16:19], s54 offen offset:1152
    s_mov_b32 s54, 110592
    buffer_load_ushort v34, v13, s[16:19], s54 offen offset:0
    buffer_load_ushort v35, v13, s[16:19], s54 offen offset:1152
    s_mov_b32 s54, 76032
    buffer_load_ushort v36, v13, s[16:19], s54 offen offset:0
    buffer_load_ushort v37, v13, s[16:19], s54 offen offset:1152
    s_mov_b32 s54, 112896
    buffer_load_ushort v38, v13, s[16:19], s54 offen offset:0
    buffer_load_ushort v39, v13, s[16:19], s54 offen offset:1152
    s_mov_b32 s54, 92160
    buffer_load_ushort v40, v13, s[16:19], s54 offen offset:0
    buffer_load_ushort v41, v13, s[16:19], s54 offen offset:1152
    s_mov_b32 s54, 129024
    buffer_load_ushort v42, v13, s[16:19], s54 offen offset:0
    buffer_load_ushort v43, v13, s[16:19], s54 offen offset:1152
    s_mov_b32 s54, 94464
    buffer_load_ushort v44, v13, s[16:19], s54 offen offset:0
    buffer_load_ushort v45, v13, s[16:19], s54 offen offset:1152
    s_mov_b32 s54, 131328
    buffer_load_ushort v46, v13, s[16:19], s54 offen offset:0
    buffer_load_ushort v47, v13, s[16:19], s54 offen offset:1152
    s_waitcnt vmcnt(32)
    v_perm_b32 v48, v228, v224, s52
    v_perm_b32 v49, v228, v224, s53
    v_perm_b32 v50, v236, v232, s52
    v_perm_b32 v51, v236, v232, s53
    v_accvgpr_write_b32 a224, v48
    v_accvgpr_write_b32 a225, v49
    v_accvgpr_write_b32 a226, v50
    v_accvgpr_write_b32 a227, v51
    v_perm_b32 v52, v244, v240, s52
    v_perm_b32 v53, v244, v240, s53
    v_perm_b32 v54, v252, v248, s52
    v_perm_b32 v55, v252, v248, s53
    v_accvgpr_write_b32 a228, v52
    v_accvgpr_write_b32 a229, v53
    v_accvgpr_write_b32 a230, v54
    v_accvgpr_write_b32 a231, v55
    v_perm_b32 v56, v229, v225, s52
    v_perm_b32 v57, v229, v225, s53
    v_perm_b32 v58, v237, v233, s52
    v_perm_b32 v59, v237, v233, s53
    v_accvgpr_write_b32 a240, v56
    v_accvgpr_write_b32 a241, v57
    v_accvgpr_write_b32 a242, v58
    v_accvgpr_write_b32 a243, v59
    v_perm_b32 v60, v245, v241, s52
    v_perm_b32 v61, v245, v241, s53
    v_perm_b32 v62, v253, v249, s52
    v_perm_b32 v63, v253, v249, s53
    v_accvgpr_write_b32 a244, v60
    v_accvgpr_write_b32 a245, v61
    v_accvgpr_write_b32 a246, v62
    v_accvgpr_write_b32 a247, v63
    v_perm_b32 v48, v230, v226, s52
    v_perm_b32 v49, v230, v226, s53
    v_perm_b32 v50, v238, v234, s52
    v_perm_b32 v51, v238, v234, s53
    v_mov_b32 v80, v48
    v_mov_b32 v81, v49
    v_mov_b32 v82, v50
    v_mov_b32 v83, v51
    v_perm_b32 v52, v246, v242, s52
    v_perm_b32 v53, v246, v242, s53
    v_perm_b32 v54, v254, v250, s52
    v_perm_b32 v55, v254, v250, s53
    v_mov_b32 v84, v52
    v_mov_b32 v85, v53
    v_mov_b32 v86, v54
    v_mov_b32 v87, v55
    v_perm_b32 v56, v231, v227, s52
    v_perm_b32 v57, v231, v227, s53
    v_perm_b32 v58, v239, v235, s52
    v_perm_b32 v59, v239, v235, s53
    v_mov_b32 v96, v56
    v_mov_b32 v97, v57
    v_mov_b32 v98, v58
    v_mov_b32 v99, v59
    v_perm_b32 v60, v247, v243, s52
    v_perm_b32 v61, v247, v243, s53
    v_perm_b32 v62, v255, v251, s52
    v_perm_b32 v63, v255, v251, s53
    v_mov_b32 v100, v60
    v_mov_b32 v101, v61
    v_mov_b32 v102, v62
    v_mov_b32 v103, v63
    s_mov_b32 s54, 0
    buffer_load_dwordx2 v[128:129], v14, s[20:23], s54 offen nt
    s_mov_b32 s54, 8192
    buffer_load_dwordx2 v[130:131], v14, s[20:23], s54 offen nt
    s_mov_b32 s54, 65536
    buffer_load_dwordx2 v[132:133], v14, s[20:23], s54 offen nt
    s_mov_b32 s54, 73728
    buffer_load_dwordx2 v[134:135], v14, s[20:23], s54 offen nt
    s_mov_b32 s54, 16384
    buffer_load_dwordx2 v[136:137], v14, s[20:23], s54 offen nt
    s_mov_b32 s54, 24576
    buffer_load_dwordx2 v[138:139], v14, s[20:23], s54 offen nt
    s_mov_b32 s54, 81920
    buffer_load_dwordx2 v[140:141], v14, s[20:23], s54 offen nt
    s_mov_b32 s54, 90112
    buffer_load_dwordx2 v[142:143], v14, s[20:23], s54 offen nt
    s_mov_b32 s54, 262144
    buffer_load_dwordx2 v[144:145], v14, s[20:23], s54 offen nt
    s_mov_b32 s54, 270336
    buffer_load_dwordx2 v[146:147], v14, s[20:23], s54 offen nt
    s_mov_b32 s54, 327680
    buffer_load_dwordx2 v[148:149], v14, s[20:23], s54 offen nt
    s_mov_b32 s54, 335872
    buffer_load_dwordx2 v[150:151], v14, s[20:23], s54 offen nt
    s_mov_b32 s54, 278528
    buffer_load_dwordx2 v[152:153], v14, s[20:23], s54 offen nt
    s_mov_b32 s54, 286720
    buffer_load_dwordx2 v[154:155], v14, s[20:23], s54 offen nt
    s_mov_b32 s54, 344064
    buffer_load_dwordx2 v[156:157], v14, s[20:23], s54 offen nt
    s_mov_b32 s54, 352256
    buffer_load_dwordx2 v[158:159], v14, s[20:23], s54 offen nt
    s_waitcnt vmcnt(32)
    v_lshl_or_b32 v48, v17, 16, v16
    v_lshl_or_b32 v49, v19, 16, v18
    v_lshl_or_b32 v50, v21, 16, v20
    v_lshl_or_b32 v51, v23, 16, v22
    ds_write_b128 v9, v[48:51] offset:34816
    v_lshl_or_b32 v52, v25, 16, v24
    v_lshl_or_b32 v53, v27, 16, v26
    v_lshl_or_b32 v54, v29, 16, v28
    v_lshl_or_b32 v55, v31, 16, v30
    ds_write_b128 v9, v[52:55] offset:35840
    s_mov_b32 s54, 524288
    buffer_load_dwordx2 v[160:161], v14, s[20:23], s54 offen nt
    s_mov_b32 s54, 532480
    buffer_load_dwordx2 v[162:163], v14, s[20:23], s54 offen nt
    s_mov_b32 s54, 589824
    buffer_load_dwordx2 v[164:165], v14, s[20:23], s54 offen nt
    s_mov_b32 s54, 598016
    buffer_load_dwordx2 v[166:167], v14, s[20:23], s54 offen nt
    s_mov_b32 s54, 540672
    buffer_load_dwordx2 v[168:169], v14, s[20:23], s54 offen nt
    s_mov_b32 s54, 548864
    buffer_load_dwordx2 v[170:171], v14, s[20:23], s54 offen nt
    s_mov_b32 s54, 606208
    buffer_load_dwordx2 v[172:173], v14, s[20:23], s54 offen nt
    s_mov_b32 s54, 614400
    buffer_load_dwordx2 v[174:175], v14, s[20:23], s54 offen nt
    s_mov_b32 s54, 786432
    buffer_load_dwordx2 v[176:177], v14, s[20:23], s54 offen nt
    s_mov_b32 s54, 794624
    buffer_load_dwordx2 v[178:179], v14, s[20:23], s54 offen nt
    s_mov_b32 s54, 851968
    buffer_load_dwordx2 v[180:181], v14, s[20:23], s54 offen nt
    s_mov_b32 s54, 860160
    buffer_load_dwordx2 v[182:183], v14, s[20:23], s54 offen nt
    s_mov_b32 s54, 802816
    buffer_load_dwordx2 v[184:185], v14, s[20:23], s54 offen nt
    s_mov_b32 s54, 811008
    buffer_load_dwordx2 v[186:187], v14, s[20:23], s54 offen nt
    s_mov_b32 s54, 868352
    buffer_load_dwordx2 v[188:189], v14, s[20:23], s54 offen nt
    s_mov_b32 s54, 876544
    buffer_load_dwordx2 v[190:191], v14, s[20:23], s54 offen nt
    s_waitcnt vmcnt(32)
    v_lshl_or_b32 v48, v33, 16, v32
    v_lshl_or_b32 v49, v35, 16, v34
    v_lshl_or_b32 v50, v37, 16, v36
    v_lshl_or_b32 v51, v39, 16, v38
    v_mov_b32 v104, v48
    v_mov_b32 v105, v49
    v_mov_b32 v106, v50
    v_mov_b32 v107, v51
    v_lshl_or_b32 v52, v41, 16, v40
    v_lshl_or_b32 v53, v43, 16, v42
    v_lshl_or_b32 v54, v45, 16, v44
    v_lshl_or_b32 v55, v47, 16, v46
    v_mov_b32 v108, v52
    v_mov_b32 v109, v53
    v_mov_b32 v110, v54
    v_mov_b32 v111, v55
    s_mov_b32 s54, 1048576
    buffer_load_dwordx2 v[192:193], v14, s[20:23], s54 offen nt
    s_mov_b32 s54, 1056768
    buffer_load_dwordx2 v[194:195], v14, s[20:23], s54 offen nt
    s_mov_b32 s54, 1114112
    buffer_load_dwordx2 v[196:197], v14, s[20:23], s54 offen nt
    s_mov_b32 s54, 1122304
    buffer_load_dwordx2 v[198:199], v14, s[20:23], s54 offen nt
    s_mov_b32 s54, 1064960
    buffer_load_dwordx2 v[200:201], v14, s[20:23], s54 offen nt
    s_mov_b32 s54, 1073152
    buffer_load_dwordx2 v[202:203], v14, s[20:23], s54 offen nt
    s_mov_b32 s54, 1130496
    buffer_load_dwordx2 v[204:205], v14, s[20:23], s54 offen nt
    s_mov_b32 s54, 1138688
    buffer_load_dwordx2 v[206:207], v14, s[20:23], s54 offen nt
    s_mov_b32 s54, 1310720
    buffer_load_dwordx2 v[208:209], v14, s[20:23], s54 offen nt
    s_mov_b32 s54, 1318912
    buffer_load_dwordx2 v[210:211], v14, s[20:23], s54 offen nt
    s_mov_b32 s54, 1376256
    buffer_load_dwordx2 v[212:213], v14, s[20:23], s54 offen nt
    s_mov_b32 s54, 1384448
    buffer_load_dwordx2 v[214:215], v14, s[20:23], s54 offen nt
    s_mov_b32 s54, 1327104
    buffer_load_dwordx2 v[216:217], v14, s[20:23], s54 offen nt
    s_mov_b32 s54, 1335296
    buffer_load_dwordx2 v[218:219], v14, s[20:23], s54 offen nt
    s_mov_b32 s54, 1392640
    buffer_load_dwordx2 v[220:221], v14, s[20:23], s54 offen nt
    s_mov_b32 s54, 1400832
    buffer_load_dwordx2 v[222:223], v14, s[20:23], s54 offen nt
    s_waitcnt vmcnt(32)
    v_perm_b32 v48, v130, v128, s52
    v_accvgpr_write_b32 a0, v48
    v_perm_b32 v49, v134, v132, s52
    v_accvgpr_write_b32 a1, v49
    v_perm_b32 v50, v138, v136, s52
    v_accvgpr_write_b32 a2, v50
    v_perm_b32 v51, v142, v140, s52
    v_accvgpr_write_b32 a3, v51
    v_perm_b32 v52, v146, v144, s52
    v_accvgpr_write_b32 a4, v52
    v_perm_b32 v53, v150, v148, s52
    v_accvgpr_write_b32 a5, v53
    v_perm_b32 v54, v154, v152, s52
    v_accvgpr_write_b32 a6, v54
    v_perm_b32 v55, v158, v156, s52
    v_accvgpr_write_b32 a7, v55
    v_perm_b32 v56, v130, v128, s53
    v_accvgpr_write_b32 a8, v56
    v_perm_b32 v57, v134, v132, s53
    v_accvgpr_write_b32 a9, v57
    v_perm_b32 v58, v138, v136, s53
    v_accvgpr_write_b32 a10, v58
    v_perm_b32 v59, v142, v140, s53
    v_accvgpr_write_b32 a11, v59
    v_perm_b32 v60, v146, v144, s53
    v_accvgpr_write_b32 a12, v60
    v_perm_b32 v61, v150, v148, s53
    v_accvgpr_write_b32 a13, v61
    v_perm_b32 v62, v154, v152, s53
    v_accvgpr_write_b32 a14, v62
    v_perm_b32 v63, v158, v156, s53
    v_accvgpr_write_b32 a15, v63
    v_perm_b32 v48, v131, v129, s52
    v_accvgpr_write_b32 a16, v48
    v_perm_b32 v49, v135, v133, s52
    v_accvgpr_write_b32 a17, v49
    v_perm_b32 v50, v139, v137, s52
    v_accvgpr_write_b32 a18, v50
    v_perm_b32 v51, v143, v141, s52
    v_accvgpr_write_b32 a19, v51
    v_perm_b32 v52, v147, v145, s52
    v_accvgpr_write_b32 a20, v52
    v_perm_b32 v53, v151, v149, s52
    v_accvgpr_write_b32 a21, v53
    v_perm_b32 v54, v155, v153, s52
    v_accvgpr_write_b32 a22, v54
    v_perm_b32 v55, v159, v157, s52
    v_accvgpr_write_b32 a23, v55
    v_perm_b32 v56, v131, v129, s53
    v_perm_b32 v57, v135, v133, s53
    v_perm_b32 v58, v139, v137, s53
    v_perm_b32 v59, v143, v141, s53
    v_perm_b32 v60, v147, v145, s53
    v_perm_b32 v61, v151, v149, s53
    v_perm_b32 v62, v155, v153, s53
    v_perm_b32 v63, v159, v157, s53
    ds_write_b128 v9, v[56:59] offset:0
    ds_write_b128 v9, v[60:63] offset:1024
    s_mov_b32 s54, 1572864
    buffer_load_dwordx2 v[224:225], v14, s[20:23], s54 offen nt
    s_mov_b32 s54, 1581056
    buffer_load_dwordx2 v[226:227], v14, s[20:23], s54 offen nt
    s_mov_b32 s54, 1638400
    buffer_load_dwordx2 v[228:229], v14, s[20:23], s54 offen nt
    s_mov_b32 s54, 1646592
    buffer_load_dwordx2 v[230:231], v14, s[20:23], s54 offen nt
    s_mov_b32 s54, 1589248
    buffer_load_dwordx2 v[232:233], v14, s[20:23], s54 offen nt
    s_mov_b32 s54, 1597440
    buffer_load_dwordx2 v[234:235], v14, s[20:23], s54 offen nt
    s_mov_b32 s54, 1654784
    buffer_load_dwordx2 v[236:237], v14, s[20:23], s54 offen nt
    s_mov_b32 s54, 1662976
    buffer_load_dwordx2 v[238:239], v14, s[20:23], s54 offen nt
    s_mov_b32 s54, 1835008
    buffer_load_dwordx2 v[240:241], v14, s[20:23], s54 offen nt
    s_mov_b32 s54, 1843200
    buffer_load_dwordx2 v[242:243], v14, s[20:23], s54 offen nt
    s_mov_b32 s54, 1900544
    buffer_load_dwordx2 v[244:245], v14, s[20:23], s54 offen nt
    s_mov_b32 s54, 1908736
    buffer_load_dwordx2 v[246:247], v14, s[20:23], s54 offen nt
    s_mov_b32 s54, 1851392
    buffer_load_dwordx2 v[248:249], v14, s[20:23], s54 offen nt
    s_mov_b32 s54, 1859584
    buffer_load_dwordx2 v[250:251], v14, s[20:23], s54 offen nt
    s_mov_b32 s54, 1916928
    buffer_load_dwordx2 v[252:253], v14, s[20:23], s54 offen nt
    s_mov_b32 s54, 1925120
    buffer_load_dwordx2 v[254:255], v14, s[20:23], s54 offen nt
    s_waitcnt vmcnt(32)
    v_perm_b32 v48, v162, v160, s52
    v_accvgpr_write_b32 a24, v48
    v_perm_b32 v49, v166, v164, s52
    v_accvgpr_write_b32 a25, v49
    v_perm_b32 v50, v170, v168, s52
    v_accvgpr_write_b32 a26, v50
    v_perm_b32 v51, v174, v172, s52
    v_accvgpr_write_b32 a27, v51
    v_perm_b32 v52, v178, v176, s52
    v_accvgpr_write_b32 a28, v52
    v_perm_b32 v53, v182, v180, s52
    v_accvgpr_write_b32 a29, v53
    v_perm_b32 v54, v186, v184, s52
    v_accvgpr_write_b32 a30, v54
    v_perm_b32 v55, v190, v188, s52
    v_accvgpr_write_b32 a31, v55
    v_perm_b32 v56, v162, v160, s53
    v_accvgpr_write_b32 a32, v56
    v_perm_b32 v57, v166, v164, s53
    v_accvgpr_write_b32 a33, v57
    v_perm_b32 v58, v170, v168, s53
    v_accvgpr_write_b32 a34, v58
    v_perm_b32 v59, v174, v172, s53
    v_accvgpr_write_b32 a35, v59
    v_perm_b32 v60, v178, v176, s53
    v_accvgpr_write_b32 a36, v60
    v_perm_b32 v61, v182, v180, s53
    v_accvgpr_write_b32 a37, v61
    v_perm_b32 v62, v186, v184, s53
    v_accvgpr_write_b32 a38, v62
    v_perm_b32 v63, v190, v188, s53
    v_accvgpr_write_b32 a39, v63
    v_perm_b32 v48, v163, v161, s52
    v_accvgpr_write_b32 a40, v48
    v_perm_b32 v49, v167, v165, s52
    v_accvgpr_write_b32 a41, v49
    v_perm_b32 v50, v171, v169, s52
    v_accvgpr_write_b32 a42, v50
    v_perm_b32 v51, v175, v173, s52
    v_accvgpr_write_b32 a43, v51
    v_perm_b32 v52, v179, v177, s52
    v_accvgpr_write_b32 a44, v52
    v_perm_b32 v53, v183, v181, s52
    v_accvgpr_write_b32 a45, v53
    v_perm_b32 v54, v187, v185, s52
    v_accvgpr_write_b32 a46, v54
    v_perm_b32 v55, v191, v189, s52
    v_accvgpr_write_b32 a47, v55
    v_perm_b32 v56, v163, v161, s53
    v_perm_b32 v57, v167, v165, s53
    v_perm_b32 v58, v171, v169, s53
    v_perm_b32 v59, v175, v173, s53
    v_perm_b32 v60, v179, v177, s53
    v_perm_b32 v61, v183, v181, s53
    v_perm_b32 v62, v187, v185, s53
    v_perm_b32 v63, v191, v189, s53
    ds_write_b128 v9, v[56:59] offset:2048
    ds_write_b128 v9, v[60:63] offset:3072
    s_mov_b32 s54, 2097152
    buffer_load_dwordx2 v[128:129], v14, s[20:23], s54 offen nt
    s_mov_b32 s54, 2105344
    buffer_load_dwordx2 v[130:131], v14, s[20:23], s54 offen nt
    s_mov_b32 s54, 2162688
    buffer_load_dwordx2 v[132:133], v14, s[20:23], s54 offen nt
    s_mov_b32 s54, 2170880
    buffer_load_dwordx2 v[134:135], v14, s[20:23], s54 offen nt
    s_mov_b32 s54, 2113536
    buffer_load_dwordx2 v[136:137], v14, s[20:23], s54 offen nt
    s_mov_b32 s54, 2121728
    buffer_load_dwordx2 v[138:139], v14, s[20:23], s54 offen nt
    s_mov_b32 s54, 2179072
    buffer_load_dwordx2 v[140:141], v14, s[20:23], s54 offen nt
    s_mov_b32 s54, 2187264
    buffer_load_dwordx2 v[142:143], v14, s[20:23], s54 offen nt
    s_mov_b32 s54, 2359296
    buffer_load_dwordx2 v[144:145], v14, s[20:23], s54 offen nt
    s_mov_b32 s54, 2367488
    buffer_load_dwordx2 v[146:147], v14, s[20:23], s54 offen nt
    s_mov_b32 s54, 2424832
    buffer_load_dwordx2 v[148:149], v14, s[20:23], s54 offen nt
    s_mov_b32 s54, 2433024
    buffer_load_dwordx2 v[150:151], v14, s[20:23], s54 offen nt
    s_mov_b32 s54, 2375680
    buffer_load_dwordx2 v[152:153], v14, s[20:23], s54 offen nt
    s_mov_b32 s54, 2383872
    buffer_load_dwordx2 v[154:155], v14, s[20:23], s54 offen nt
    s_mov_b32 s54, 2441216
    buffer_load_dwordx2 v[156:157], v14, s[20:23], s54 offen nt
    s_mov_b32 s54, 2449408
    buffer_load_dwordx2 v[158:159], v14, s[20:23], s54 offen nt
    s_waitcnt vmcnt(32)
    s_barrier
    s_cmp_eq_u32 s5, 0
    s_cselect_b32 s54, 1, 0x10001
    s_cmp_lg_u32 s86, 0
    s_cselect_b32 s54, 1, s54
    v_mov_b32 v74, s54
    s_cmp_eq_u32 s4, 0
    s_cselect_b32 s54, 0, 0x1000
    s_mov_b64 exec, 1
    buffer_atomic_add v74, off, s[12:15], s54 offset:8
    s_mov_b64 exec, -1
    v_perm_b32 v48, v194, v192, s52
    v_accvgpr_write_b32 a48, v48
    v_perm_b32 v49, v198, v196, s52
    v_accvgpr_write_b32 a49, v49
    v_perm_b32 v50, v202, v200, s52
    v_accvgpr_write_b32 a50, v50
    v_perm_b32 v51, v206, v204, s52
    v_accvgpr_write_b32 a51, v51
    v_perm_b32 v52, v210, v208, s52
    v_accvgpr_write_b32 a52, v52
    v_perm_b32 v53, v214, v212, s52
    v_accvgpr_write_b32 a53, v53
    v_perm_b32 v54, v218, v216, s52
    v_accvgpr_write_b32 a54, v54
    v_perm_b32 v55, v222, v220, s52
    v_accvgpr_write_b32 a55, v55
    v_perm_b32 v56, v194, v192, s53
    v_accvgpr_write_b32 a56, v56
    v_perm_b32 v57, v198, v196, s53
    v_accvgpr_write_b32 a57, v57
    v_perm_b32 v58, v202, v200, s53
    v_accvgpr_write_b32 a58, v58
    v_perm_b32 v59, v206, v204, s53
    v_accvgpr_write_b32 a59, v59
    v_perm_b32 v60, v210, v208, s53
    v_accvgpr_write_b32 a60, v60
    v_perm_b32 v61, v214, v212, s53
    v_accvgpr_write_b32 a61, v61
    v_perm_b32 v62, v218, v216, s53
    v_accvgpr_write_b32 a62, v62
    v_perm_b32 v63, v222, v220, s53
    v_accvgpr_write_b32 a63, v63
    v_perm_b32 v48, v195, v193, s52
    v_accvgpr_write_b32 a64, v48
    v_perm_b32 v49, v199, v197, s52
    v_accvgpr_write_b32 a65, v49
    v_perm_b32 v50, v203, v201, s52
    v_accvgpr_write_b32 a66, v50
    v_perm_b32 v51, v207, v205, s52
    v_accvgpr_write_b32 a67, v51
    v_perm_b32 v52, v211, v209, s52
    v_accvgpr_write_b32 a68, v52
    v_perm_b32 v53, v215, v213, s52
    v_accvgpr_write_b32 a69, v53
    v_perm_b32 v54, v219, v217, s52
    v_accvgpr_write_b32 a70, v54
    v_perm_b32 v55, v223, v221, s52
    v_accvgpr_write_b32 a71, v55
    v_perm_b32 v56, v195, v193, s53
    v_perm_b32 v57, v199, v197, s53
    v_perm_b32 v58, v203, v201, s53
    v_perm_b32 v59, v207, v205, s53
    v_perm_b32 v60, v211, v209, s53
    v_perm_b32 v61, v215, v213, s53
    v_perm_b32 v62, v219, v217, s53
    v_perm_b32 v63, v223, v221, s53
    ds_write_b128 v9, v[56:59] offset:4096
    ds_write_b128 v9, v[60:63] offset:5120
    s_mov_b32 s54, 2621440
    buffer_load_dwordx2 v[160:161], v14, s[20:23], s54 offen nt
    s_mov_b32 s54, 2629632
    buffer_load_dwordx2 v[162:163], v14, s[20:23], s54 offen nt
    s_mov_b32 s54, 2686976
    buffer_load_dwordx2 v[164:165], v14, s[20:23], s54 offen nt
    s_mov_b32 s54, 2695168
    buffer_load_dwordx2 v[166:167], v14, s[20:23], s54 offen nt
    s_mov_b32 s54, 2637824
    buffer_load_dwordx2 v[168:169], v14, s[20:23], s54 offen nt
    s_mov_b32 s54, 2646016
    buffer_load_dwordx2 v[170:171], v14, s[20:23], s54 offen nt
    s_mov_b32 s54, 2703360
    buffer_load_dwordx2 v[172:173], v14, s[20:23], s54 offen nt
    s_mov_b32 s54, 2711552
    buffer_load_dwordx2 v[174:175], v14, s[20:23], s54 offen nt
    s_mov_b32 s54, 2883584
    buffer_load_dwordx2 v[176:177], v14, s[20:23], s54 offen nt
    s_mov_b32 s54, 2891776
    buffer_load_dwordx2 v[178:179], v14, s[20:23], s54 offen nt
    s_mov_b32 s54, 2949120
    buffer_load_dwordx2 v[180:181], v14, s[20:23], s54 offen nt
    s_mov_b32 s54, 2957312
    buffer_load_dwordx2 v[182:183], v14, s[20:23], s54 offen nt
    s_mov_b32 s54, 2899968
    buffer_load_dwordx2 v[184:185], v14, s[20:23], s54 offen nt
    s_mov_b32 s54, 2908160
    buffer_load_dwordx2 v[186:187], v14, s[20:23], s54 offen nt
    s_mov_b32 s54, 2965504
    buffer_load_dwordx2 v[188:189], v14, s[20:23], s54 offen nt
    s_mov_b32 s54, 2973696
    buffer_load_dwordx2 v[190:191], v14, s[20:23], s54 offen nt
    s_waitcnt vmcnt(33)
    v_perm_b32 v48, v226, v224, s52
    v_accvgpr_write_b32 a72, v48
    v_perm_b32 v49, v230, v228, s52
    v_accvgpr_write_b32 a73, v49
    v_perm_b32 v50, v234, v232, s52
    v_accvgpr_write_b32 a74, v50
    v_perm_b32 v51, v238, v236, s52
    v_accvgpr_write_b32 a75, v51
    v_perm_b32 v52, v242, v240, s52
    v_accvgpr_write_b32 a76, v52
    v_perm_b32 v53, v246, v244, s52
    v_accvgpr_write_b32 a77, v53
    v_perm_b32 v54, v250, v248, s52
    v_accvgpr_write_b32 a78, v54
    v_perm_b32 v55, v254, v252, s52
    v_accvgpr_write_b32 a79, v55
    v_perm_b32 v56, v226, v224, s53
    v_accvgpr_write_b32 a80, v56
    v_perm_b32 v57, v230, v228, s53
    v_accvgpr_write_b32 a81, v57
    v_perm_b32 v58, v234, v232, s53
    v_accvgpr_write_b32 a82, v58
    v_perm_b32 v59, v238, v236, s53
    v_accvgpr_write_b32 a83, v59
    v_perm_b32 v60, v242, v240, s53
    v_accvgpr_write_b32 a84, v60
    v_perm_b32 v61, v246, v244, s53
    v_accvgpr_write_b32 a85, v61
    v_perm_b32 v62, v250, v248, s53
    v_accvgpr_write_b32 a86, v62
    v_perm_b32 v63, v254, v252, s53
    v_accvgpr_write_b32 a87, v63
    v_perm_b32 v48, v227, v225, s52
    v_accvgpr_write_b32 a88, v48
    v_perm_b32 v49, v231, v229, s52
    v_accvgpr_write_b32 a89, v49
    v_perm_b32 v50, v235, v233, s52
    v_accvgpr_write_b32 a90, v50
    v_perm_b32 v51, v239, v237, s52
    v_accvgpr_write_b32 a91, v51
    v_perm_b32 v52, v243, v241, s52
    v_accvgpr_write_b32 a92, v52
    v_perm_b32 v53, v247, v245, s52
    v_accvgpr_write_b32 a93, v53
    v_perm_b32 v54, v251, v249, s52
    v_accvgpr_write_b32 a94, v54
    v_perm_b32 v55, v255, v253, s52
    v_accvgpr_write_b32 a95, v55
    v_perm_b32 v56, v227, v225, s53
    v_perm_b32 v57, v231, v229, s53
    v_perm_b32 v58, v235, v233, s53
    v_perm_b32 v59, v239, v237, s53
    v_perm_b32 v60, v243, v241, s53
    v_perm_b32 v61, v247, v245, s53
    v_perm_b32 v62, v251, v249, s53
    v_perm_b32 v63, v255, v253, s53
    ds_write_b128 v9, v[56:59] offset:6144
    ds_write_b128 v9, v[60:63] offset:7168
    s_mov_b32 s54, 3145728
    buffer_load_dwordx2 v[192:193], v14, s[20:23], s54 offen nt
    s_mov_b32 s54, 3153920
    buffer_load_dwordx2 v[194:195], v14, s[20:23], s54 offen nt
    s_mov_b32 s54, 3211264
    buffer_load_dwordx2 v[196:197], v14, s[20:23], s54 offen nt
    s_mov_b32 s54, 3219456
    buffer_load_dwordx2 v[198:199], v14, s[20:23], s54 offen nt
    s_mov_b32 s54, 3162112
    buffer_load_dwordx2 v[200:201], v14, s[20:23], s54 offen nt
    s_mov_b32 s54, 3170304
    buffer_load_dwordx2 v[202:203], v14, s[20:23], s54 offen nt
    s_mov_b32 s54, 3227648
    buffer_load_dwordx2 v[204:205], v14, s[20:23], s54 offen nt
    s_mov_b32 s54, 3235840
    buffer_load_dwordx2 v[206:207], v14, s[20:23], s54 offen nt
    s_mov_b32 s54, 3407872
    buffer_load_dwordx2 v[208:209], v14, s[20:23], s54 offen nt
    s_mov_b32 s54, 3416064
    buffer_load_dwordx2 v[210:211], v14, s[20:23], s54 offen nt
    s_mov_b32 s54, 3473408
    buffer_load_dwordx2 v[212:213], v14, s[20:23], s54 offen nt
    s_mov_b32 s54, 3481600
    buffer_load_dwordx2 v[214:215], v14, s[20:23], s54 offen nt
    s_mov_b32 s54, 3424256
    buffer_load_dwordx2 v[216:217], v14, s[20:23], s54 offen nt
    s_mov_b32 s54, 3432448
    buffer_load_dwordx2 v[218:219], v14, s[20:23], s54 offen nt
    s_mov_b32 s54, 3489792
    buffer_load_dwordx2 v[220:221], v14, s[20:23], s54 offen nt
    s_mov_b32 s54, 3497984
    buffer_load_dwordx2 v[222:223], v14, s[20:23], s54 offen nt
    s_waitcnt vmcnt(33)
    v_perm_b32 v48, v130, v128, s52
    v_accvgpr_write_b32 a96, v48
    v_perm_b32 v49, v134, v132, s52
    v_accvgpr_write_b32 a97, v49
    v_perm_b32 v50, v138, v136, s52
    v_accvgpr_write_b32 a98, v50
    v_perm_b32 v51, v142, v140, s52
    v_accvgpr_write_b32 a99, v51
    v_perm_b32 v52, v146, v144, s52
    v_accvgpr_write_b32 a100, v52
    v_perm_b32 v53, v150, v148, s52
    v_accvgpr_write_b32 a101, v53
    v_perm_b32 v54, v154, v152, s52
    v_accvgpr_write_b32 a102, v54
    v_perm_b32 v55, v158, v156, s52
    v_accvgpr_write_b32 a103, v55
    v_perm_b32 v56, v130, v128, s53
    v_accvgpr_write_b32 a104, v56
    v_perm_b32 v57, v134, v132, s53
    v_accvgpr_write_b32 a105, v57
    v_perm_b32 v58, v138, v136, s53
    v_accvgpr_write_b32 a106, v58
    v_perm_b32 v59, v142, v140, s53
    v_accvgpr_write_b32 a107, v59
    v_perm_b32 v60, v146, v144, s53
    v_accvgpr_write_b32 a108, v60
    v_perm_b32 v61, v150, v148, s53
    v_accvgpr_write_b32 a109, v61
    v_perm_b32 v62, v154, v152, s53
    v_accvgpr_write_b32 a110, v62
    v_perm_b32 v63, v158, v156, s53
    v_accvgpr_write_b32 a111, v63
    v_perm_b32 v48, v131, v129, s52
    v_accvgpr_write_b32 a112, v48
    v_perm_b32 v49, v135, v133, s52
    v_accvgpr_write_b32 a113, v49
    v_perm_b32 v50, v139, v137, s52
    v_accvgpr_write_b32 a114, v50
    v_perm_b32 v51, v143, v141, s52
    v_accvgpr_write_b32 a115, v51
    v_perm_b32 v52, v147, v145, s52
    v_accvgpr_write_b32 a116, v52
    v_perm_b32 v53, v151, v149, s52
    v_accvgpr_write_b32 a117, v53
    v_perm_b32 v54, v155, v153, s52
    v_accvgpr_write_b32 a118, v54
    v_perm_b32 v55, v159, v157, s52
    v_accvgpr_write_b32 a119, v55
    v_perm_b32 v56, v131, v129, s53
    v_perm_b32 v57, v135, v133, s53
    v_perm_b32 v58, v139, v137, s53
    v_perm_b32 v59, v143, v141, s53
    v_perm_b32 v60, v147, v145, s53
    v_perm_b32 v61, v151, v149, s53
    v_perm_b32 v62, v155, v153, s53
    v_perm_b32 v63, v159, v157, s53
    ds_write_b128 v9, v[56:59] offset:8192
    ds_write_b128 v9, v[60:63] offset:9216
    s_mov_b32 s54, 3670016
    buffer_load_dwordx2 v[224:225], v14, s[20:23], s54 offen nt
    s_mov_b32 s54, 3678208
    buffer_load_dwordx2 v[226:227], v14, s[20:23], s54 offen nt
    s_mov_b32 s54, 3735552
    buffer_load_dwordx2 v[228:229], v14, s[20:23], s54 offen nt
    s_mov_b32 s54, 3743744
    buffer_load_dwordx2 v[230:231], v14, s[20:23], s54 offen nt
    s_mov_b32 s54, 3686400
    buffer_load_dwordx2 v[232:233], v14, s[20:23], s54 offen nt
    s_mov_b32 s54, 3694592
    buffer_load_dwordx2 v[234:235], v14, s[20:23], s54 offen nt
    s_mov_b32 s54, 3751936
    buffer_load_dwordx2 v[236:237], v14, s[20:23], s54 offen nt
    s_mov_b32 s54, 3760128
    buffer_load_dwordx2 v[238:239], v14, s[20:23], s54 offen nt
    s_mov_b32 s54, 3932160
    buffer_load_dwordx2 v[240:241], v14, s[20:23], s54 offen nt
    s_mov_b32 s54, 3940352
    buffer_load_dwordx2 v[242:243], v14, s[20:23], s54 offen nt
    s_mov_b32 s54, 3997696
    buffer_load_dwordx2 v[244:245], v14, s[20:23], s54 offen nt
    s_mov_b32 s54, 4005888
    buffer_load_dwordx2 v[246:247], v14, s[20:23], s54 offen nt
    s_mov_b32 s54, 3948544
    buffer_load_dwordx2 v[248:249], v14, s[20:23], s54 offen nt
    s_mov_b32 s54, 3956736
    buffer_load_dwordx2 v[250:251], v14, s[20:23], s54 offen nt
    s_mov_b32 s54, 4014080
    buffer_load_dwordx2 v[252:253], v14, s[20:23], s54 offen nt
    s_mov_b32 s54, 4022272
    buffer_load_dwordx2 v[254:255], v14, s[20:23], s54 offen nt
    s_waitcnt vmcnt(32)
    v_perm_b32 v48, v162, v160, s52
    v_accvgpr_write_b32 a120, v48
    v_perm_b32 v49, v166, v164, s52
    v_accvgpr_write_b32 a121, v49
    v_perm_b32 v50, v170, v168, s52
    v_accvgpr_write_b32 a122, v50
    v_perm_b32 v51, v174, v172, s52
    v_accvgpr_write_b32 a123, v51
    v_perm_b32 v52, v178, v176, s52
    v_accvgpr_write_b32 a124, v52
    v_perm_b32 v53, v182, v180, s52
    v_accvgpr_write_b32 a125, v53
    v_perm_b32 v54, v186, v184, s52
    v_accvgpr_write_b32 a126, v54
    v_perm_b32 v55, v190, v188, s52
    v_accvgpr_write_b32 a127, v55
    v_perm_b32 v56, v162, v160, s53
    v_accvgpr_write_b32 a128, v56
    v_perm_b32 v57, v166, v164, s53
    v_accvgpr_write_b32 a129, v57
    v_perm_b32 v58, v170, v168, s53
    v_accvgpr_write_b32 a130, v58
    v_perm_b32 v59, v174, v172, s53
    v_accvgpr_write_b32 a131, v59
    v_perm_b32 v60, v178, v176, s53
    v_accvgpr_write_b32 a132, v60
    v_perm_b32 v61, v182, v180, s53
    v_accvgpr_write_b32 a133, v61
    v_perm_b32 v62, v186, v184, s53
    v_accvgpr_write_b32 a134, v62
    v_perm_b32 v63, v190, v188, s53
    v_accvgpr_write_b32 a135, v63
    v_perm_b32 v48, v163, v161, s52
    v_accvgpr_write_b32 a136, v48
    v_perm_b32 v49, v167, v165, s52
    v_accvgpr_write_b32 a137, v49
    v_perm_b32 v50, v171, v169, s52
    v_accvgpr_write_b32 a138, v50
    v_perm_b32 v51, v175, v173, s52
    v_accvgpr_write_b32 a139, v51
    v_perm_b32 v52, v179, v177, s52
    v_accvgpr_write_b32 a140, v52
    v_perm_b32 v53, v183, v181, s52
    v_accvgpr_write_b32 a141, v53
    v_perm_b32 v54, v187, v185, s52
    v_accvgpr_write_b32 a142, v54
    v_perm_b32 v55, v191, v189, s52
    v_accvgpr_write_b32 a143, v55
    v_perm_b32 v56, v163, v161, s53
    v_perm_b32 v57, v167, v165, s53
    v_perm_b32 v58, v171, v169, s53
    v_perm_b32 v59, v175, v173, s53
    v_perm_b32 v60, v179, v177, s53
    v_perm_b32 v61, v183, v181, s53
    v_perm_b32 v62, v187, v185, s53
    v_perm_b32 v63, v191, v189, s53
    ds_write_b128 v9, v[56:59] offset:10240
    ds_write_b128 v9, v[60:63] offset:11264
    s_mov_b32 s54, 4194304
    buffer_load_dwordx2 v[128:129], v14, s[20:23], s54 offen nt
    s_mov_b32 s54, 4202496
    buffer_load_dwordx2 v[130:131], v14, s[20:23], s54 offen nt
    s_mov_b32 s54, 4259840
    buffer_load_dwordx2 v[132:133], v14, s[20:23], s54 offen nt
    s_mov_b32 s54, 4268032
    buffer_load_dwordx2 v[134:135], v14, s[20:23], s54 offen nt
    s_mov_b32 s54, 4210688
    buffer_load_dwordx2 v[136:137], v14, s[20:23], s54 offen nt
    s_mov_b32 s54, 4218880
    buffer_load_dwordx2 v[138:139], v14, s[20:23], s54 offen nt
    s_mov_b32 s54, 4276224
    buffer_load_dwordx2 v[140:141], v14, s[20:23], s54 offen nt
    s_mov_b32 s54, 4284416
    buffer_load_dwordx2 v[142:143], v14, s[20:23], s54 offen nt
    s_mov_b32 s54, 4456448
    buffer_load_dwordx2 v[144:145], v14, s[20:23], s54 offen nt
    s_mov_b32 s54, 4464640
    buffer_load_dwordx2 v[146:147], v14, s[20:23], s54 offen nt
    s_mov_b32 s54, 4521984
    buffer_load_dwordx2 v[148:149], v14, s[20:23], s54 offen nt
    s_mov_b32 s54, 4530176
    buffer_load_dwordx2 v[150:151], v14, s[20:23], s54 offen nt
    s_mov_b32 s54, 4472832
    buffer_load_dwordx2 v[152:153], v14, s[20:23], s54 offen nt
    s_mov_b32 s54, 4481024
    buffer_load_dwordx2 v[154:155], v14, s[20:23], s54 offen nt
    s_mov_b32 s54, 4538368
    buffer_load_dwordx2 v[156:157], v14, s[20:23], s54 offen nt
    s_mov_b32 s54, 4546560
    buffer_load_dwordx2 v[158:159], v14, s[20:23], s54 offen nt
    s_waitcnt vmcnt(32)
    v_perm_b32 v48, v194, v192, s52
    v_accvgpr_write_b32 a144, v48
    v_perm_b32 v49, v198, v196, s52
    v_accvgpr_write_b32 a145, v49
    v_perm_b32 v50, v202, v200, s52
    v_accvgpr_write_b32 a146, v50
    v_perm_b32 v51, v206, v204, s52
    v_accvgpr_write_b32 a147, v51
    v_perm_b32 v52, v210, v208, s52
    v_accvgpr_write_b32 a148, v52
    v_perm_b32 v53, v214, v212, s52
    v_accvgpr_write_b32 a149, v53
    v_perm_b32 v54, v218, v216, s52
    v_accvgpr_write_b32 a150, v54
    v_perm_b32 v55, v222, v220, s52
    v_accvgpr_write_b32 a151, v55
    v_perm_b32 v56, v194, v192, s53
    v_accvgpr_write_b32 a152, v56
    v_perm_b32 v57, v198, v196, s53
    v_accvgpr_write_b32 a153, v57
    v_perm_b32 v58, v202, v200, s53
    v_accvgpr_write_b32 a154, v58
    v_perm_b32 v59, v206, v204, s53
    v_accvgpr_write_b32 a155, v59
    v_perm_b32 v60, v210, v208, s53
    v_accvgpr_write_b32 a156, v60
    v_perm_b32 v61, v214, v212, s53
    v_accvgpr_write_b32 a157, v61
    v_perm_b32 v62, v218, v216, s53
    v_accvgpr_write_b32 a158, v62
    v_perm_b32 v63, v222, v220, s53
    v_accvgpr_write_b32 a159, v63
    v_perm_b32 v48, v195, v193, s52
    v_accvgpr_write_b32 a160, v48
    v_perm_b32 v49, v199, v197, s52
    v_accvgpr_write_b32 a161, v49
    v_perm_b32 v50, v203, v201, s52
    v_accvgpr_write_b32 a162, v50
    v_perm_b32 v51, v207, v205, s52
    v_accvgpr_write_b32 a163, v51
    v_perm_b32 v52, v211, v209, s52
    v_accvgpr_write_b32 a164, v52
    v_perm_b32 v53, v215, v213, s52
    v_accvgpr_write_b32 a165, v53
    v_perm_b32 v54, v219, v217, s52
    v_accvgpr_write_b32 a166, v54
    v_perm_b32 v55, v223, v221, s52
    v_accvgpr_write_b32 a167, v55
    v_perm_b32 v56, v195, v193, s53
    v_perm_b32 v57, v199, v197, s53
    v_perm_b32 v58, v203, v201, s53
    v_perm_b32 v59, v207, v205, s53
    v_perm_b32 v60, v211, v209, s53
    v_perm_b32 v61, v215, v213, s53
    v_perm_b32 v62, v219, v217, s53
    v_perm_b32 v63, v223, v221, s53
    ds_write_b128 v9, v[56:59] offset:12288
    ds_write_b128 v9, v[60:63] offset:13312
    s_mov_b32 s54, 0
    buffer_load_dword v112, v15, s[24:27], s54 offen
    s_mov_b32 s54, 8192
    buffer_load_dword v120, v15, s[24:27], s54 offen
    s_mov_b32 s54, 65536
    buffer_load_dword v113, v15, s[24:27], s54 offen
    s_mov_b32 s54, 73728
    buffer_load_dword v121, v15, s[24:27], s54 offen
    s_mov_b32 s54, 16384
    buffer_load_dword v114, v15, s[24:27], s54 offen
    s_mov_b32 s54, 24576
    buffer_load_dword v122, v15, s[24:27], s54 offen
    s_mov_b32 s54, 81920
    buffer_load_dword v115, v15, s[24:27], s54 offen
    s_mov_b32 s54, 90112
    buffer_load_dword v123, v15, s[24:27], s54 offen
    s_mov_b32 s54, 262144
    buffer_load_dword v116, v15, s[24:27], s54 offen
    s_mov_b32 s54, 270336
    buffer_load_dword v124, v15, s[24:27], s54 offen
    s_mov_b32 s54, 327680
    buffer_load_dword v117, v15, s[24:27], s54 offen
    s_mov_b32 s54, 335872
    buffer_load_dword v125, v15, s[24:27], s54 offen
    s_mov_b32 s54, 278528
    buffer_load_dword v118, v15, s[24:27], s54 offen
    s_mov_b32 s54, 286720
    buffer_load_dword v126, v15, s[24:27], s54 offen
    s_mov_b32 s54, 344064
    buffer_load_dword v119, v15, s[24:27], s54 offen
    s_mov_b32 s54, 352256
    buffer_load_dword v127, v15, s[24:27], s54 offen
    s_waitcnt vmcnt(32)
    v_perm_b32 v48, v226, v224, s52
    v_accvgpr_write_b32 a168, v48
    v_perm_b32 v49, v230, v228, s52
    v_accvgpr_write_b32 a169, v49
    v_perm_b32 v50, v234, v232, s52
    v_accvgpr_write_b32 a170, v50
    v_perm_b32 v51, v238, v236, s52
    v_accvgpr_write_b32 a171, v51
    v_perm_b32 v52, v242, v240, s52
    v_accvgpr_write_b32 a172, v52
    v_perm_b32 v53, v246, v244, s52
    v_accvgpr_write_b32 a173, v53
    v_perm_b32 v54, v250, v248, s52
    v_accvgpr_write_b32 a174, v54
    v_perm_b32 v55, v254, v252, s52
    v_accvgpr_write_b32 a175, v55
    v_perm_b32 v56, v226, v224, s53
    v_accvgpr_write_b32 a176, v56
    v_perm_b32 v57, v230, v228, s53
    v_accvgpr_write_b32 a177, v57
    v_perm_b32 v58, v234, v232, s53
    v_accvgpr_write_b32 a178, v58
    v_perm_b32 v59, v238, v236, s53
    v_accvgpr_write_b32 a179, v59
    v_perm_b32 v60, v242, v240, s53
    v_accvgpr_write_b32 a180, v60
    v_perm_b32 v61, v246, v244, s53
    v_accvgpr_write_b32 a181, v61
    v_perm_b32 v62, v250, v248, s53
    v_accvgpr_write_b32 a182, v62
    v_perm_b32 v63, v254, v252, s53
    v_accvgpr_write_b32 a183, v63
    v_perm_b32 v48, v227, v225, s52
    v_accvgpr_write_b32 a184, v48
    v_perm_b32 v49, v231, v229, s52
    v_accvgpr_write_b32 a185, v49
    v_perm_b32 v50, v235, v233, s52
    v_accvgpr_write_b32 a186, v50
    v_perm_b32 v51, v239, v237, s52
    v_accvgpr_write_b32 a187, v51
    v_perm_b32 v52, v243, v241, s52
    v_accvgpr_write_b32 a188, v52
    v_perm_b32 v53, v247, v245, s52
    v_accvgpr_write_b32 a189, v53
    v_perm_b32 v54, v251, v249, s52
    v_accvgpr_write_b32 a190, v54
    v_perm_b32 v55, v255, v253, s52
    v_accvgpr_write_b32 a191, v55
    v_perm_b32 v56, v227, v225, s53
    v_perm_b32 v57, v231, v229, s53
    v_perm_b32 v58, v235, v233, s53
    v_perm_b32 v59, v239, v237, s53
    v_perm_b32 v60, v243, v241, s53
    v_perm_b32 v61, v247, v245, s53
    v_perm_b32 v62, v251, v249, s53
    v_perm_b32 v63, v255, v253, s53
    ds_write_b128 v9, v[56:59] offset:14336
    ds_write_b128 v9, v[60:63] offset:15360
    s_mov_b32 s54, 1572864
    buffer_load_dword v160, v15, s[24:27], s54 offen
    s_mov_b32 s54, 1581056
    buffer_load_dword v168, v15, s[24:27], s54 offen
    s_mov_b32 s54, 1638400
    buffer_load_dword v161, v15, s[24:27], s54 offen
    s_mov_b32 s54, 1646592
    buffer_load_dword v169, v15, s[24:27], s54 offen
    s_mov_b32 s54, 1589248
    buffer_load_dword v162, v15, s[24:27], s54 offen
    s_mov_b32 s54, 1597440
    buffer_load_dword v170, v15, s[24:27], s54 offen
    s_mov_b32 s54, 1654784
    buffer_load_dword v163, v15, s[24:27], s54 offen
    s_mov_b32 s54, 1662976
    buffer_load_dword v171, v15, s[24:27], s54 offen
    s_mov_b32 s54, 1835008
    buffer_load_dword v164, v15, s[24:27], s54 offen
    s_mov_b32 s54, 1843200
    buffer_load_dword v172, v15, s[24:27], s54 offen
    s_mov_b32 s54, 1900544
    buffer_load_dword v165, v15, s[24:27], s54 offen
    s_mov_b32 s54, 1908736
    buffer_load_dword v173, v15, s[24:27], s54 offen
    s_mov_b32 s54, 1851392
    buffer_load_dword v166, v15, s[24:27], s54 offen
    s_mov_b32 s54, 1859584
    buffer_load_dword v174, v15, s[24:27], s54 offen
    s_mov_b32 s54, 1916928
    buffer_load_dword v167, v15, s[24:27], s54 offen
    s_mov_b32 s54, 1925120
    buffer_load_dword v175, v15, s[24:27], s54 offen
    buffer_load_dword v72, off, s[12:15], 0 offset:8 sc1
    buffer_load_dword v73, off, s[12:15], 0 offset:64 sc1
    s_waitcnt vmcnt(34)
    v_perm_b32 v48, v130, v128, s52
    v_accvgpr_write_b32 a192, v48
    v_perm_b32 v49, v134, v132, s52
    v_accvgpr_write_b32 a193, v49
    v_perm_b32 v50, v138, v136, s52
    v_accvgpr_write_b32 a194, v50
    v_perm_b32 v51, v142, v140, s52
    v_accvgpr_write_b32 a195, v51
    v_perm_b32 v52, v146, v144, s52
    v_accvgpr_write_b32 a196, v52
    v_perm_b32 v53, v150, v148, s52
    v_accvgpr_write_b32 a197, v53
    v_perm_b32 v54, v154, v152, s52
    v_accvgpr_write_b32 a198, v54
    v_perm_b32 v55, v158, v156, s52
    v_accvgpr_write_b32 a199, v55
    v_perm_b32 v56, v130, v128, s53
    v_accvgpr_write_b32 a200, v56
    v_perm_b32 v57, v134, v132, s53
    v_accvgpr_write_b32 a201, v57
    v_perm_b32 v58, v138, v136, s53
    v_accvgpr_write_b32 a202, v58
    v_perm_b32 v59, v142, v140, s53
    v_accvgpr_write_b32 a203, v59
    v_perm_b32 v60, v146, v144, s53
    v_accvgpr_write_b32 a204, v60
    v_perm_b32 v61, v150, v148, s53
    v_accvgpr_write_b32 a205, v61
    v_perm_b32 v62, v154, v152, s53
    v_accvgpr_write_b32 a206, v62
    v_perm_b32 v63, v158, v156, s53
    v_accvgpr_write_b32 a207, v63
    v_perm_b32 v48, v131, v129, s52
    v_accvgpr_write_b32 a208, v48
    v_perm_b32 v49, v135, v133, s52
    v_accvgpr_write_b32 a209, v49
    v_perm_b32 v50, v139, v137, s52
    v_accvgpr_write_b32 a210, v50
    v_perm_b32 v51, v143, v141, s52
    v_accvgpr_write_b32 a211, v51
    v_perm_b32 v52, v147, v145, s52
    v_accvgpr_write_b32 a212, v52
    v_perm_b32 v53, v151, v149, s52
    v_accvgpr_write_b32 a213, v53
    v_perm_b32 v54, v155, v153, s52
    v_accvgpr_write_b32 a214, v54
    v_perm_b32 v55, v159, v157, s52
    v_accvgpr_write_b32 a215, v55
    v_perm_b32 v56, v131, v129, s53
    v_perm_b32 v57, v135, v133, s53
    v_perm_b32 v58, v139, v137, s53
    v_perm_b32 v59, v143, v141, s53
    v_perm_b32 v60, v147, v145, s53
    v_perm_b32 v61, v151, v149, s53
    v_perm_b32 v62, v155, v153, s53
    v_perm_b32 v63, v159, v157, s53
    ds_write_b128 v9, v[56:59] offset:16384
    ds_write_b128 v9, v[60:63] offset:17408
    s_mov_b32 s54, 2097152
    buffer_load_dword v176, v15, s[24:27], s54 offen
    s_mov_b32 s54, 2105344
    buffer_load_dword v184, v15, s[24:27], s54 offen
    s_mov_b32 s54, 2162688
    buffer_load_dword v177, v15, s[24:27], s54 offen
    s_mov_b32 s54, 2170880
    buffer_load_dword v185, v15, s[24:27], s54 offen
    s_mov_b32 s54, 2113536
    buffer_load_dword v178, v15, s[24:27], s54 offen
    s_mov_b32 s54, 2121728
    buffer_load_dword v186, v15, s[24:27], s54 offen
    s_mov_b32 s54, 2179072
    buffer_load_dword v179, v15, s[24:27], s54 offen
    s_mov_b32 s54, 2187264
    buffer_load_dword v187, v15, s[24:27], s54 offen
    s_mov_b32 s54, 2359296
    buffer_load_dword v180, v15, s[24:27], s54 offen
    s_mov_b32 s54, 2367488
    buffer_load_dword v188, v15, s[24:27], s54 offen
    s_mov_b32 s54, 2424832
    buffer_load_dword v181, v15, s[24:27], s54 offen
    s_mov_b32 s54, 2433024
    buffer_load_dword v189, v15, s[24:27], s54 offen
    s_mov_b32 s54, 2375680
    buffer_load_dword v182, v15, s[24:27], s54 offen
    s_mov_b32 s54, 2383872
    buffer_load_dword v190, v15, s[24:27], s54 offen
    s_mov_b32 s54, 2441216
    buffer_load_dword v183, v15, s[24:27], s54 offen
    s_mov_b32 s54, 2449408
    buffer_load_dword v191, v15, s[24:27], s54 offen
    s_waitcnt vmcnt(34)
    v_perm_b32 v16, v120, v112, s52
    v_perm_b32 v120, v120, v112, s53
    v_mov_b32 v112, v16
    v_perm_b32 v17, v121, v113, s52
    v_perm_b32 v121, v121, v113, s53
    v_mov_b32 v113, v17
    v_perm_b32 v18, v122, v114, s52
    v_perm_b32 v122, v122, v114, s53
    v_mov_b32 v114, v18
    v_perm_b32 v19, v123, v115, s52
    v_perm_b32 v123, v123, v115, s53
    v_mov_b32 v115, v19
    v_perm_b32 v20, v124, v116, s52
    v_perm_b32 v124, v124, v116, s53
    v_mov_b32 v116, v20
    v_perm_b32 v21, v125, v117, s52
    v_perm_b32 v125, v125, v117, s53
    v_mov_b32 v117, v21
    v_perm_b32 v22, v126, v118, s52
    v_perm_b32 v126, v126, v118, s53
    v_mov_b32 v118, v22
    v_perm_b32 v23, v127, v119, s52
    v_perm_b32 v127, v127, v119, s53
    v_mov_b32 v119, v23
    s_mov_b32 s54, 2621440
    buffer_load_dword v192, v15, s[24:27], s54 offen
    s_mov_b32 s54, 2629632
    buffer_load_dword v200, v15, s[24:27], s54 offen
    s_mov_b32 s54, 2686976
    buffer_load_dword v193, v15, s[24:27], s54 offen
    s_mov_b32 s54, 2695168
    buffer_load_dword v201, v15, s[24:27], s54 offen
    s_mov_b32 s54, 2637824
    buffer_load_dword v194, v15, s[24:27], s54 offen
    s_mov_b32 s54, 2646016
    buffer_load_dword v202, v15, s[24:27], s54 offen
    s_mov_b32 s54, 2703360
    buffer_load_dword v195, v15, s[24:27], s54 offen
    s_mov_b32 s54, 2711552
    buffer_load_dword v203, v15, s[24:27], s54 offen
    s_mov_b32 s54, 2883584
    buffer_load_dword v196, v15, s[24:27], s54 offen
    s_mov_b32 s54, 2891776
    buffer_load_dword v204, v15, s[24:27], s54 offen
    s_mov_b32 s54, 2949120
    buffer_load_dword v197, v15, s[24:27], s54 offen
    s_mov_b32 s54, 2957312
    buffer_load_dword v205, v15, s[24:27], s54 offen
    s_mov_b32 s54, 2899968
    buffer_load_dword v198, v15, s[24:27], s54 offen
    s_mov_b32 s54, 2908160
    buffer_load_dword v206, v15, s[24:27], s54 offen
    s_mov_b32 s54, 2965504
    buffer_load_dword v199, v15, s[24:27], s54 offen
    s_mov_b32 s54, 2973696
    buffer_load_dword v207, v15, s[24:27], s54 offen
    s_waitcnt vmcnt(34)
    v_perm_b32 v16, v168, v160, s52
    v_perm_b32 v168, v168, v160, s53
    v_mov_b32 v160, v16
    v_perm_b32 v17, v169, v161, s52
    v_perm_b32 v169, v169, v161, s53
    v_mov_b32 v161, v17
    v_perm_b32 v18, v170, v162, s52
    v_perm_b32 v170, v170, v162, s53
    v_mov_b32 v162, v18
    v_perm_b32 v19, v171, v163, s52
    v_perm_b32 v171, v171, v163, s53
    v_mov_b32 v163, v19
    v_perm_b32 v20, v172, v164, s52
    v_perm_b32 v172, v172, v164, s53
    v_mov_b32 v164, v20
    v_perm_b32 v21, v173, v165, s52
    v_perm_b32 v173, v173, v165, s53
    v_mov_b32 v165, v21
    v_perm_b32 v22, v174, v166, s52
    v_perm_b32 v174, v174, v166, s53
    v_mov_b32 v166, v22
    v_perm_b32 v23, v175, v167, s52
    v_perm_b32 v175, v175, v167, s53
    v_mov_b32 v167, v23
    s_mov_b32 s54, 3145728
    buffer_load_dword v208, v15, s[24:27], s54 offen
    s_mov_b32 s54, 3153920
    buffer_load_dword v216, v15, s[24:27], s54 offen
    s_mov_b32 s54, 3211264
    buffer_load_dword v209, v15, s[24:27], s54 offen
    s_mov_b32 s54, 3219456
    buffer_load_dword v217, v15, s[24:27], s54 offen
    s_mov_b32 s54, 3162112
    buffer_load_dword v210, v15, s[24:27], s54 offen
    s_mov_b32 s54, 3170304
    buffer_load_dword v218, v15, s[24:27], s54 offen
    s_mov_b32 s54, 3227648
    buffer_load_dword v211, v15, s[24:27], s54 offen
    s_mov_b32 s54, 3235840
    buffer_load_dword v219, v15, s[24:27], s54 offen
    s_mov_b32 s54, 3407872
    buffer_load_dword v212, v15, s[24:27], s54 offen
    s_mov_b32 s54, 3416064
    buffer_load_dword v220, v15, s[24:27], s54 offen
    s_mov_b32 s54, 3473408
    buffer_load_dword v213, v15, s[24:27], s54 offen
    s_mov_b32 s54, 3481600
    buffer_load_dword v221, v15, s[24:27], s54 offen
    s_mov_b32 s54, 3424256
    buffer_load_dword v214, v15, s[24:27], s54 offen
    s_mov_b32 s54, 3432448
    buffer_load_dword v222, v15, s[24:27], s54 offen
    s_mov_b32 s54, 3489792
    buffer_load_dword v215, v15, s[24:27], s54 offen
    s_mov_b32 s54, 3497984
    buffer_load_dword v223, v15, s[24:27], s54 offen
    s_waitcnt vmcnt(48)
    v_readfirstlane_b32 s30, v72
    v_readfirstlane_b32 s93, v73
    s_waitcnt vmcnt(32)
    v_perm_b32 v16, v184, v176, s52
    v_perm_b32 v184, v184, v176, s53
    v_mov_b32 v176, v16
    v_perm_b32 v17, v185, v177, s52
    v_perm_b32 v185, v185, v177, s53
    v_mov_b32 v177, v17
    v_perm_b32 v18, v186, v178, s52
    v_perm_b32 v186, v186, v178, s53
    v_mov_b32 v178, v18
    v_perm_b32 v19, v187, v179, s52
    v_perm_b32 v187, v187, v179, s53
    v_mov_b32 v179, v19
    v_perm_b32 v20, v188, v180, s52
    v_perm_b32 v188, v188, v180, s53
    v_mov_b32 v180, v20
    v_perm_b32 v21, v189, v181, s52
    v_perm_b32 v189, v189, v181, s53
    v_mov_b32 v181, v21
    v_perm_b32 v22, v190, v182, s52
    v_perm_b32 v190, v190, v182, s53
    v_mov_b32 v182, v22
    v_perm_b32 v23, v191, v183, s52
    v_perm_b32 v191, v191, v183, s53
    v_mov_b32 v183, v23
    s_mov_b32 s54, 3670016
    buffer_load_dword v224, v15, s[24:27], s54 offen
    s_mov_b32 s54, 3678208
    buffer_load_dword v232, v15, s[24:27], s54 offen
    s_mov_b32 s54, 3735552
    buffer_load_dword v225, v15, s[24:27], s54 offen
    s_mov_b32 s54, 3743744
    buffer_load_dword v233, v15, s[24:27], s54 offen
    s_mov_b32 s54, 3686400
    buffer_load_dword v226, v15, s[24:27], s54 offen
    s_mov_b32 s54, 3694592
    buffer_load_dword v234, v15, s[24:27], s54 offen
    s_mov_b32 s54, 3751936
    buffer_load_dword v227, v15, s[24:27], s54 offen
    s_mov_b32 s54, 3760128
    buffer_load_dword v235, v15, s[24:27], s54 offen
    s_mov_b32 s54, 3932160
    buffer_load_dword v228, v15, s[24:27], s54 offen
    s_mov_b32 s54, 3940352
    buffer_load_dword v236, v15, s[24:27], s54 offen
    s_mov_b32 s54, 3997696
    buffer_load_dword v229, v15, s[24:27], s54 offen
    s_mov_b32 s54, 4005888
    buffer_load_dword v237, v15, s[24:27], s54 offen
    s_mov_b32 s54, 3948544
    buffer_load_dword v230, v15, s[24:27], s54 offen
    s_mov_b32 s54, 3956736
    buffer_load_dword v238, v15, s[24:27], s54 offen
    s_mov_b32 s54, 4014080
    buffer_load_dword v231, v15, s[24:27], s54 offen
    s_mov_b32 s54, 4022272
    buffer_load_dword v239, v15, s[24:27], s54 offen
    s_waitcnt vmcnt(32)
    v_perm_b32 v16, v200, v192, s52
    v_perm_b32 v200, v200, v192, s53
    v_mov_b32 v192, v16
    v_perm_b32 v17, v201, v193, s52
    v_perm_b32 v201, v201, v193, s53
    v_mov_b32 v193, v17
    v_perm_b32 v18, v202, v194, s52
    v_perm_b32 v202, v202, v194, s53
    v_mov_b32 v194, v18
    v_perm_b32 v19, v203, v195, s52
    v_perm_b32 v203, v203, v195, s53
    v_mov_b32 v195, v19
    v_perm_b32 v20, v204, v196, s52
    v_perm_b32 v204, v204, v196, s53
    v_mov_b32 v196, v20
    v_perm_b32 v21, v205, v197, s52
    v_perm_b32 v205, v205, v197, s53
    v_mov_b32 v197, v21
    v_perm_b32 v22, v206, v198, s52
    v_perm_b32 v206, v206, v198, s53
    v_mov_b32 v198, v22
    v_perm_b32 v23, v207, v199, s52
    v_perm_b32 v207, v207, v199, s53
    v_mov_b32 v199, v23
    s_mov_b32 s54, 4194304
    buffer_load_dword v240, v15, s[24:27], s54 offen
    s_mov_b32 s54, 4202496
    buffer_load_dword v248, v15, s[24:27], s54 offen
    s_mov_b32 s54, 4259840
    buffer_load_dword v241, v15, s[24:27], s54 offen
    s_mov_b32 s54, 4268032
    buffer_load_dword v249, v15, s[24:27], s54 offen
    s_mov_b32 s54, 4210688
    buffer_load_dword v242, v15, s[24:27], s54 offen
    s_mov_b32 s54, 4218880
    buffer_load_dword v250, v15, s[24:27], s54 offen
    s_mov_b32 s54, 4276224
    buffer_load_dword v243, v15, s[24:27], s54 offen
    s_mov_b32 s54, 4284416
    buffer_load_dword v251, v15, s[24:27], s54 offen
    s_mov_b32 s54, 4456448
    buffer_load_dword v244, v15, s[24:27], s54 offen
    s_mov_b32 s54, 4464640
    buffer_load_dword v252, v15, s[24:27], s54 offen
    s_mov_b32 s54, 4521984
    buffer_load_dword v245, v15, s[24:27], s54 offen
    s_mov_b32 s54, 4530176
    buffer_load_dword v253, v15, s[24:27], s54 offen
    s_mov_b32 s54, 4472832
    buffer_load_dword v246, v15, s[24:27], s54 offen
    s_mov_b32 s54, 4481024
    buffer_load_dword v254, v15, s[24:27], s54 offen
    s_mov_b32 s54, 4538368
    buffer_load_dword v247, v15, s[24:27], s54 offen
    s_mov_b32 s54, 4546560
    buffer_load_dword v255, v15, s[24:27], s54 offen
    s_waitcnt vmcnt(32)
    v_perm_b32 v16, v216, v208, s52
    v_perm_b32 v216, v216, v208, s53
    v_mov_b32 v208, v16
    v_perm_b32 v17, v217, v209, s52
    v_perm_b32 v217, v217, v209, s53
    v_mov_b32 v209, v17
    v_perm_b32 v18, v218, v210, s52
    v_perm_b32 v218, v218, v210, s53
    v_mov_b32 v210, v18
    v_perm_b32 v19, v219, v211, s52
    v_perm_b32 v219, v219, v211, s53
    v_mov_b32 v211, v19
    v_perm_b32 v20, v220, v212, s52
    v_perm_b32 v220, v220, v212, s53
    v_mov_b32 v212, v20
    v_perm_b32 v21, v221, v213, s52
    v_perm_b32 v221, v221, v213, s53
    v_mov_b32 v213, v21
    v_perm_b32 v22, v222, v214, s52
    v_perm_b32 v222, v222, v214, s53
    v_mov_b32 v214, v22
    v_perm_b32 v23, v223, v215, s52
    v_perm_b32 v223, v223, v215, s53
    v_mov_b32 v215, v23
    s_mov_b32 s54, 524288
    buffer_load_dword v128, v15, s[24:27], s54 offen
    s_mov_b32 s54, 532480
    buffer_load_dword v136, v15, s[24:27], s54 offen
    s_mov_b32 s54, 589824
    buffer_load_dword v129, v15, s[24:27], s54 offen
    s_mov_b32 s54, 598016
    buffer_load_dword v137, v15, s[24:27], s54 offen
    s_mov_b32 s54, 540672
    buffer_load_dword v130, v15, s[24:27], s54 offen
    s_mov_b32 s54, 548864
    buffer_load_dword v138, v15, s[24:27], s54 offen
    s_mov_b32 s54, 606208
    buffer_load_dword v131, v15, s[24:27], s54 offen
    s_mov_b32 s54, 614400
    buffer_load_dword v139, v15, s[24:27], s54 offen
    s_mov_b32 s54, 786432
    buffer_load_dword v132, v15, s[24:27], s54 offen
    s_mov_b32 s54, 794624
    buffer_load_dword v140, v15, s[24:27], s54 offen
    s_mov_b32 s54, 851968
    buffer_load_dword v133, v15, s[24:27], s54 offen
    s_mov_b32 s54, 860160
    buffer_load_dword v141, v15, s[24:27], s54 offen
    s_mov_b32 s54, 802816
    buffer_load_dword v134, v15, s[24:27], s54 offen
    s_mov_b32 s54, 811008
    buffer_load_dword v142, v15, s[24:27], s54 offen
    s_mov_b32 s54, 868352
    buffer_load_dword v135, v15, s[24:27], s54 offen
    s_mov_b32 s54, 876544
    buffer_load_dword v143, v15, s[24:27], s54 offen
    s_waitcnt vmcnt(32)
    v_perm_b32 v16, v232, v224, s52
    v_perm_b32 v232, v232, v224, s53
    v_mov_b32 v224, v16
    v_perm_b32 v17, v233, v225, s52
    v_perm_b32 v233, v233, v225, s53
    v_mov_b32 v225, v17
    v_perm_b32 v18, v234, v226, s52
    v_perm_b32 v234, v234, v226, s53
    v_mov_b32 v226, v18
    v_perm_b32 v19, v235, v227, s52
    v_perm_b32 v235, v235, v227, s53
    v_mov_b32 v227, v19
    v_perm_b32 v20, v236, v228, s52
    v_perm_b32 v236, v236, v228, s53
    v_mov_b32 v228, v20
    v_perm_b32 v21, v237, v229, s52
    v_perm_b32 v237, v237, v229, s53
    v_mov_b32 v229, v21
    v_perm_b32 v22, v238, v230, s52
    v_perm_b32 v238, v238, v230, s53
    v_mov_b32 v230, v22
    v_perm_b32 v23, v239, v231, s52
    v_perm_b32 v239, v239, v231, s53
    v_mov_b32 v231, v23
    s_mov_b32 s54, 1048576
    buffer_load_dword v144, v15, s[24:27], s54 offen
    s_mov_b32 s54, 1056768
    buffer_load_dword v152, v15, s[24:27], s54 offen
    s_mov_b32 s54, 1114112
    buffer_load_dword v145, v15, s[24:27], s54 offen
    s_mov_b32 s54, 1122304
    buffer_load_dword v153, v15, s[24:27], s54 offen
    s_mov_b32 s54, 1064960
    buffer_load_dword v146, v15, s[24:27], s54 offen
    s_mov_b32 s54, 1073152
    buffer_load_dword v154, v15, s[24:27], s54 offen
    s_mov_b32 s54, 1130496
    buffer_load_dword v147, v15, s[24:27], s54 offen
    s_mov_b32 s54, 1138688
    buffer_load_dword v155, v15, s[24:27], s54 offen
    s_mov_b32 s54, 1310720
    buffer_load_dword v148, v15, s[24:27], s54 offen
    s_mov_b32 s54, 1318912
    buffer_load_dword v156, v15, s[24:27], s54 offen
    s_mov_b32 s54, 1376256
    buffer_load_dword v149, v15, s[24:27], s54 offen
    s_mov_b32 s54, 1384448
    buffer_load_dword v157, v15, s[24:27], s54 offen
    s_mov_b32 s54, 1327104
    buffer_load_dword v150, v15, s[24:27], s54 offen
    s_mov_b32 s54, 1335296
    buffer_load_dword v158, v15, s[24:27], s54 offen
    s_mov_b32 s54, 1392640
    buffer_load_dword v151, v15, s[24:27], s54 offen
    s_mov_b32 s54, 1400832
    buffer_load_dword v159, v15, s[24:27], s54 offen
    buffer_load_dwordx2 v[72:73], off, s[8:11], s92 sc1
    s_waitcnt vmcnt(33)
    v_perm_b32 v16, v248, v240, s52
    v_perm_b32 v248, v248, v240, s53
    v_mov_b32 v240, v16
    v_perm_b32 v17, v249, v241, s52
    v_perm_b32 v249, v249, v241, s53
    v_mov_b32 v241, v17
    v_perm_b32 v18, v250, v242, s52
    v_perm_b32 v250, v250, v242, s53
    v_mov_b32 v242, v18
    v_perm_b32 v19, v251, v243, s52
    v_perm_b32 v251, v251, v243, s53
    v_mov_b32 v243, v19
    v_perm_b32 v20, v252, v244, s52
    v_perm_b32 v252, v252, v244, s53
    v_mov_b32 v244, v20
    v_perm_b32 v21, v253, v245, s52
    v_perm_b32 v253, v253, v245, s53
    v_mov_b32 v245, v21
    v_perm_b32 v22, v254, v246, s52
    v_perm_b32 v254, v254, v246, s53
    v_mov_b32 v246, v22
    v_perm_b32 v23, v255, v247, s52
    v_perm_b32 v255, v255, v247, s53
    v_mov_b32 v247, v23
    s_waitcnt vmcnt(17)
    v_perm_b32 v16, v136, v128, s52
    v_perm_b32 v136, v136, v128, s53
    v_mov_b32 v128, v16
    v_perm_b32 v17, v137, v129, s52
    v_perm_b32 v137, v137, v129, s53
    v_mov_b32 v129, v17
    v_perm_b32 v18, v138, v130, s52
    v_perm_b32 v138, v138, v130, s53
    v_mov_b32 v130, v18
    v_perm_b32 v19, v139, v131, s52
    v_perm_b32 v139, v139, v131, s53
    v_mov_b32 v131, v19
    v_perm_b32 v20, v140, v132, s52
    v_perm_b32 v140, v140, v132, s53
    v_mov_b32 v132, v20
    v_perm_b32 v21, v141, v133, s52
    v_perm_b32 v141, v141, v133, s53
    v_mov_b32 v133, v21
    v_perm_b32 v22, v142, v134, s52
    v_perm_b32 v142, v142, v134, s53
    v_mov_b32 v134, v22
    v_perm_b32 v23, v143, v135, s52
    v_perm_b32 v143, v143, v135, s53
    v_mov_b32 v135, v23
    s_waitcnt vmcnt(1)
    v_perm_b32 v16, v152, v144, s52
    v_perm_b32 v152, v152, v144, s53
    v_mov_b32 v144, v16
    v_perm_b32 v17, v153, v145, s52
    v_perm_b32 v153, v153, v145, s53
    v_mov_b32 v145, v17
    v_perm_b32 v18, v154, v146, s52
    v_perm_b32 v154, v154, v146, s53
    v_mov_b32 v146, v18
    v_perm_b32 v19, v155, v147, s52
    v_perm_b32 v155, v155, v147, s53
    v_mov_b32 v147, v19
    v_perm_b32 v20, v156, v148, s52
    v_perm_b32 v156, v156, v148, s53
    v_mov_b32 v148, v20
    v_perm_b32 v21, v157, v149, s52
    v_perm_b32 v157, v157, v149, s53
    v_mov_b32 v149, v21
    v_perm_b32 v22, v158, v150, s52
    v_perm_b32 v158, v158, v150, s53
    v_mov_b32 v150, v22
    v_perm_b32 v23, v159, v151, s52
    v_perm_b32 v159, v159, v151, s53
    v_mov_b32 v151, v23
    s_waitcnt vmcnt(0)
    v_readfirstlane_b32 s60, v72
    v_readfirstlane_b32 s57, v73
    s_lshl_b32 s60, s60, 1
    s_lshl_b32 s57, s57, 1
    s_add_u32 s57, s57, 1
    s_min_u32 s60, s60, s57
    s_cmp_ge_u32 s93, 128
    s_cselect_b32 s60, s60, 0
    s_cmp_lg_u32 s86, 0
    s_mov_b32 s29, 0x0
    s_cselect_b32 s29, 0x0, s29
    s_mov_b32 s85, 0x3e7
    s_cselect_b32 s85, 0x0, s85
    s_mov_b32 s34, 0x80000
    s_cselect_b32 s34, 0x50000, s34
    s_mov_b32 s35, 0x90000
    s_cselect_b32 s35, 0x60000, s35
    s_mov_b32 s36, 0xa0000
    s_cselect_b32 s36, 0x80000, s36
    s_mov_b32 s59, 0
    s_mov_b32 s33, 1
    s_add_u32 s31, s58, 32768
    s_mov_b32 s94, s39
    s_mov_b32 s95, s39
    s_add_u32 s101, s100, s34
    s_add_u32 s63, s101, 4096
    s_add_u32 s6, s101, 8192
    s_lshl_b32 s54, s29, 5
    s_add_u32 s54, s54, s28
    s_mul_i32 s37, s54, 24576
    s_add_u32 s37, s37, 0x1800000
    s_mul_i32 s38, s54, 4096
    s_add_u32 s38, s38, 0x800000
    s_and_b32 s54, s4, 1
    s_lshl_b32 s54, s54, 10
    s_add_u32 s62, s38, s54
    s_cmp_ge_u32 s4, 2
    s_cselect_b32 s62, s62, 0x20000000
    s_lshl_b32 s54, s4, 9
    s_add_u32 s38, s38, s54
    s_add_u32 s38, s38, 2048
    s_mov_b32 s54, s30
R_team_8:
    s_and_b32 s55, s54, 0xffff
    s_cmp_ge_u32 s55, 32
    s_cbranch_scc1 R_teamok_9
    buffer_load_dword v26, off, s[12:15], 0 offset:8 sc1
    s_waitcnt vmcnt(0)
    v_readfirstlane_b32 s54, v26
    s_sub_u32 s41, s41, 1
    s_cmp_gt_i32 s41, 0
    s_cbranch_scc1 R_team_8
R_teamok_9:
    s_mov_b32 s91, s29
    s_cmp_gt_u32 s60, s91
    s_cbranch_scc1 R_go_10
R_rdy_11:
    s_cmp_ge_u32 s93, 128
    s_cbranch_scc1 R_rdyok_12
    buffer_load_dword v26, off, s[12:15], 0 offset:64 sc1
    s_waitcnt vmcnt(0)
    v_readfirstlane_b32 s93, v26
    s_sub_u32 s41, s41, 1
    s_cmp_gt_i32 s41, 0
    s_cbranch_scc1 R_rdy_11
R_rdyok_12:
R_kv_13:
    v_lshrrev_b32 v26, 2, v1
    v_and_b32 v26, 4, v26
    buffer_load_dword v26, v26, s[8:11], s92 offen sc1
    s_waitcnt vmcnt(0)
    v_readlane_b32 s60, v26, 0
    v_readlane_b32 s57, v26, 1
    s_lshl_b32 s60, s60, 1
    s_lshl_b32 s57, s57, 1
    s_add_u32 s57, s57, 1
    s_min_u32 s60, s60, s57
    s_cmp_gt_u32 s60, s91
    s_cbranch_scc1 R_kvok_14
    s_sleep 1
    s_sub_u32 s41, s41, 1
    s_cmp_gt_i32 s41, 0
    s_cbranch_scc1 R_kv_13
R_kvok_14:
R_go_10:
    s_lshl_b32 s55, s4, 11
    s_add_u32 s97, s55, 147456
    s_mov_b32 m0, s97
    s_lshl_b32 s98, s4, 8
    s_add_u32 s98, s98, 162304
    s_lshl_b32 s99, s4, 4
    s_add_u32 s99, s99, 163328
    s_mov_b32 s88, 0x3f803f80
    s_mov_b32 s89, 0x3f803f80
    s_lshl_b32 s96, s4, 12
    s_add_u32 s96, s96, s37
    s_add_u32 s96, s96, 794624
    s_cmp_gt_u32 s60, 2
    s_cselect_b32 s93, s96, 0x20000000
    s_add_u32 s37, s37, s55
    s_add_u32 s37, s37, 16384
    s_sub_u32 s55, s37, 8192
    buffer_load_dwordx4 v1, s[8:11], s55 offen sc1 lds
    buffer_load_dwordx4 v1, s[8:11], s55 offen offset:1024 sc1 lds
    v_mov_b32 v26, s99
    v_mov_b64 v[28:29], 0
    ds_write_b64 v26, v[28:29]
    s_waitcnt vmcnt(0) lgkmcnt(0)
    s_mov_b32 m0, s98
    s_mov_b32 s87, 0x20000000
    s_lshr_b32 s54, s54, 16
    s_or_b32 s54, s54, s86
    s_cmp_lg_u32 s54, 0
    s_cbranch_scc1 R_loop_slow
.p2align 6
R_loop_fast:
    s_waitcnt vmcnt(0)
R_loop2_fast:
    s_barrier
    buffer_load_dwordx4 v[12:15], v1, s[8:11], s101 offen offset:0 sc1
    s_xor_b32 s33, s33, 1
    v_mov_b32 v10, s99
    ds_read_b64 v[10:11], v10
    ds_read_b128 v[72:75], v9 offset:0
    ds_read_b128 v[76:79], v9 offset:1024
    buffer_load_dwordx4 v[16:19], v1, s[8:11], s101 offen offset:1024 sc1
    ds_read_b128 v[64:67], v9 offset:4096
    ds_read_b128 v[68:71], v9 offset:5120
    v_mov_b64 v[48:49], 0
    v_mov_b64 v[50:51], 0
    v_mov_b64 v[52:53], 0
    buffer_load_dwordx4 v[20:23], v1, s[8:11], s101 offen offset:2048 sc1
    v_mov_b64 v[54:55], 0
    v_mov_b64 v[56:57], 0
    v_mov_b64 v[58:59], 0
    v_mov_b64 v[60:61], 0
    v_mov_b64 v[62:63], 0
    s_add_u32 s91, s29, 1
    s_min_u32 s91, s91, 63
    s_add_u32 s96, s96, 786432
    s_mov_b32 m0, s98
    buffer_load_dwordx4 v[24:27], v1, s[8:11], s101 offen offset:3072 sc1
    s_waitcnt lgkmcnt(0)
    v_readfirstlane_b32 s56, v10
    v_readfirstlane_b32 s57, v11
    s_lshl_b32 s56, s56, 1
    s_lshl_b32 s57, s57, 1
    s_add_u32 s57, s57, 1
    s_min_u32 s56, s56, s57
    s_max_u32 s60, s60, s56
    buffer_load_dwordx4 v[28:31], v1, s[8:11], s63 offen offset:0 sc1
    s_cmp_gt_u32 s60, s91
    s_cbranch_scc0 R_kvwait_fast
R_kvok_fast:
    s_add_u32 s57, s29, 2
    s_cmp_gt_u32 s60, s57
    s_cselect_b32 s93, s96, 0x20000000
    s_bitcmp0_b32 s4, 0
    s_cselect_b32 s93, s93, 0x20000000
    s_cmp_lt_u32 s4, 2
    buffer_load_dwordx4 v[32:35], v1, s[8:11], s63 offen offset:1024 sc1
    s_cselect_b32 s87, 0x20000000, s93
    s_cselect_b32 s93, s93, 0x20000000
    s_add_u32 s57, s29, 5
    s_min_u32 s57, s57, 63
    s_cmp_gt_u32 s60, s57
    s_cselect_b32 s61, 0x20000000, s92
    v_lshlrev_b32 v11, 3, v1
    v_add_u32 v10, 147456, v1
    buffer_load_dwordx4 v[36:39], v1, s[8:11], s63 offen offset:2048 sc1
R_mpoll_fast:
    s_waitcnt vmcnt(6)
    v_cmp_u_f32 vcc, v12, v14
    s_cbranch_vccnz R_retry0_fast
R_mok0_fast:
    v_smfmac_f32_16x16x64_bf16 v[48:51], v[12:15], a[0:7], v0
    s_waitcnt vmcnt(5)
    v_cmp_u_f32 vcc, v16, v18
    v_smfmac_f32_16x16x64_bf16 v[52:55], v[12:15], a[8:15], v0
    buffer_load_dwordx4 v[40:43], v1, s[8:11], s63 offen offset:3072 sc1
    v_smfmac_f32_16x16x64_bf16 v[56:59], v[12:15], a[16:23], v0
    s_cbranch_vccnz R_retry1_fast
R_mok1_fast:
    v_smfmac_f32_16x16x64_bf16 v[60:63], v[12:15], v[72:79], v0
R_post0_fast:
    ds_read_b128 v[72:75], v9 offset:8192
    ds_read_b128 v[76:79], v9 offset:9216
    v_smfmac_f32_16x16x64_bf16 v[48:51], v[16:19], a[48:55], v0
    s_waitcnt vmcnt(5)
    v_cmp_u_f32 vcc, v20, v22
    v_smfmac_f32_16x16x64_bf16 v[52:55], v[16:19], a[56:63], v0
    buffer_load_dwordx4 v[44:47], v1, s[8:11], s6 offen offset:0 sc1
    v_smfmac_f32_16x16x64_bf16 v[56:59], v[16:19], a[64:71], v0
    s_cbranch_vccnz R_retry2_fast
R_mok2_fast:
    v_smfmac_f32_16x16x64_bf16 v[60:63], v[16:19], v[64:71], v0
R_post1_fast:
    ds_read_b128 v[64:67], v9 offset:12288
    ds_read_b128 v[68:71], v9 offset:13312
    v_smfmac_f32_16x16x64_bf16 v[48:51], v[20:23], a[96:103], v0
    s_waitcnt vmcnt(5)
    v_cmp_u_f32 vcc, v24, v26
    v_smfmac_f32_16x16x64_bf16 v[52:55], v[20:23], a[104:111], v0
    s_waitcnt lgkmcnt(2)
    v_smfmac_f32_16x16x64_bf16 v[56:59], v[20:23], a[112:119], v0
    s_cbranch_vccnz R_retry3_fast
R_mok3_fast:
    v_smfmac_f32_16x16x64_bf16 v[60:63], v[20:23], v[72:79], v0
R_post2_fast:
    ds_read_b128 v[72:75], v9 offset:2048
    ds_read_b128 v[76:79], v9 offset:3072
    v_smfmac_f32_16x16x64_bf16 v[48:51], v[24:27], a[144:151], v0
    s_waitcnt vmcnt(4)
    v_cmp_u_f32 vcc, v28, v30
    v_smfmac_f32_16x16x64_bf16 v[52:55], v[24:27], a[152:159], v0
    s_waitcnt lgkmcnt(2)
    v_smfmac_f32_16x16x64_bf16 v[56:59], v[24:27], a[160:167], v0
    s_cbranch_vccnz R_retry4_fast
R_mok4_fast:
    v_smfmac_f32_16x16x64_bf16 v[60:63], v[24:27], v[64:71], v0
R_post3_fast:
    ds_read_b128 v[64:67], v9 offset:6144
    ds_read_b128 v[68:71], v9 offset:7168
    v_smfmac_f32_16x16x64_bf16 v[48:51], v[28:31], a[24:31], v0
    s_waitcnt vmcnt(3)
    v_cmp_u_f32 vcc, v32, v34
    v_smfmac_f32_16x16x64_bf16 v[52:55], v[28:31], a[32:39], v0
    s_waitcnt lgkmcnt(2)
    buffer_load_dword v11, s[8:11], s93 offen sc1 lds
    v_smfmac_f32_16x16x64_bf16 v[56:59], v[28:31], a[40:47], v0
    s_cbranch_vccnz R_retry5_fast
R_mok5_fast:
    v_smfmac_f32_16x16x64_bf16 v[60:63], v[28:31], v[72:79], v0
R_post4_fast:
    ds_read_b128 v[72:75], v9 offset:10240
    ds_read_b128 v[76:79], v9 offset:11264
    v_smfmac_f32_16x16x64_bf16 v[48:51], v[32:35], a[72:79], v0
    s_waitcnt vmcnt(3)
    v_cmp_u_f32 vcc, v36, v38
    v_smfmac_f32_16x16x64_bf16 v[52:55], v[32:35], a[80:87], v0
    s_waitcnt lgkmcnt(2)
    v_smfmac_f32_16x16x64_bf16 v[56:59], v[32:35], a[88:95], v0
    s_cbranch_vccnz R_retry6_fast
R_mok6_fast:
    v_smfmac_f32_16x16x64_bf16 v[60:63], v[32:35], v[64:71], v0
R_post5_fast:
    ds_read_b128 v[64:67], v9 offset:14336
    ds_read_b128 v[68:71], v9 offset:15360
    v_smfmac_f32_16x16x64_bf16 v[48:51], v[36:39], a[120:127], v0
    s_waitcnt vmcnt(2)
    v_cmp_u_f32 vcc, v40, v42
    v_smfmac_f32_16x16x64_bf16 v[52:55], v[36:39], a[128:135], v0
    s_waitcnt lgkmcnt(2)
    v_smfmac_f32_16x16x64_bf16 v[56:59], v[36:39], a[136:143], v0
    s_cbranch_vccnz R_retry7_fast
R_mok7_fast:
    v_smfmac_f32_16x16x64_bf16 v[60:63], v[36:39], v[72:79], v0
R_post6_fast:
    ds_read_b128 v[72:75], v9 offset:16384
    ds_read_b128 v[76:79], v9 offset:17408
    v_smfmac_f32_16x16x64_bf16 v[48:51], v[40:43], a[168:175], v0
    s_waitcnt vmcnt(1)
    v_cmp_u_f32 vcc, v44, v46
    v_smfmac_f32_16x16x64_bf16 v[52:55], v[40:43], a[176:183], v0
    s_waitcnt lgkmcnt(2)
    v_smfmac_f32_16x16x64_bf16 v[56:59], v[40:43], a[184:191], v0
    s_cbranch_vccnz R_retry8_fast
R_mok8_fast:
    v_smfmac_f32_16x16x64_bf16 v[60:63], v[40:43], v[64:71], v0
R_post7_fast:
    v_smfmac_f32_16x16x64_bf16 v[48:51], v[44:47], a[192:199], v0
    v_mov_b64 v[64:65], 0
    v_smfmac_f32_16x16x64_bf16 v[52:55], v[44:47], a[200:207], v0
    s_waitcnt lgkmcnt(0)
    v_mov_b64 v[66:67], 0
    v_smfmac_f32_16x16x64_bf16 v[56:59], v[44:47], a[208:215], v0
    v_mov_b64 v[68:69], 0
    v_smfmac_f32_16x16x64_bf16 v[60:63], v[44:47], v[72:79], v0
R_post8_fast:
    v_mov_b64 v[70:71], 0
    v_smfmac_f32_16x16x64_bf16 v[64:67], v[12:15], v[112:119], v0
    buffer_load_dwordx4 v[72:75], v1, s[8:11], s37 offen sc1
    v_add_f32 v48, v48, v49
    v_smfmac_f32_16x16x64_bf16 v[68:71], v[12:15], v[120:127], v0
    buffer_load_dwordx4 v[76:79], v1, s[8:11], s37 offen offset:1024 sc1
    v_add_f32 v49, v50, v51
    v_smfmac_f32_16x16x64_bf16 v[64:67], v[16:19], v[144:151], v0
    v_add_f32 v52, v52, v53
    v_add_f32 v53, v54, v55
    v_smfmac_f32_16x16x64_bf16 v[68:71], v[16:19], v[152:159], v0
    v_add_f32 v56, v56, v57
    v_add_f32 v57, v58, v59
    v_smfmac_f32_16x16x64_bf16 v[64:67], v[20:23], v[176:183], v0
    v_add_f32 v60, v60, v61
    v_add_f32 v61, v62, v63
    v_smfmac_f32_16x16x64_bf16 v[68:71], v[20:23], v[184:191], v0
    v_cvt_pk_bf16_f32 v12, v48, v52
    v_cvt_pk_bf16_f32 v14, v49, v53
    v_smfmac_f32_16x16x64_bf16 v[64:67], v[24:27], v[208:215], v0
    v_cvt_pk_bf16_f32 v13, v56, v60
    v_cvt_pk_bf16_f32 v15, v57, v61
    v_smfmac_f32_16x16x64_bf16 v[68:71], v[24:27], v[216:223], v0
    ds_write2_b64 v5, v[12:13], v[14:15] offset0:0 offset1:34
    v_smfmac_f32_16x16x64_bf16 v[64:67], v[28:31], v[128:135], v0
    ds_read_b128 v[48:51], v10 offset:0
    ds_read_b128 v[52:55], v10 offset:1024
    v_smfmac_f32_16x16x64_bf16 v[68:71], v[28:31], v[136:143], v0
    ds_read_b128 v[56:59], v10 offset:2048
    ds_read_b128 v[60:63], v10 offset:3072
    v_smfmac_f32_16x16x64_bf16 v[64:67], v[32:35], v[160:167], v0
    buffer_store_dwordx4 v[12:15], v1, s[8:11], s62 offen sc1
    v_smfmac_f32_16x16x64_bf16 v[68:71], v[32:35], v[168:175], v0
    s_waitcnt lgkmcnt(4)
    s_barrier
    ds_read_b128 v[12:15], v6
    v_smfmac_f32_16x16x64_bf16 v[64:67], v[36:39], v[192:199], v0
    ds_read_b128 v[16:19], v6 offset:64
    ds_read_b128 v[20:23], v6 offset:128
    v_smfmac_f32_16x16x64_bf16 v[68:71], v[36:39], v[200:207], v0
    ds_read_b128 v[24:27], v6 offset:192
    ds_read_b128 v[28:31], v10 offset:4096
    v_smfmac_f32_16x16x64_bf16 v[64:67], v[40:43], v[224:231], v0
    ds_read_b128 v[32:35], v10 offset:5120
    buffer_load_dword v11, s[8:11], s87 offen sc1 lds
    v_smfmac_f32_16x16x64_bf16 v[68:71], v[40:43], v[232:239], v0
    v_smfmac_f32_16x16x64_bf16 v[64:67], v[44:47], v[240:247], v0
    s_mov_b32 m0, s99
    s_add_u32 s37, s37, 786432
    v_smfmac_f32_16x16x64_bf16 v[68:71], v[44:47], v[248:255], v0
    s_sub_u32 s55, s37, 8192
    s_waitcnt lgkmcnt(5)
    v_mfma_f32_16x16x32_bf16 v[36:39], v[48:51], v[12:15], 0
    ds_read_b128 v[48:51], v10 offset:6144
    v_mfma_f32_16x16x32_bf16 v[40:43], v[52:55], v[12:15], 0
    ds_read_b128 v[52:55], v10 offset:7168
    v_mfma_f32_16x16x32_bf16 v[44:47], v[12:15], v[12:15], 0
    s_cmp_eq_u32 s29, 63
    s_waitcnt lgkmcnt(6)
    v_mfma_f32_16x16x32_bf16 v[36:39], v[56:59], v[16:19], v[36:39]
    v_mfma_f32_16x16x32_bf16 v[40:43], v[60:63], v[16:19], v[40:43]
    s_mov_b64 exec, 1
    buffer_load_dwordx4 off, s[8:11], s61 sc1 lds
    s_mov_b64 exec, -1
    v_mfma_f32_16x16x32_bf16 v[44:47], v[16:19], v[16:19], v[44:47]
    v_add_f32 v64, v64, v65
    v_add_f32 v65, v66, v67
    s_waitcnt lgkmcnt(2)
    v_mfma_f32_16x16x32_bf16 v[36:39], v[28:31], v[20:23], v[36:39]
    v_add_f32 v68, v68, v69
    v_add_f32 v69, v70, v71
    v_mfma_f32_16x16x32_bf16 v[40:43], v[32:35], v[20:23], v[40:43]
    v_cvt_pk_bf16_f32 v10, v64, v65
    v_cvt_pk_bf16_f32 v11, v68, v69
    v_mfma_f32_16x16x32_bf16 v[44:47], v[20:23], v[20:23], v[44:47]
    ds_read_b128 v[12:15], v9 offset:18432
    ds_read_b128 v[16:19], v9 offset:19456
    s_waitcnt lgkmcnt(2)
    v_mfma_f32_16x16x32_bf16 v[36:39], v[48:51], v[24:27], v[36:39]
    v_lshrrev_b32 v71, 1, v1
    v_mov_b64 v[34:35], 0
    v_mfma_f32_16x16x32_bf16 v[40:43], v[52:55], v[24:27], v[40:43]
    buffer_store_dwordx2 v[10:11], v71, s[8:11], s38 offen sc1
    v_mfma_f32_16x16x32_bf16 v[44:47], v[24:27], v[24:27], v[44:47]
    ds_read_b128 v[20:23], v9 offset:22528
    ds_read_b128 v[24:27], v9 offset:23552
    s_mov_b32 m0, s97
    s_cbranch_scc1 R_done_fast
    v_max3_f32 v68, v36, v37, v38
    s_nop 0
    v_max3_f32 v69, v39, v40, v41
    v_max3_f32 v68, v68, v42, v43
    v_mov_b32 v33, 0
    v_max3_f32 v69, v69, v44, v45
    v_max_f32 v46, v68, v69
    v_max_f32 v47, v68, v69
    v_mov_b64 v[64:65], s[88:89]
    v_mov_b64 v[66:67], s[88:89]
    v_permlane16_swap_b32 v46, v47
    v_max_f32 v68, v46, v47
    v_max_f32 v69, v46, v47
    s_mov_b32 s54, s34
    s_mov_b32 s34, s35
    v_permlane32_swap_b32 v68, v69
    v_max_f32 v46, v68, v69
    v_mul_f32 v46, s39, v46
    v_pk_fma_f32 v[44:45], v[44:45], s[94:95], v[46:47] op_sel_hi:[1,1,0] neg_lo:[0,0,1] neg_hi:[0,0,1]
    v_pk_fma_f32 v[36:37], v[36:37], s[94:95], v[46:47] op_sel_hi:[1,1,0] neg_lo:[0,0,1] neg_hi:[0,0,1]
    v_pk_fma_f32 v[38:39], v[38:39], s[94:95], v[46:47] op_sel_hi:[1,1,0] neg_lo:[0,0,1] neg_hi:[0,0,1]
    v_pk_fma_f32 v[40:41], v[40:41], s[94:95], v[46:47] op_sel_hi:[1,1,0] neg_lo:[0,0,1] neg_hi:[0,0,1]
    v_pk_fma_f32 v[42:43], v[42:43], s[94:95], v[46:47] op_sel_hi:[1,1,0] neg_lo:[0,0,1] neg_hi:[0,0,1]
    v_exp_f32 v44, v44
    v_exp_f32 v45, v45
    v_exp_f32 v36, v36
    v_cvt_pk_bf16_f32 v32, v44, v45
    v_cvt_pk_bf16_f32 v35, v44, v45
    v_exp_f32 v37, v37
    v_mfma_f32_16x16x16_bf16 v[68:71], v[64:65], v[32:33], 0
    v_exp_f32 v38, v38
    v_mfma_f32_16x16x16_bf16 v[56:59], v[10:11], v[32:33], 0
    v_exp_f32 v39, v39
    v_mfma_f32_16x16x16_bf16 v[60:63], v[10:11], v[34:35], 0
    v_exp_f32 v40, v40
    v_exp_f32 v41, v41
    v_exp_f32 v42, v42
    v_exp_f32 v43, v43
    v_cvt_pk_bf16_f32 v28, v36, v37
    v_cvt_pk_bf16_f32 v29, v38, v39
    v_cvt_pk_bf16_f32 v30, v40, v41
    v_cvt_pk_bf16_f32 v31, v42, v43
    s_waitcnt vmcnt(4)
    v_mov_b64 v[36:37], 0
    v_mfma_f32_16x16x32_bf16 v[68:71], v[64:67], v[28:31], v[68:71]
    v_mov_b64 v[38:39], 0
    v_mov_b64 v[40:41], 0
    v_mfma_f32_16x16x32_bf16 v[56:59], v[72:75], v[28:31], v[56:59]
    v_mov_b64 v[42:43], 0
    v_mov_b64 v[44:45], 0
    v_mfma_f32_16x16x32_bf16 v[60:63], v[76:79], v[28:31], v[60:63]
    ds_read_b128 v[48:51], v9 offset:34816
    ds_read_b128 v[52:55], v9 offset:35840
    v_rcp_f32 v68, v68
    v_mov_b64 v[46:47], 0
    v_mov_b64 v[32:33], 0
    s_mov_b64 exec, s[42:43]
    v_pk_mul_f32 v[56:57], v[56:57], v[68:69] op_sel_hi:[1,0]
    v_pk_mul_f32 v[58:59], v[58:59], v[68:69] op_sel_hi:[1,0]
    v_pk_mul_f32 v[60:61], v[60:61], v[68:69] op_sel_hi:[1,0]
    v_pk_mul_f32 v[62:63], v[62:63], v[68:69] op_sel_hi:[1,0]
    v_cvt_pk_bf16_f32 v28, v56, v60
    v_cvt_pk_bf16_f32 v29, v57, v61
    v_cvt_pk_bf16_f32 v30, v58, v62
    v_cvt_pk_bf16_f32 v31, v59, v63
    ds_write_b128 v7, v[28:31]
    s_mov_b64 exec, -1
    v_mov_b64 v[34:35], 0
    v_and_b32 v11, 16, v1
    v_lshl_add_u32 v11, v11, 2, v8
    s_add_u32 s38, s38, 131072
    s_add_u32 s62, s62, 131072
    s_add_u32 s29, s29, 1
    s_mov_b32 s35, s36
    s_mov_b32 s36, s54
    s_add_u32 s101, s34, s100
    s_add_u32 s63, s101, 4096
    s_add_u32 s6, s101, 8192
    s_waitcnt lgkmcnt(0)
    s_barrier
    ds_read_b128 v[72:75], v8 offset:0
    ds_read_b128 v[64:67], v11 offset:0
    ds_read_b128 v[76:79], v8 offset:64
    ds_read_b128 v[68:71], v11 offset:128
    ds_read_b128 v[60:63], v8 offset:192
    ds_read_b128 v[56:59], v8 offset:128
    buffer_load_dwordx4 v1, s[8:11], s55 offen sc1 lds
    buffer_load_dwordx4 v1, s[8:11], s55 offen offset:1024 sc1 lds
    v_mov_b64 v[28:29], 0
    v_mov_b64 v[30:31], 0
    s_waitcnt lgkmcnt(5)
    v_smfmac_f32_16x16x64_bf16 v[40:43], v[72:75], v[12:19], v0
    ds_read_b128 v[12:15], v9 offset:24576
    ds_read_b128 v[16:19], v9 offset:25600
    v_smfmac_f32_16x16x64_bf16 v[32:35], v[72:75], v[20:27], v0
    s_waitcnt lgkmcnt(6)
    ds_read_b128 v[20:23], v9 offset:20480
    ds_read_b128 v[24:27], v9 offset:21504
    v_smfmac_f32_16x16x64_bf16 v[36:39], v[64:67], v[48:55], v0
    s_waitcnt lgkmcnt(7)
    ds_read_b128 v[48:51], v9 offset:26624
    v_smfmac_f32_16x16x64_bf16 v[40:43], v[76:79], a[216:223], v0
    s_waitcnt lgkmcnt(7)
    ds_read_b128 v[52:55], v9 offset:27648
    v_smfmac_f32_16x16x64_bf16 v[36:39], v[68:71], v[104:111], v0
    ds_read_b128 v[64:67], v9 offset:30720
    v_smfmac_f32_16x16x64_bf16 v[32:35], v[76:79], a[232:239], v0
    s_waitcnt lgkmcnt(8)
    ds_read_b128 v[68:71], v9 offset:31744
    v_smfmac_f32_16x16x64_bf16 v[40:43], v[60:63], a[224:231], v0
    s_waitcnt lgkmcnt(8)
    s_waitcnt lgkmcnt(6)
    v_smfmac_f32_16x16x64_bf16 v[32:35], v[56:59], v[12:19], v0
    s_waitcnt lgkmcnt(4)
    ds_read_b128 v[12:15], v9 offset:28672
    v_add_f32 v36, v36, v37
    v_smfmac_f32_16x16x64_bf16 v[40:43], v[56:59], v[20:27], v0
    ds_read_b128 v[16:19], v9 offset:29696
    v_add_f32 v37, v38, v39
    v_smfmac_f32_16x16x64_bf16 v[32:35], v[60:63], a[240:247], v0
    s_waitcnt lgkmcnt(4)
    ds_read_b128 v[20:23], v9 offset:32768
    v_cvt_pk_bf16_f32 v10, v36, v37
    v_smfmac_f32_16x16x64_bf16 v[44:47], v[72:75], v[48:55], v0
    ds_read_b128 v[24:27], v9 offset:33792
    v_bfi_b32 v10, 1, s33, v10
    v_smfmac_f32_16x16x64_bf16 v[28:31], v[76:79], v[88:95], v0
    buffer_store_dword v10, v3, s[8:11], s58 offen
    v_cvt_pk_bf16_f32 v36, v40, v41
    v_smfmac_f32_16x16x64_bf16 v[44:47], v[76:79], a[248:255], v0
    s_waitcnt lgkmcnt(4)
    v_cvt_pk_bf16_f32 v38, v42, v43
    v_smfmac_f32_16x16x64_bf16 v[28:31], v[72:75], v[64:71], v0
    s_waitcnt lgkmcnt(2)
    v_bfi_b32 v36, 1, s33, v36
    v_smfmac_f32_16x16x64_bf16 v[44:47], v[56:59], v[12:19], v0
    v_cvt_pk_bf16_f32 v37, v32, v33
    v_smfmac_f32_16x16x64_bf16 v[28:31], v[60:63], v[96:103], v0
    v_cvt_pk_bf16_f32 v39, v34, v35
    v_smfmac_f32_16x16x64_bf16 v[44:47], v[60:63], v[80:87], v0
    s_waitcnt lgkmcnt(0)
    buffer_store_dwordx4 v[36:39], v2, s[8:11], s58 offen
    v_smfmac_f32_16x16x64_bf16 v[28:31], v[56:59], v[20:27], v0
    s_nop 4
    v_cvt_pk_bf16_f32 v40, v44, v45
    v_cvt_pk_bf16_f32 v42, v46, v47
    v_bfi_b32 v40, 1, s33, v40
    v_cvt_pk_bf16_f32 v41, v28, v29
    v_cvt_pk_bf16_f32 v43, v30, v31
    buffer_store_dwordx4 v[40:43], v2, s[8:11], s31 offen
    s_cmp_ge_u32 s40, 72
    s_cbranch_scc1 R_nored_fast
    v_bfe_u32 v56, v1, s90, 1
    v_lshlrev_b32 v56, 4, v56
    v_mov_b32 v57, 0x3f80
    v_lshlrev_b32 v56, v56, v57
    v_cndmask_b32 v48, 0, v56, s[44:45]
    v_cndmask_b32 v49, 0, v56, s[46:47]
    v_cndmask_b32 v50, 0, v56, s[48:49]
    v_cndmask_b32 v51, 0, v56, s[50:51]
    v_mov_b64 v[10:11], -1
    s_waitcnt vmcnt(2)
    buffer_load_dwordx4 v[12:15], v1, s[8:11], s32 offen offset:0 sc1
    buffer_load_dwordx4 v[16:19], v1, s[8:11], s32 offen offset:1024 sc1
    buffer_load_dwordx4 v[20:23], v1, s[8:11], s32 offen offset:2048 sc1
    buffer_load_dwordx4 v[24:27], v1, s[8:11], s32 offen offset:3072 sc1
    s_waitcnt vmcnt(4)
    buffer_load_dwordx4 v[28:31], v1, s[8:11], s32 offen offset:0 sc1
    buffer_load_dwordx4 v[32:35], v1, s[8:11], s32 offen offset:1024 sc1
    buffer_load_dwordx4 v[36:39], v1, s[8:11], s32 offen offset:2048 sc1
    buffer_load_dwordx4 v[40:43], v1, s[8:11], s32 offen offset:3072 sc1
R_rpoll_fast:
    s_waitcnt vmcnt(7)
    v_mfma_f32_16x16x32_bf16 v[52:55], v[48:51], v[12:15], 0
    s_waitcnt vmcnt(6)
    v_mfma_f32_16x16x32_bf16 v[52:55], v[48:51], v[16:19], v[52:55]
    v_bitop3_b32 v56, v12, v16, s33 bitop3:0x7e
    s_waitcnt vmcnt(5)
    v_mfma_f32_16x16x32_bf16 v[52:55], v[48:51], v[20:23], v[52:55]
    s_waitcnt vmcnt(4)
    v_mfma_f32_16x16x32_bf16 v[52:55], v[48:51], v[24:27], v[52:55]
    v_bitop3_b32 v57, v20, v24, s33 bitop3:0x7e
    v_bitop3_b32 v56, v56, v57, 1 bitop3:0xa8
    v_cmp_ne_u32 vcc, 0, v56
    s_cbranch_vccz R_rok_fast
    buffer_load_dwordx4 v[12:15], v1, s[8:11], s32 offen offset:0 sc1
    buffer_load_dwordx4 v[16:19], v1, s[8:11], s32 offen offset:1024 sc1
    buffer_load_dwordx4 v[20:23], v1, s[8:11], s32 offen offset:2048 sc1
    buffer_load_dwordx4 v[24:27], v1, s[8:11], s32 offen offset:3072 sc1
    s_waitcnt vmcnt(7)
    v_mfma_f32_16x16x32_bf16 v[52:55], v[48:51], v[28:31], 0
    s_waitcnt vmcnt(6)
    v_mfma_f32_16x16x32_bf16 v[52:55], v[48:51], v[32:35], v[52:55]
    v_bitop3_b32 v56, v28, v32, s33 bitop3:0x7e
    s_waitcnt vmcnt(5)
    v_mfma_f32_16x16x32_bf16 v[52:55], v[48:51], v[36:39], v[52:55]
    s_waitcnt vmcnt(4)
    v_mfma_f32_16x16x32_bf16 v[52:55], v[48:51], v[40:43], v[52:55]
    v_bitop3_b32 v57, v36, v40, s33 bitop3:0x7e
    v_bitop3_b32 v56, v56, v57, 1 bitop3:0xa8
    v_cmp_ne_u32 vcc, 0, v56
    s_cbranch_vccnz R_rretry_fast
R_rok_fast:
    s_nop 3
    v_add_f32_dpp v56, v52, v52 row_ror:8 row_mask:0xf bank_mask:0xf
    v_add_f32_dpp v57, v53, v53 row_ror:8 row_mask:0xf bank_mask:0xf
    v_add_f32_dpp v58, v54, v54 row_ror:8 row_mask:0xf bank_mask:0xf
    v_add_f32_dpp v59, v55, v55 row_ror:8 row_mask:0xf bank_mask:0xf
    v_cvt_pk_bf16_f32 v44, v56, v57
    v_cvt_pk_bf16_f32 v45, v58, v59
    buffer_store_dwordx2 v[44:45], v4, s[8:11], s34 offen
    buffer_store_dwordx2 v[10:11], v4, s[8:11], s36 offen
R_nored_fast:
R_red_done_fast:
    s_branch R_loop_fast
R_retry0_fast:
    s_sub_u32 s41, s41, 1
    s_cmp_gt_i32 s41, 0
    s_cbranch_scc0 R_mok0_fast
    buffer_load_dwordx4 v[12:15], v1, s[8:11], s101 offen offset:0 sc1
    s_waitcnt vmcnt(0)
    s_branch R_mpoll_fast
R_retry1_fast:
    s_sub_u32 s41, s41, 1
    s_cmp_gt_i32 s41, 0
    s_cbranch_scc0 R_mok1_fast
    buffer_load_dwordx4 v[16:19], v1, s[8:11], s101 offen offset:1024 sc1
    s_waitcnt vmcnt(0)
    v_cmp_u_f32 vcc, v16, v18
    s_cbranch_vccnz R_retry1_fast
    s_branch R_mok1_fast
R_retry2_fast:
    s_sub_u32 s41, s41, 1
    s_cmp_gt_i32 s41, 0
    s_cbranch_scc0 R_mok2_fast
    buffer_load_dwordx4 v[20:23], v1, s[8:11], s101 offen offset:2048 sc1
    s_waitcnt vmcnt(0)
    v_cmp_u_f32 vcc, v20, v22
    s_cbranch_vccnz R_retry2_fast
    s_branch R_mok2_fast
R_retry3_fast:
    s_sub_u32 s41, s41, 1
    s_cmp_gt_i32 s41, 0
    s_cbranch_scc0 R_mok3_fast
    buffer_load_dwordx4 v[24:27], v1, s[8:11], s101 offen offset:3072 sc1
    s_waitcnt vmcnt(0)
    v_cmp_u_f32 vcc, v24, v26
    s_cbranch_vccnz R_retry3_fast
    s_branch R_mok3_fast
R_retry4_fast:
    s_sub_u32 s41, s41, 1
    s_cmp_gt_i32 s41, 0
    s_cbranch_scc0 R_mok4_fast
    buffer_load_dwordx4 v[28:31], v1, s[8:11], s63 offen offset:0 sc1
    s_waitcnt vmcnt(0)
    v_cmp_u_f32 vcc, v28, v30
    s_cbranch_vccnz R_retry4_fast
    s_branch R_mok4_fast
R_retry5_fast:
    s_sub_u32 s41, s41, 1
    s_cmp_gt_i32 s41, 0
    s_cbranch_scc0 R_mok5_fast
    buffer_load_dwordx4 v[32:35], v1, s[8:11], s63 offen offset:1024 sc1
    s_waitcnt vmcnt(0)
    v_cmp_u_f32 vcc, v32, v34
    s_cbranch_vccnz R_retry5_fast
    s_branch R_mok5_fast
R_retry6_fast:
    s_sub_u32 s41, s41, 1
    s_cmp_gt_i32 s41, 0
    s_cbranch_scc0 R_mok6_fast
    buffer_load_dwordx4 v[36:39], v1, s[8:11], s63 offen offset:2048 sc1
    s_waitcnt vmcnt(0)
    v_cmp_u_f32 vcc, v36, v38
    s_cbranch_vccnz R_retry6_fast
    s_branch R_mok6_fast
R_retry7_fast:
    s_sub_u32 s41, s41, 1
    s_cmp_gt_i32 s41, 0
    s_cbranch_scc0 R_mok7_fast
    buffer_load_dwordx4 v[40:43], v1, s[8:11], s63 offen offset:3072 sc1
    s_waitcnt vmcnt(0)
    v_cmp_u_f32 vcc, v40, v42
    s_cbranch_vccnz R_retry7_fast
    s_branch R_mok7_fast
R_retry8_fast:
    s_sub_u32 s41, s41, 1
    s_cmp_gt_i32 s41, 0
    s_cbranch_scc0 R_mok8_fast
    buffer_load_dwordx4 v[44:47], v1, s[8:11], s6 offen offset:0 sc1
    s_waitcnt vmcnt(0)
    v_cmp_u_f32 vcc, v44, v46
    s_cbranch_vccnz R_retry8_fast
    s_branch R_mok8_fast
R_rretry_fast:
    s_sub_u32 s41, s41, 1
    s_cmp_gt_i32 s41, 0
    s_cbranch_scc0 R_rok_fast
    buffer_load_dwordx4 v[28:31], v1, s[8:11], s32 offen offset:0 sc1
    buffer_load_dwordx4 v[32:35], v1, s[8:11], s32 offen offset:1024 sc1
    buffer_load_dwordx4 v[36:39], v1, s[8:11], s32 offen offset:2048 sc1
    buffer_load_dwordx4 v[40:43], v1, s[8:11], s32 offen offset:3072 sc1
    s_branch R_rpoll_fast
R_kvwait_fast:
R_kv_15:
    v_lshrrev_b32 v11, 2, v1
    v_and_b32 v11, 4, v11
    buffer_load_dword v11, v11, s[8:11], s92 offen sc1
    s_waitcnt vmcnt(0)
    v_readlane_b32 s60, v11, 0
    v_readlane_b32 s57, v11, 1
    s_lshl_b32 s60, s60, 1
    s_lshl_b32 s57, s57, 1
    s_add_u32 s57, s57, 1
    s_min_u32 s60, s60, s57
    s_cmp_gt_u32 s60, s91
    s_cbranch_scc1 R_kvok_16
    s_sleep 1
    s_sub_u32 s41, s41, 1
    s_cmp_gt_i32 s41, 0
    s_cbranch_scc1 R_kv_15
R_kvok_16:
    s_branch R_kvok_fast
R_done_fast:
    s_mov_b64 exec, 1
    s_waitcnt vmcnt(0)
    s_endpgm
.p2align 6
R_loop_slow:
    s_waitcnt vmcnt(0)
R_loop2_slow:
    s_barrier
    buffer_load_dwordx4 v[12:15], v1, s[8:11], s101 offen offset:0 sc1
    s_xor_b32 s33, s33, 1
    v_mov_b32 v10, s99
    ds_read_b64 v[10:11], v10
    ds_read_b128 v[72:75], v9 offset:0
    ds_read_b128 v[76:79], v9 offset:1024
    buffer_load_dwordx4 v[16:19], v1, s[8:11], s101 offen offset:1024 sc1
    ds_read_b128 v[64:67], v9 offset:4096
    ds_read_b128 v[68:71], v9 offset:5120
    v_mov_b64 v[48:49], 0
    v_mov_b64 v[50:51], 0
    v_mov_b64 v[52:53], 0
    buffer_load_dwordx4 v[20:23], v1, s[8:11], s101 offen offset:2048 sc1
    v_mov_b64 v[54:55], 0
    v_mov_b64 v[56:57], 0
    v_mov_b64 v[58:59], 0
    v_mov_b64 v[60:61], 0
    v_mov_b64 v[62:63], 0
    s_add_u32 s91, s29, 1
    s_min_u32 s91, s91, 63
    s_add_u32 s96, s96, 786432
    s_mov_b32 m0, s98
    buffer_load_dwordx4 v[24:27], v1, s[8:11], s101 offen offset:3072 sc1
    s_waitcnt lgkmcnt(0)
    v_readfirstlane_b32 s56, v10
    v_readfirstlane_b32 s57, v11
    s_lshl_b32 s56, s56, 1
    s_lshl_b32 s57, s57, 1
    s_add_u32 s57, s57, 1
    s_min_u32 s56, s56, s57
    s_max_u32 s60, s60, s56
    buffer_load_dwordx4 v[28:31], v1, s[8:11], s63 offen offset:0 sc1
    s_cmp_gt_u32 s60, s91
    s_cbranch_scc0 R_kvwait_slow
R_kvok_slow:
    s_add_u32 s57, s29, 2
    s_cmp_gt_u32 s60, s57
    s_cselect_b32 s93, s96, 0x20000000
    s_bitcmp0_b32 s4, 0
    s_cselect_b32 s93, s93, 0x20000000
    s_cmp_lt_u32 s4, 2
    buffer_load_dwordx4 v[32:35], v1, s[8:11], s63 offen offset:1024 sc1
    s_cselect_b32 s87, 0x20000000, s93
    s_cselect_b32 s93, s93, 0x20000000
    s_add_u32 s57, s29, 5
    s_min_u32 s57, s57, 63
    s_cmp_gt_u32 s60, s57
    s_cselect_b32 s61, 0x20000000, s92
    v_lshlrev_b32 v11, 3, v1
    v_add_u32 v10, 147456, v1
    buffer_load_dwordx4 v[36:39], v1, s[8:11], s63 offen offset:2048 sc1
R_mpoll_slow:
    s_waitcnt vmcnt(6)
    v_cmp_u_f32 vcc, v12, v14
    s_cbranch_vccnz R_retry0_slow
R_mok0_slow:
    v_smfmac_f32_16x16x64_bf16 v[48:51], v[12:15], a[0:7], v0
    s_waitcnt vmcnt(5)
    v_cmp_u_f32 vcc, v16, v18
    v_smfmac_f32_16x16x64_bf16 v[52:55], v[12:15], a[8:15], v0
    buffer_load_dwordx4 v[40:43], v1, s[8:11], s63 offen offset:3072 sc1
    v_smfmac_f32_16x16x64_bf16 v[56:59], v[12:15], a[16:23], v0
    s_cbranch_vccnz R_retry1_slow
R_mok1_slow:
    v_smfmac_f32_16x16x64_bf16 v[60:63], v[12:15], v[72:79], v0
R_post0_slow:
    ds_read_b128 v[72:75], v9 offset:8192
    ds_read_b128 v[76:79], v9 offset:9216
    v_smfmac_f32_16x16x64_bf16 v[48:51], v[16:19], a[48:55], v0
    s_waitcnt vmcnt(5)
    v_cmp_u_f32 vcc, v20, v22
    v_smfmac_f32_16x16x64_bf16 v[52:55], v[16:19], a[56:63], v0
    buffer_load_dwordx4 v[44:47], v1, s[8:11], s6 offen offset:0 sc1
    v_smfmac_f32_16x16x64_bf16 v[56:59], v[16:19], a[64:71], v0
    s_cbranch_vccnz R_retry2_slow
R_mok2_slow:
    v_smfmac_f32_16x16x64_bf16 v[60:63], v[16:19], v[64:71], v0
R_post1_slow:
    ds_read_b128 v[64:67], v9 offset:12288
    ds_read_b128 v[68:71], v9 offset:13312
    v_smfmac_f32_16x16x64_bf16 v[48:51], v[20:23], a[96:103], v0
    s_waitcnt vmcnt(5)
    v_cmp_u_f32 vcc, v24, v26
    v_smfmac_f32_16x16x64_bf16 v[52:55], v[20:23], a[104:111], v0
    s_waitcnt lgkmcnt(2)
    v_smfmac_f32_16x16x64_bf16 v[56:59], v[20:23], a[112:119], v0
    s_cbranch_vccnz R_retry3_slow
R_mok3_slow:
    v_smfmac_f32_16x16x64_bf16 v[60:63], v[20:23], v[72:79], v0
R_post2_slow:
    ds_read_b128 v[72:75], v9 offset:2048
    ds_read_b128 v[76:79], v9 offset:3072
    v_smfmac_f32_16x16x64_bf16 v[48:51], v[24:27], a[144:151], v0
    s_waitcnt vmcnt(4)
    v_cmp_u_f32 vcc, v28, v30
    v_smfmac_f32_16x16x64_bf16 v[52:55], v[24:27], a[152:159], v0
    s_waitcnt lgkmcnt(2)
    v_smfmac_f32_16x16x64_bf16 v[56:59], v[24:27], a[160:167], v0
    s_cbranch_vccnz R_retry4_slow
R_mok4_slow:
    v_smfmac_f32_16x16x64_bf16 v[60:63], v[24:27], v[64:71], v0
R_post3_slow:
    ds_read_b128 v[64:67], v9 offset:6144
    ds_read_b128 v[68:71], v9 offset:7168
    v_smfmac_f32_16x16x64_bf16 v[48:51], v[28:31], a[24:31], v0
    s_waitcnt vmcnt(3)
    v_cmp_u_f32 vcc, v32, v34
    v_smfmac_f32_16x16x64_bf16 v[52:55], v[28:31], a[32:39], v0
    s_waitcnt lgkmcnt(2)
    buffer_load_dword v11, s[8:11], s93 offen sc1 lds
    v_smfmac_f32_16x16x64_bf16 v[56:59], v[28:31], a[40:47], v0
    s_cbranch_vccnz R_retry5_slow
R_mok5_slow:
    v_smfmac_f32_16x16x64_bf16 v[60:63], v[28:31], v[72:79], v0
R_post4_slow:
    ds_read_b128 v[72:75], v9 offset:10240
    ds_read_b128 v[76:79], v9 offset:11264
    v_smfmac_f32_16x16x64_bf16 v[48:51], v[32:35], a[72:79], v0
    s_waitcnt vmcnt(3)
    v_cmp_u_f32 vcc, v36, v38
    v_smfmac_f32_16x16x64_bf16 v[52:55], v[32:35], a[80:87], v0
    s_waitcnt lgkmcnt(2)
    v_smfmac_f32_16x16x64_bf16 v[56:59], v[32:35], a[88:95], v0
    s_cbranch_vccnz R_retry6_slow
R_mok6_slow:
    v_smfmac_f32_16x16x64_bf16 v[60:63], v[32:35], v[64:71], v0
R_post5_slow:
    ds_read_b128 v[64:67], v9 offset:14336
    ds_read_b128 v[68:71], v9 offset:15360
    v_smfmac_f32_16x16x64_bf16 v[48:51], v[36:39], a[120:127], v0
    s_waitcnt vmcnt(2)
    v_cmp_u_f32 vcc, v40, v42
    v_smfmac_f32_16x16x64_bf16 v[52:55], v[36:39], a[128:135], v0
    s_waitcnt lgkmcnt(2)
    v_smfmac_f32_16x16x64_bf16 v[56:59], v[36:39], a[136:143], v0
    s_cbranch_vccnz R_retry7_slow
R_mok7_slow:
    v_smfmac_f32_16x16x64_bf16 v[60:63], v[36:39], v[72:79], v0
R_post6_slow:
    ds_read_b128 v[72:75], v9 offset:16384
    ds_read_b128 v[76:79], v9 offset:17408
    v_smfmac_f32_16x16x64_bf16 v[48:51], v[40:43], a[168:175], v0
    s_waitcnt vmcnt(1)
    v_cmp_u_f32 vcc, v44, v46
    v_smfmac_f32_16x16x64_bf16 v[52:55], v[40:43], a[176:183], v0
    s_waitcnt lgkmcnt(2)
    v_smfmac_f32_16x16x64_bf16 v[56:59], v[40:43], a[184:191], v0
    s_cbranch_vccnz R_retry8_slow
R_mok8_slow:
    v_smfmac_f32_16x16x64_bf16 v[60:63], v[40:43], v[64:71], v0
R_post7_slow:
    v_smfmac_f32_16x16x64_bf16 v[48:51], v[44:47], a[192:199], v0
    v_mov_b64 v[64:65], 0
    v_smfmac_f32_16x16x64_bf16 v[52:55], v[44:47], a[200:207], v0
    s_waitcnt lgkmcnt(0)
    v_mov_b64 v[66:67], 0
    v_smfmac_f32_16x16x64_bf16 v[56:59], v[44:47], a[208:215], v0
    v_mov_b64 v[68:69], 0
    v_smfmac_f32_16x16x64_bf16 v[60:63], v[44:47], v[72:79], v0
R_post8_slow:
    v_mov_b64 v[70:71], 0
    v_smfmac_f32_16x16x64_bf16 v[64:67], v[12:15], v[112:119], v0
    buffer_load_dwordx4 v[72:75], v1, s[8:11], s37 offen sc1
    v_add_f32 v48, v48, v49
    v_smfmac_f32_16x16x64_bf16 v[68:71], v[12:15], v[120:127], v0
    buffer_load_dwordx4 v[76:79], v1, s[8:11], s37 offen offset:1024 sc1
    v_add_f32 v49, v50, v51
    v_smfmac_f32_16x16x64_bf16 v[64:67], v[16:19], v[144:151], v0
    v_add_f32 v52, v52, v53
    v_add_f32 v53, v54, v55
    v_smfmac_f32_16x16x64_bf16 v[68:71], v[16:19], v[152:159], v0
    v_add_f32 v56, v56, v57
    v_add_f32 v57, v58, v59
    v_smfmac_f32_16x16x64_bf16 v[64:67], v[20:23], v[176:183], v0
    v_add_f32 v60, v60, v61
    v_add_f32 v61, v62, v63
    v_smfmac_f32_16x16x64_bf16 v[68:71], v[20:23], v[184:191], v0
    v_cvt_pk_bf16_f32 v12, v48, v52
    v_cvt_pk_bf16_f32 v14, v49, v53
    v_smfmac_f32_16x16x64_bf16 v[64:67], v[24:27], v[208:215], v0
    v_cvt_pk_bf16_f32 v13, v56, v60
    v_cvt_pk_bf16_f32 v15, v57, v61
    v_smfmac_f32_16x16x64_bf16 v[68:71], v[24:27], v[216:223], v0
    ds_write2_b64 v5, v[12:13], v[14:15] offset0:0 offset1:34
    v_smfmac_f32_16x16x64_bf16 v[64:67], v[28:31], v[128:135], v0
    ds_read_b128 v[48:51], v10 offset:0
    ds_read_b128 v[52:55], v10 offset:1024
    v_smfmac_f32_16x16x64_bf16 v[68:71], v[28:31], v[136:143], v0
    ds_read_b128 v[56:59], v10 offset:2048
    ds_read_b128 v[60:63], v10 offset:3072
    v_smfmac_f32_16x16x64_bf16 v[64:67], v[32:35], v[160:167], v0
    buffer_store_dwordx4 v[12:15], v1, s[8:11], s62 offen sc1
    v_smfmac_f32_16x16x64_bf16 v[68:71], v[32:35], v[168:175], v0
    s_waitcnt lgkmcnt(4)
    s_barrier
    ds_read_b128 v[12:15], v6
    v_smfmac_f32_16x16x64_bf16 v[64:67], v[36:39], v[192:199], v0
    ds_read_b128 v[16:19], v6 offset:64
    ds_read_b128 v[20:23], v6 offset:128
    v_smfmac_f32_16x16x64_bf16 v[68:71], v[36:39], v[200:207], v0
    ds_read_b128 v[24:27], v6 offset:192
    ds_read_b128 v[28:31], v10 offset:4096
    v_smfmac_f32_16x16x64_bf16 v[64:67], v[40:43], v[224:231], v0
    ds_read_b128 v[32:35], v10 offset:5120
    buffer_load_dword v11, s[8:11], s87 offen sc1 lds
    v_smfmac_f32_16x16x64_bf16 v[68:71], v[40:43], v[232:239], v0
    v_smfmac_f32_16x16x64_bf16 v[64:67], v[44:47], v[240:247], v0
    s_mov_b32 m0, s99
    s_add_u32 s37, s37, 786432
    v_smfmac_f32_16x16x64_bf16 v[68:71], v[44:47], v[248:255], v0
    s_sub_u32 s55, s37, 8192
    s_waitcnt lgkmcnt(5)
    v_mfma_f32_16x16x32_bf16 v[36:39], v[48:51], v[12:15], 0
    ds_read_b128 v[48:51], v10 offset:6144
    v_mfma_f32_16x16x32_bf16 v[40:43], v[52:55], v[12:15], 0
    ds_read_b128 v[52:55], v10 offset:7168
    v_mfma_f32_16x16x32_bf16 v[44:47], v[12:15], v[12:15], 0
    s_cmp_eq_u32 s29, 63
    s_waitcnt lgkmcnt(6)
    v_mfma_f32_16x16x32_bf16 v[36:39], v[56:59], v[16:19], v[36:39]
    v_mfma_f32_16x16x32_bf16 v[40:43], v[60:63], v[16:19], v[40:43]
    s_mov_b64 exec, 1
    buffer_load_dwordx4 off, s[8:11], s61 sc1 lds
    s_mov_b64 exec, -1
    v_mfma_f32_16x16x32_bf16 v[44:47], v[16:19], v[16:19], v[44:47]
    v_add_f32 v64, v64, v65
    v_add_f32 v65, v66, v67
    s_waitcnt lgkmcnt(2)
    v_mfma_f32_16x16x32_bf16 v[36:39], v[28:31], v[20:23], v[36:39]
    v_add_f32 v68, v68, v69
    v_add_f32 v69, v70, v71
    v_mfma_f32_16x16x32_bf16 v[40:43], v[32:35], v[20:23], v[40:43]
    v_cvt_pk_bf16_f32 v10, v64, v65
    v_cvt_pk_bf16_f32 v11, v68, v69
    v_mfma_f32_16x16x32_bf16 v[44:47], v[20:23], v[20:23], v[44:47]
    ds_read_b128 v[12:15], v9 offset:18432
    ds_read_b128 v[16:19], v9 offset:19456
    s_waitcnt lgkmcnt(2)
    v_mfma_f32_16x16x32_bf16 v[36:39], v[48:51], v[24:27], v[36:39]
    v_lshrrev_b32 v71, 1, v1
    v_mov_b64 v[34:35], 0
    v_mfma_f32_16x16x32_bf16 v[40:43], v[52:55], v[24:27], v[40:43]
    buffer_store_dwordx2 v[10:11], v71, s[8:11], s38 offen sc1
    v_mfma_f32_16x16x32_bf16 v[44:47], v[24:27], v[24:27], v[44:47]
    ds_read_b128 v[20:23], v9 offset:22528
    ds_read_b128 v[24:27], v9 offset:23552
    s_mov_b32 m0, s97
    s_cbranch_scc1 R_done_slow
    v_max3_f32 v68, v36, v37, v38
    s_nop 0
    v_max3_f32 v69, v39, v40, v41
    v_max3_f32 v68, v68, v42, v43
    v_mov_b32 v33, 0
    v_max3_f32 v69, v69, v44, v45
    v_max_f32 v46, v68, v69
    v_max_f32 v47, v68, v69
    v_mov_b64 v[64:65], s[88:89]
    v_mov_b64 v[66:67], s[88:89]
    v_permlane16_swap_b32 v46, v47
    v_max_f32 v68, v46, v47
    v_max_f32 v69, v46, v47
    s_mov_b32 s54, s34
    s_mov_b32 s34, s35
    v_permlane32_swap_b32 v68, v69
    v_max_f32 v46, v68, v69
    v_mul_f32 v46, s39, v46
    v_pk_fma_f32 v[44:45], v[44:45], s[94:95], v[46:47] op_sel_hi:[1,1,0] neg_lo:[0,0,1] neg_hi:[0,0,1]
    v_pk_fma_f32 v[36:37], v[36:37], s[94:95], v[46:47] op_sel_hi:[1,1,0] neg_lo:[0,0,1] neg_hi:[0,0,1]
    v_pk_fma_f32 v[38:39], v[38:39], s[94:95], v[46:47] op_sel_hi:[1,1,0] neg_lo:[0,0,1] neg_hi:[0,0,1]
    v_pk_fma_f32 v[40:41], v[40:41], s[94:95], v[46:47] op_sel_hi:[1,1,0] neg_lo:[0,0,1] neg_hi:[0,0,1]
    v_pk_fma_f32 v[42:43], v[42:43], s[94:95], v[46:47] op_sel_hi:[1,1,0] neg_lo:[0,0,1] neg_hi:[0,0,1]
    v_exp_f32 v44, v44
    v_exp_f32 v45, v45
    v_exp_f32 v36, v36
    v_cvt_pk_bf16_f32 v32, v44, v45
    v_cvt_pk_bf16_f32 v35, v44, v45
    v_exp_f32 v37, v37
    v_mfma_f32_16x16x16_bf16 v[68:71], v[64:65], v[32:33], 0
    v_exp_f32 v38, v38
    v_mfma_f32_16x16x16_bf16 v[56:59], v[10:11], v[32:33], 0
    v_exp_f32 v39, v39
    v_mfma_f32_16x16x16_bf16 v[60:63], v[10:11], v[34:35], 0
    v_exp_f32 v40, v40
    v_exp_f32 v41, v41
    v_exp_f32 v42, v42
    v_exp_f32 v43, v43
    v_cvt_pk_bf16_f32 v28, v36, v37
    v_cvt_pk_bf16_f32 v29, v38, v39
    v_cvt_pk_bf16_f32 v30, v40, v41
    v_cvt_pk_bf16_f32 v31, v42, v43
    s_waitcnt vmcnt(4)
    v_mov_b64 v[36:37], 0
    v_mfma_f32_16x16x32_bf16 v[68:71], v[64:67], v[28:31], v[68:71]
    v_mov_b64 v[38:39], 0
    v_mov_b64 v[40:41], 0
    v_mfma_f32_16x16x32_bf16 v[56:59], v[72:75], v[28:31], v[56:59]
    v_mov_b64 v[42:43], 0
    v_mov_b64 v[44:45], 0
    v_mfma_f32_16x16x32_bf16 v[60:63], v[76:79], v[28:31], v[60:63]
    ds_read_b128 v[48:51], v9 offset:34816
    ds_read_b128 v[52:55], v9 offset:35840
    v_rcp_f32 v68, v68
    v_mov_b64 v[46:47], 0
    v_mov_b64 v[32:33], 0
    s_mov_b64 exec, s[42:43]
    v_pk_mul_f32 v[56:57], v[56:57], v[68:69] op_sel_hi:[1,0]
    v_pk_mul_f32 v[58:59], v[58:59], v[68:69] op_sel_hi:[1,0]
    v_pk_mul_f32 v[60:61], v[60:61], v[68:69] op_sel_hi:[1,0]
    v_pk_mul_f32 v[62:63], v[62:63], v[68:69] op_sel_hi:[1,0]
    v_cvt_pk_bf16_f32 v28, v56, v60
    v_cvt_pk_bf16_f32 v29, v57, v61
    v_cvt_pk_bf16_f32 v30, v58, v62
    v_cvt_pk_bf16_f32 v31, v59, v63
    ds_write_b128 v7, v[28:31]
    s_mov_b64 exec, -1
    v_mov_b64 v[34:35], 0
    v_and_b32 v11, 16, v1
    v_lshl_add_u32 v11, v11, 2, v8
    s_add_u32 s38, s38, 131072
    s_add_u32 s62, s62, 131072
    s_add_u32 s29, s29, 1
    s_mov_b32 s35, s36
    s_mov_b32 s36, s54
    s_add_u32 s101, s34, s100
    s_add_u32 s63, s101, 4096
    s_add_u32 s6, s101, 8192
    s_waitcnt lgkmcnt(0)
    s_barrier
    ds_read_b128 v[72:75], v8 offset:0
    ds_read_b128 v[64:67], v11 offset:0
    ds_read_b128 v[76:79], v8 offset:64
    ds_read_b128 v[68:71], v11 offset:128
    ds_read_b128 v[60:63], v8 offset:192
    ds_read_b128 v[56:59], v8 offset:128
    buffer_load_dwordx4 v1, s[8:11], s55 offen sc1 lds
    buffer_load_dwordx4 v1, s[8:11], s55 offen offset:1024 sc1 lds
    v_mov_b64 v[28:29], 0
    v_mov_b64 v[30:31], 0
    s_waitcnt lgkmcnt(5)
    v_smfmac_f32_16x16x64_bf16 v[40:43], v[72:75], v[12:19], v0
    ds_read_b128 v[12:15], v9 offset:24576
    ds_read_b128 v[16:19], v9 offset:25600
    v_smfmac_f32_16x16x64_bf16 v[32:35], v[72:75], v[20:27], v0
    s_waitcnt lgkmcnt(6)
    ds_read_b128 v[20:23], v9 offset:20480
    ds_read_b128 v[24:27], v9 offset:21504
    v_smfmac_f32_16x16x64_bf16 v[36:39], v[64:67], v[48:55], v0
    s_waitcnt lgkmcnt(7)
    ds_read_b128 v[48:51], v9 offset:26624
    v_smfmac_f32_16x16x64_bf16 v[40:43], v[76:79], a[216:223], v0
    s_waitcnt lgkmcnt(7)
    ds_read_b128 v[52:55], v9 offset:27648
    v_smfmac_f32_16x16x64_bf16 v[36:39], v[68:71], v[104:111], v0
    ds_read_b128 v[64:67], v9 offset:30720
    v_smfmac_f32_16x16x64_bf16 v[32:35], v[76:79], a[232:239], v0
    s_waitcnt lgkmcnt(8)
    ds_read_b128 v[68:71], v9 offset:31744
    v_smfmac_f32_16x16x64_bf16 v[40:43], v[60:63], a[224:231], v0
    s_waitcnt lgkmcnt(8)
    s_waitcnt lgkmcnt(6)
    v_smfmac_f32_16x16x64_bf16 v[32:35], v[56:59], v[12:19], v0
    s_waitcnt lgkmcnt(4)
    ds_read_b128 v[12:15], v9 offset:28672
    v_add_f32 v36, v36, v37
    v_smfmac_f32_16x16x64_bf16 v[40:43], v[56:59], v[20:27], v0
    ds_read_b128 v[16:19], v9 offset:29696
    v_add_f32 v37, v38, v39
    v_smfmac_f32_16x16x64_bf16 v[32:35], v[60:63], a[240:247], v0
    s_waitcnt lgkmcnt(4)
    ds_read_b128 v[20:23], v9 offset:32768
    v_cvt_pk_bf16_f32 v10, v36, v37
    v_smfmac_f32_16x16x64_bf16 v[44:47], v[72:75], v[48:55], v0
    ds_read_b128 v[24:27], v9 offset:33792
    v_bfi_b32 v10, 1, s33, v10
    v_smfmac_f32_16x16x64_bf16 v[28:31], v[76:79], v[88:95], v0
    buffer_store_dword v10, v3, s[8:11], s58 offen sc1
    v_cvt_pk_bf16_f32 v36, v40, v41
    v_smfmac_f32_16x16x64_bf16 v[44:47], v[76:79], a[248:255], v0
    s_waitcnt lgkmcnt(4)
    v_cvt_pk_bf16_f32 v38, v42, v43
    v_smfmac_f32_16x16x64_bf16 v[28:31], v[72:75], v[64:71], v0
    s_waitcnt lgkmcnt(2)
    v_bfi_b32 v36, 1, s33, v36
    v_smfmac_f32_16x16x64_bf16 v[44:47], v[56:59], v[12:19], v0
    v_cvt_pk_bf16_f32 v37, v32, v33
    v_smfmac_f32_16x16x64_bf16 v[28:31], v[60:63], v[96:103], v0
    v_cvt_pk_bf16_f32 v39, v34, v35
    v_smfmac_f32_16x16x64_bf16 v[44:47], v[60:63], v[80:87], v0
    s_waitcnt lgkmcnt(0)
    buffer_store_dwordx4 v[36:39], v2, s[8:11], s58 offen sc1
    v_smfmac_f32_16x16x64_bf16 v[28:31], v[56:59], v[20:27], v0
    s_nop 4
    v_cvt_pk_bf16_f32 v40, v44, v45
    v_cvt_pk_bf16_f32 v42, v46, v47
    v_bfi_b32 v40, 1, s33, v40
    v_cvt_pk_bf16_f32 v41, v28, v29
    v_cvt_pk_bf16_f32 v43, v30, v31
    buffer_store_dwordx4 v[40:43], v2, s[8:11], s31 offen sc1
    s_cmp_ge_u32 s40, 72
    s_cbranch_scc1 R_nored_slow
    v_bfe_u32 v56, v1, s90, 1
    v_lshlrev_b32 v56, 4, v56
    v_mov_b32 v57, 0x3f80
    v_lshlrev_b32 v56, v56, v57
    v_cndmask_b32 v48, 0, v56, s[44:45]
    v_cndmask_b32 v49, 0, v56, s[46:47]
    v_cndmask_b32 v50, 0, v56, s[48:49]
    v_cndmask_b32 v51, 0, v56, s[50:51]
    v_mov_b64 v[10:11], -1
    s_waitcnt vmcnt(2)
    buffer_load_dwordx4 v[12:15], v1, s[8:11], s32 offen offset:0 sc1
    buffer_load_dwordx4 v[16:19], v1, s[8:11], s32 offen offset:1024 sc1
    buffer_load_dwordx4 v[20:23], v1, s[8:11], s32 offen offset:2048 sc1
    buffer_load_dwordx4 v[24:27], v1, s[8:11], s32 offen offset:3072 sc1
    s_waitcnt vmcnt(4)
    buffer_load_dwordx4 v[28:31], v1, s[8:11], s32 offen offset:0 sc1
    buffer_load_dwordx4 v[32:35], v1, s[8:11], s32 offen offset:1024 sc1
    buffer_load_dwordx4 v[36:39], v1, s[8:11], s32 offen offset:2048 sc1
    buffer_load_dwordx4 v[40:43], v1, s[8:11], s32 offen offset:3072 sc1
R_rpoll_slow:
    s_waitcnt vmcnt(7)
    v_mfma_f32_16x16x32_bf16 v[52:55], v[48:51], v[12:15], 0
    s_waitcnt vmcnt(6)
    v_mfma_f32_16x16x32_bf16 v[52:55], v[48:51], v[16:19], v[52:55]
    v_bitop3_b32 v56, v12, v16, s33 bitop3:0x7e
    s_waitcnt vmcnt(5)
    v_mfma_f32_16x16x32_bf16 v[52:55], v[48:51], v[20:23], v[52:55]
    s_waitcnt vmcnt(4)
    v_mfma_f32_16x16x32_bf16 v[52:55], v[48:51], v[24:27], v[52:55]
    v_bitop3_b32 v57, v20, v24, s33 bitop3:0x7e
    v_bitop3_b32 v56, v56, v57, 1 bitop3:0xa8
    v_cmp_ne_u32 vcc, 0, v56
    s_cbranch_vccz R_rok_slow
    buffer_load_dwordx4 v[12:15], v1, s[8:11], s32 offen offset:0 sc1
    buffer_load_dwordx4 v[16:19], v1, s[8:11], s32 offen offset:1024 sc1
    buffer_load_dwordx4 v[20:23], v1, s[8:11], s32 offen offset:2048 sc1
    buffer_load_dwordx4 v[24:27], v1, s[8:11], s32 offen offset:3072 sc1
    s_waitcnt vmcnt(7)
    v_mfma_f32_16x16x32_bf16 v[52:55], v[48:51], v[28:31], 0
    s_waitcnt vmcnt(6)
    v_mfma_f32_16x16x32_bf16 v[52:55], v[48:51], v[32:35], v[52:55]
    v_bitop3_b32 v56, v28, v32, s33 bitop3:0x7e
    s_waitcnt vmcnt(5)
    v_mfma_f32_16x16x32_bf16 v[52:55], v[48:51], v[36:39], v[52:55]
    s_waitcnt vmcnt(4)
    v_mfma_f32_16x16x32_bf16 v[52:55], v[48:51], v[40:43], v[52:55]
    v_bitop3_b32 v57, v36, v40, s33 bitop3:0x7e
    v_bitop3_b32 v56, v56, v57, 1 bitop3:0xa8
    v_cmp_ne_u32 vcc, 0, v56
    s_cbranch_vccnz R_rretry_slow
R_rok_slow:
    s_nop 3
    v_add_f32_dpp v56, v52, v52 row_ror:8 row_mask:0xf bank_mask:0xf
    v_add_f32_dpp v57, v53, v53 row_ror:8 row_mask:0xf bank_mask:0xf
    v_add_f32_dpp v58, v54, v54 row_ror:8 row_mask:0xf bank_mask:0xf
    v_add_f32_dpp v59, v55, v55 row_ror:8 row_mask:0xf bank_mask:0xf
    v_cvt_pk_bf16_f32 v44, v56, v57
    v_cvt_pk_bf16_f32 v45, v58, v59
    buffer_store_dwordx2 v[44:45], v4, s[8:11], s34 offen sc1
    buffer_store_dwordx2 v[10:11], v4, s[8:11], s36 offen sc1
R_nored_slow:
R_red_done_slow:
    s_branch R_loop_slow
R_retry0_slow:
    s_sub_u32 s41, s41, 1
    s_cmp_gt_i32 s41, 0
    s_cbranch_scc0 R_mok0_slow
    buffer_load_dwordx4 v[12:15], v1, s[8:11], s101 offen offset:0 sc1
    s_waitcnt vmcnt(0)
    s_branch R_mpoll_slow
R_retry1_slow:
    s_sub_u32 s41, s41, 1
    s_cmp_gt_i32 s41, 0
    s_cbranch_scc0 R_mok1_slow
    buffer_load_dwordx4 v[16:19], v1, s[8:11], s101 offen offset:1024 sc1
    s_waitcnt vmcnt(0)
    v_cmp_u_f32 vcc, v16, v18
    s_cbranch_vccnz R_retry1_slow
    s_branch R_mok1_slow
R_retry2_slow:
    s_sub_u32 s41, s41, 1
    s_cmp_gt_i32 s41, 0
    s_cbranch_scc0 R_mok2_slow
    buffer_load_dwordx4 v[20:23], v1, s[8:11], s101 offen offset:2048 sc1
    s_waitcnt vmcnt(0)
    v_cmp_u_f32 vcc, v20, v22
    s_cbranch_vccnz R_retry2_slow
    s_branch R_mok2_slow
R_retry3_slow:
    s_sub_u32 s41, s41, 1
    s_cmp_gt_i32 s41, 0
    s_cbranch_scc0 R_mok3_slow
    buffer_load_dwordx4 v[24:27], v1, s[8:11], s101 offen offset:3072 sc1
    s_waitcnt vmcnt(0)
    v_cmp_u_f32 vcc, v24, v26
    s_cbranch_vccnz R_retry3_slow
    s_branch R_mok3_slow
R_retry4_slow:
    s_sub_u32 s41, s41, 1
    s_cmp_gt_i32 s41, 0
    s_cbranch_scc0 R_mok4_slow
    buffer_load_dwordx4 v[28:31], v1, s[8:11], s63 offen offset:0 sc1
    s_waitcnt vmcnt(0)
    v_cmp_u_f32 vcc, v28, v30
    s_cbranch_vccnz R_retry4_slow
    s_branch R_mok4_slow
R_retry5_slow:
    s_sub_u32 s41, s41, 1
    s_cmp_gt_i32 s41, 0
    s_cbranch_scc0 R_mok5_slow
    buffer_load_dwordx4 v[32:35], v1, s[8:11], s63 offen offset:1024 sc1
    s_waitcnt vmcnt(0)
    v_cmp_u_f32 vcc, v32, v34
    s_cbranch_vccnz R_retry5_slow
    s_branch R_mok5_slow
R_retry6_slow:
    s_sub_u32 s41, s41, 1
    s_cmp_gt_i32 s41, 0
    s_cbranch_scc0 R_mok6_slow
    buffer_load_dwordx4 v[36:39], v1, s[8:11], s63 offen offset:2048 sc1
    s_waitcnt vmcnt(0)
    v_cmp_u_f32 vcc, v36, v38
    s_cbranch_vccnz R_retry6_slow
    s_branch R_mok6_slow
R_retry7_slow:
    s_sub_u32 s41, s41, 1
    s_cmp_gt_i32 s41, 0
    s_cbranch_scc0 R_mok7_slow
    buffer_load_dwordx4 v[40:43], v1, s[8:11], s63 offen offset:3072 sc1
    s_waitcnt vmcnt(0)
    v_cmp_u_f32 vcc, v40, v42
    s_cbranch_vccnz R_retry7_slow
    s_branch R_mok7_slow
R_retry8_slow:
    s_sub_u32 s41, s41, 1
    s_cmp_gt_i32 s41, 0
    s_cbranch_scc0 R_mok8_slow
    buffer_load_dwordx4 v[44:47], v1, s[8:11], s6 offen offset:0 sc1
    s_waitcnt vmcnt(0)
    v_cmp_u_f32 vcc, v44, v46
    s_cbranch_vccnz R_retry8_slow
    s_branch R_mok8_slow
R_rretry_slow:
    s_sub_u32 s41, s41, 1
    s_cmp_gt_i32 s41, 0
    s_cbranch_scc0 R_rok_slow
    buffer_load_dwordx4 v[28:31], v1, s[8:11], s32 offen offset:0 sc1
    buffer_load_dwordx4 v[32:35], v1, s[8:11], s32 offen offset:1024 sc1
    buffer_load_dwordx4 v[36:39], v1, s[8:11], s32 offen offset:2048 sc1
    buffer_load_dwordx4 v[40:43], v1, s[8:11], s32 offen offset:3072 sc1
    s_branch R_rpoll_slow
R_kvwait_slow:
R_kv_17:
    v_lshrrev_b32 v11, 2, v1
    v_and_b32 v11, 4, v11
    buffer_load_dword v11, v11, s[8:11], s92 offen sc1
    s_waitcnt vmcnt(0)
    v_readlane_b32 s60, v11, 0
    v_readlane_b32 s57, v11, 1
    s_lshl_b32 s60, s60, 1
    s_lshl_b32 s57, s57, 1
    s_add_u32 s57, s57, 1
    s_min_u32 s60, s60, s57
    s_cmp_gt_u32 s60, s91
    s_cbranch_scc1 R_kvok_18
    s_sleep 1
    s_sub_u32 s41, s41, 1
    s_cmp_gt_i32 s41, 0
    s_cbranch_scc1 R_kv_17
R_kvok_18:
    s_branch R_kvok_slow
R_done_slow:
    s_mov_b64 exec, 1
    s_waitcnt vmcnt(0)
    s_endpgm
A1_entry:
    v_and_b32 v20, 63, v0
    v_and_b32 v21, 15, v20
    v_lshrrev_b32 v22, 4, v20
    v_lshlrev_b32 v1, 4, v20
    s_mov_b32 s34, 0x05040100
    s_mov_b32 s35, 0x07060302
    s_mov_b32 s45, 0xffff0000
    s_mov_b32 s33, 400000
    v_lshrrev_b32 v23, 3, v20
    s_lshl_b32 s36, s4, 3
    v_add_u32 v23, s36, v23
    v_bfe_u32 v24, v23, 1, 3
    v_and_b32 v25, 7, v20
    v_xor_b32 v24, v24, v25
    v_mul_u32_u24 v23, 1152, v23
    v_lshl_add_u32 v2, v24, 4, v23
    v_lshrrev_b32 v23, 3, v21
    v_lshlrev_b32 v23, 10, v23
    v_and_b32 v24, 7, v21
    v_lshl_add_u32 v23, v24, 7, v23
    v_bfe_u32 v24, v21, 1, 3
    v_xor_b32 v24, v24, v22
    v_lshl_add_u32 v3, v24, 4, v23
    v_xor_b32 v4, 64, v3
    s_lshr_b32 s42, s28, 1
    s_and_b32 s43, s28, 1
    s_load_dwordx2 s[16:17], s[0:1], 16
    s_mov_b32 s18, 0x480000
    s_mov_b32 s19, 0x20000
    s_load_dwordx2 s[20:21], s[0:1], 24
    s_mov_b32 s22, 0x480000
    s_mov_b32 s23, 0x20000
    s_load_dwordx2 s[24:25], s[0:1], 32
    s_mov_b32 s26, 0x480000
    s_mov_b32 s27, 0x20000
    s_lshl_b32 s36, s4, 16
    s_lshl_b32 s37, s42, 8
    s_add_u32 s36, s36, s37
    v_lshlrev_b32 v23, 13, v22
    v_lshl_add_u32 v23, v21, 4, v23
    v_add_u32 v8, s36, v23
    v_lshlrev_b32 v23, 11, v22
    s_lshr_b32 s36, s4, 1
    s_lshl_b32 s36, s36, 13
    s_and_b32 s37, s4, 1
    s_lshl_b32 s37, s37, 7
    s_add_u32 s36, s36, s37
    v_lshl_add_u32 v24, v21, 3, v23
    v_add_u32 v6, s36, v24
    s_lshl_b32 s36, s4, 6
    s_add_u32 s36, s36, 16384
    v_lshl_add_u32 v24, v21, 2, v23
    v_add_u32 v7, s36, v24
    v_lshrrev_b32 v23, 1, v22
    v_lshlrev_b32 v23, 11, v23
    v_and_b32 v24, 1, v22
    v_lshl_add_u32 v23, v24, 9, v23
    v_lshl_add_u32 v23, v21, 4, v23
    s_lshl_b32 s36, s4, 12
    v_add_u32 v5, s36, v23
    s_waitcnt lgkmcnt(0)
    s_mov_b32 s29, 0
    s_mul_i32 s30, s43, 36864
    s_add_u32 s30, s30, 0x200000
    s_lshl_b32 s36, s43, 5
    s_add_u32 s36, s36, s42
    s_mul_i32 s31, s36, 24576
    s_add_u32 s31, s31, 0x1800000
    s_mul_i32 s52, s36, 4096
    s_lshl_b32 s37, s4, 10
    s_add_u32 s52, s52, s37
    s_add_u32 s52, s52, 0x800000
    s_lshl_b32 s32, s42, 7
    s_lshl_b32 s36, s43, 2
    s_add_u32 s32, s32, s36
    s_add_u32 s32, s32, 0x144000
    s_mov_b32 s40, 0
    s_mov_b32 s41, 1
    s_mov_b32 s53, 0
    v_lshlrev_b32 v60, 3, v1
    s_lshl_b32 s36, s4, 11
    s_add_u32 m0, s36, 0
    s_mov_b32 s36, 0
    buffer_load_dwordx4 v8, s[16:19], s36 offen lds
    s_add_u32 m0, m0, 1024
    s_mov_b32 s36, 32768
    buffer_load_dwordx4 v8, s[16:19], s36 offen lds
    s_lshl_b32 s36, s4, 11
    s_add_u32 m0, s36, 8192
    s_mov_b32 s36, 0
    buffer_load_dwordx4 v8, s[20:23], s36 offen lds
    s_add_u32 m0, m0, 1024
    s_mov_b32 s36, 32768
    buffer_load_dwordx4 v8, s[20:23], s36 offen lds
    s_lshl_b32 s36, s4, 11
    s_add_u32 m0, s36, 16384
    s_mov_b32 s36, 0
    buffer_load_dwordx4 v8, s[24:27], s36 offen lds
    s_add_u32 m0, m0, 1024
    s_mov_b32 s36, 32768
    buffer_load_dwordx4 v8, s[24:27], s36 offen lds
    s_lshl_b32 s36, s4, 11
    s_add_u32 m0, s36, 24576
    s_mov_b32 s36, 262144
    buffer_load_dwordx4 v8, s[16:19], s36 offen lds
    s_add_u32 m0, m0, 1024
    s_mov_b32 s36, 294912
    buffer_load_dwordx4 v8, s[16:19], s36 offen lds
    s_lshl_b32 s36, s4, 11
    s_add_u32 m0, s36, 32768
    s_mov_b32 s36, 262144
    buffer_load_dwordx4 v8, s[20:23], s36 offen lds
    s_add_u32 m0, m0, 1024
    s_mov_b32 s36, 294912
    buffer_load_dwordx4 v8, s[20:23], s36 offen lds
    s_lshl_b32 s36, s4, 11
    s_add_u32 m0, s36, 40960
    s_mov_b32 s36, 262144
    buffer_load_dwordx4 v8, s[24:27], s36 offen lds
    s_add_u32 m0, m0, 1024
    s_mov_b32 s36, 294912
    buffer_load_dwordx4 v8, s[24:27], s36 offen lds
    s_lshl_b32 s36, s4, 11
    s_add_u32 m0, s36, 49152
    s_mov_b32 s36, 524288
    buffer_load_dwordx4 v8, s[16:19], s36 offen lds
    s_add_u32 m0, m0, 1024
    s_mov_b32 s36, 557056
    buffer_load_dwordx4 v8, s[16:19], s36 offen lds
    s_lshl_b32 s36, s4, 11
    s_add_u32 m0, s36, 57344
    s_mov_b32 s36, 524288
    buffer_load_dwordx4 v8, s[20:23], s36 offen lds
    s_add_u32 m0, m0, 1024
    s_mov_b32 s36, 557056
    buffer_load_dwordx4 v8, s[20:23], s36 offen lds
    s_lshl_b32 s36, s4, 11
    s_add_u32 m0, s36, 65536
    s_mov_b32 s36, 524288
    buffer_load_dwordx4 v8, s[24:27], s36 offen lds
    s_add_u32 m0, m0, 1024
    s_mov_b32 s36, 557056
    buffer_load_dwordx4 v8, s[24:27], s36 offen lds
    s_lshl_b32 s36, s4, 11
    s_add_u32 m0, s36, 73728
    s_mov_b32 s36, 786432
    buffer_load_dwordx4 v8, s[16:19], s36 offen lds
    s_add_u32 m0, m0, 1024
    s_mov_b32 s36, 819200
    buffer_load_dwordx4 v8, s[16:19], s36 offen lds
    s_lshl_b32 s36, s4, 11
    s_add_u32 m0, s36, 81920
    s_mov_b32 s36, 786432
    buffer_load_dwordx4 v8, s[20:23], s36 offen lds
    s_add_u32 m0, m0, 1024
    s_mov_b32 s36, 819200
    buffer_load_dwordx4 v8, s[20:23], s36 offen lds
    s_lshl_b32 s36, s4, 11
    s_add_u32 m0, s36, 90112
    s_mov_b32 s36, 786432
    buffer_load_dwordx4 v8, s[24:27], s36 offen lds
    s_add_u32 m0, m0, 1024
    s_mov_b32 s36, 819200
    buffer_load_dwordx4 v8, s[24:27], s36 offen lds
    s_lshl_b32 s36, s4, 11
    s_add_u32 m0, s36, 98304
    s_mov_b32 s36, 1048576
    buffer_load_dwordx4 v8, s[16:19], s36 offen lds
    s_add_u32 m0, m0, 1024
    s_mov_b32 s36, 1081344
    buffer_load_dwordx4 v8, s[16:19], s36 offen lds
    s_lshl_b32 s36, s4, 11
    s_add_u32 m0, s36, 106496
    s_mov_b32 s36, 1048576
    buffer_load_dwordx4 v8, s[20:23], s36 offen lds
    s_add_u32 m0, m0, 1024
    s_mov_b32 s36, 1081344
    buffer_load_dwordx4 v8, s[20:23], s36 offen lds
    s_lshl_b32 s36, s4, 11
    s_add_u32 m0, s36, 114688
    s_mov_b32 s36, 1048576
    buffer_load_dwordx4 v8, s[24:27], s36 offen lds
    s_add_u32 m0, m0, 1024
    s_mov_b32 s36, 1081344
    buffer_load_dwordx4 v8, s[24:27], s36 offen lds
    s_waitcnt vmcnt(24)
    s_barrier
    s_lshl_b32 s36, s4, 11
    s_add_u32 m0, s36, 122880
    s_mov_b32 s36, 1310720
    buffer_load_dwordx4 v8, s[16:19], s36 offen lds
    s_add_u32 m0, m0, 1024
    s_mov_b32 s36, 1343488
    buffer_load_dwordx4 v8, s[16:19], s36 offen lds
    s_lshl_b32 s36, s4, 11
    s_add_u32 m0, s36, 131072
    s_mov_b32 s36, 1310720
    buffer_load_dwordx4 v8, s[20:23], s36 offen lds
    s_add_u32 m0, m0, 1024
    s_mov_b32 s36, 1343488
    buffer_load_dwordx4 v8, s[20:23], s36 offen lds
    s_lshl_b32 s36, s4, 11
    s_add_u32 m0, s36, 139264
    s_mov_b32 s36, 1310720
    buffer_load_dwordx4 v8, s[24:27], s36 offen lds
    s_add_u32 m0, m0, 1024
    s_mov_b32 s36, 1343488
    buffer_load_dwordx4 v8, s[24:27], s36 offen lds
    v_add_u32 v9, 0, v6
    ds_read_b64 v[32:33], v9 offset:0
    ds_read_b64 v[34:35], v9 offset:256
    ds_read_b64 v[36:37], v9 offset:512
    ds_read_b64 v[38:39], v9 offset:768
    ds_read_b64 v[40:41], v9 offset:1024
    ds_read_b64 v[42:43], v9 offset:1280
    ds_read_b64 v[44:45], v9 offset:1536
    ds_read_b64 v[46:47], v9 offset:1792
    v_add_u32 v9, 0, v7
    ds_read_b32 v48, v9 offset:0
    ds_read_b32 v49, v9 offset:256
    ds_read_b32 v50, v9 offset:512
    ds_read_b32 v51, v9 offset:768
    ds_read_b32 v52, v9 offset:1024
    ds_read_b32 v53, v9 offset:1280
    ds_read_b32 v54, v9 offset:1536
    ds_read_b32 v55, v9 offset:1792
    s_waitcnt lgkmcnt(8)
    v_perm_b32 v24, v34, v32, s34
    v_accvgpr_write_b32 a0, v24
    v_perm_b32 v25, v38, v36, s34
    v_accvgpr_write_b32 a1, v25
    v_perm_b32 v26, v42, v40, s34
    v_accvgpr_write_b32 a2, v26
    v_perm_b32 v27, v46, v44, s34
    v_accvgpr_write_b32 a3, v27
    v_perm_b32 v28, v34, v32, s35
    v_accvgpr_write_b32 a4, v28
    v_perm_b32 v29, v38, v36, s35
    v_accvgpr_write_b32 a5, v29
    v_perm_b32 v30, v42, v40, s35
    v_accvgpr_write_b32 a6, v30
    v_perm_b32 v31, v46, v44, s35
    v_accvgpr_write_b32 a7, v31
    v_perm_b32 v24, v35, v33, s34
    v_accvgpr_write_b32 a8, v24
    v_perm_b32 v25, v39, v37, s34
    v_accvgpr_write_b32 a9, v25
    v_perm_b32 v26, v43, v41, s34
    v_accvgpr_write_b32 a10, v26
    v_perm_b32 v27, v47, v45, s34
    v_accvgpr_write_b32 a11, v27
    v_perm_b32 v28, v35, v33, s35
    v_accvgpr_write_b32 a12, v28
    v_perm_b32 v29, v39, v37, s35
    v_accvgpr_write_b32 a13, v29
    v_perm_b32 v30, v43, v41, s35
    v_accvgpr_write_b32 a14, v30
    v_perm_b32 v31, v47, v45, s35
    v_accvgpr_write_b32 a15, v31
    s_waitcnt lgkmcnt(0)
    v_perm_b32 v112, v49, v48, s34
    v_perm_b32 v113, v51, v50, s34
    v_perm_b32 v114, v53, v52, s34
    v_perm_b32 v115, v55, v54, s34
    v_perm_b32 v116, v49, v48, s35
    v_perm_b32 v117, v51, v50, s35
    v_perm_b32 v118, v53, v52, s35
    v_perm_b32 v119, v55, v54, s35
    s_waitcnt vmcnt(24)
    s_barrier
    s_lshl_b32 s36, s4, 11
    s_add_u32 m0, s36, 0
    s_mov_b32 s36, 1572864
    buffer_load_dwordx4 v8, s[16:19], s36 offen lds
    s_add_u32 m0, m0, 1024
    s_mov_b32 s36, 1605632
    buffer_load_dwordx4 v8, s[16:19], s36 offen lds
    s_lshl_b32 s36, s4, 11
    s_add_u32 m0, s36, 8192
    s_mov_b32 s36, 1572864
    buffer_load_dwordx4 v8, s[20:23], s36 offen lds
    s_add_u32 m0, m0, 1024
    s_mov_b32 s36, 1605632
    buffer_load_dwordx4 v8, s[20:23], s36 offen lds
    s_lshl_b32 s36, s4, 11
    s_add_u32 m0, s36, 16384
    s_mov_b32 s36, 1572864
    buffer_load_dwordx4 v8, s[24:27], s36 offen lds
    s_add_u32 m0, m0, 1024
    s_mov_b32 s36, 1605632
    buffer_load_dwordx4 v8, s[24:27], s36 offen lds
    v_add_u32 v9, 24576, v6
    ds_read_b64 v[32:33], v9 offset:0
    ds_read_b64 v[34:35], v9 offset:256
    ds_read_b64 v[36:37], v9 offset:512
    ds_read_b64 v[38:39], v9 offset:768
    ds_read_b64 v[40:41], v9 offset:1024
    ds_read_b64 v[42:43], v9 offset:1280
    ds_read_b64 v[44:45], v9 offset:1536
    ds_read_b64 v[46:47], v9 offset:1792
    v_add_u32 v9, 24576, v7
    ds_read_b32 v48, v9 offset:0
    ds_read_b32 v49, v9 offset:256
    ds_read_b32 v50, v9 offset:512
    ds_read_b32 v51, v9 offset:768
    ds_read_b32 v52, v9 offset:1024
    ds_read_b32 v53, v9 offset:1280
    ds_read_b32 v54, v9 offset:1536
    ds_read_b32 v55, v9 offset:1792
    s_waitcnt lgkmcnt(8)
    v_perm_b32 v24, v34, v32, s34
    v_accvgpr_write_b32 a16, v24
    v_perm_b32 v25, v38, v36, s34
    v_accvgpr_write_b32 a17, v25
    v_perm_b32 v26, v42, v40, s34
    v_accvgpr_write_b32 a18, v26
    v_perm_b32 v27, v46, v44, s34
    v_accvgpr_write_b32 a19, v27
    v_perm_b32 v28, v34, v32, s35
    v_accvgpr_write_b32 a20, v28
    v_perm_b32 v29, v38, v36, s35
    v_accvgpr_write_b32 a21, v29
    v_perm_b32 v30, v42, v40, s35
    v_accvgpr_write_b32 a22, v30
    v_perm_b32 v31, v46, v44, s35
    v_accvgpr_write_b32 a23, v31
    v_perm_b32 v24, v35, v33, s34
    v_accvgpr_write_b32 a24, v24
    v_perm_b32 v25, v39, v37, s34
    v_accvgpr_write_b32 a25, v25
    v_perm_b32 v26, v43, v41, s34
    v_accvgpr_write_b32 a26, v26
    v_perm_b32 v27, v47, v45, s34
    v_accvgpr_write_b32 a27, v27
    v_perm_b32 v28, v35, v33, s35
    v_accvgpr_write_b32 a28, v28
    v_perm_b32 v29, v39, v37, s35
    v_accvgpr_write_b32 a29, v29
    v_perm_b32 v30, v43, v41, s35
    v_accvgpr_write_b32 a30, v30
    v_perm_b32 v31, v47, v45, s35
    v_accvgpr_write_b32 a31, v31
    s_waitcnt lgkmcnt(0)
    v_perm_b32 v120, v49, v48, s34
    v_perm_b32 v121, v51, v50, s34
    v_perm_b32 v122, v53, v52, s34
    v_perm_b32 v123, v55, v54, s34
    v_perm_b32 v124, v49, v48, s35
    v_perm_b32 v125, v51, v50, s35
    v_perm_b32 v126, v53, v52, s35
    v_perm_b32 v127, v55, v54, s35
    s_waitcnt vmcnt(24)
    s_barrier
    s_lshl_b32 s36, s4, 11
    s_add_u32 m0, s36, 24576
    s_mov_b32 s36, 1835008
    buffer_load_dwordx4 v8, s[16:19], s36 offen lds
    s_add_u32 m0, m0, 1024
    s_mov_b32 s36, 1867776
    buffer_load_dwordx4 v8, s[16:19], s36 offen lds
    s_lshl_b32 s36, s4, 11
    s_add_u32 m0, s36, 32768
    s_mov_b32 s36, 1835008
    buffer_load_dwordx4 v8, s[20:23], s36 offen lds
    s_add_u32 m0, m0, 1024
    s_mov_b32 s36, 1867776
    buffer_load_dwordx4 v8, s[20:23], s36 offen lds
    s_lshl_b32 s36, s4, 11
    s_add_u32 m0, s36, 40960
    s_mov_b32 s36, 1835008
    buffer_load_dwordx4 v8, s[24:27], s36 offen lds
    s_add_u32 m0, m0, 1024
    s_mov_b32 s36, 1867776
    buffer_load_dwordx4 v8, s[24:27], s36 offen lds
    v_add_u32 v9, 49152, v6
    ds_read_b64 v[32:33], v9 offset:0
    ds_read_b64 v[34:35], v9 offset:256
    ds_read_b64 v[36:37], v9 offset:512
    ds_read_b64 v[38:39], v9 offset:768
    ds_read_b64 v[40:41], v9 offset:1024
    ds_read_b64 v[42:43], v9 offset:1280
    ds_read_b64 v[44:45], v9 offset:1536
    ds_read_b64 v[46:47], v9 offset:1792
    v_add_u32 v9, 49152, v7
    ds_read_b32 v48, v9 offset:0
    ds_read_b32 v49, v9 offset:256
    ds_read_b32 v50, v9 offset:512
    ds_read_b32 v51, v9 offset:768
    ds_read_b32 v52, v9 offset:1024
    ds_read_b32 v53, v9 offset:1280
    ds_read_b32 v54, v9 offset:1536
    ds_read_b32 v55, v9 offset:1792
    s_waitcnt lgkmcnt(8)
    v_perm_b32 v24, v34, v32, s34
    v_accvgpr_write_b32 a32, v24
    v_perm_b32 v25, v38, v36, s34
    v_accvgpr_write_b32 a33, v25
    v_perm_b32 v26, v42, v40, s34
    v_accvgpr_write_b32 a34, v26
    v_perm_b32 v27, v46, v44, s34
    v_accvgpr_write_b32 a35, v27
    v_perm_b32 v28, v34, v32, s35
    v_accvgpr_write_b32 a36, v28
    v_perm_b32 v29, v38, v36, s35
    v_accvgpr_write_b32 a37, v29
    v_perm_b32 v30, v42, v40, s35
    v_accvgpr_write_b32 a38, v30
    v_perm_b32 v31, v46, v44, s35
    v_accvgpr_write_b32 a39, v31
    v_perm_b32 v24, v35, v33, s34
    v_accvgpr_write_b32 a40, v24
    v_perm_b32 v25, v39, v37, s34
    v_accvgpr_write_b32 a41, v25
    v_perm_b32 v26, v43, v41, s34
    v_accvgpr_write_b32 a42, v26
    v_perm_b32 v27, v47, v45, s34
    v_accvgpr_write_b32 a43, v27
    v_perm_b32 v28, v35, v33, s35
    v_accvgpr_write_b32 a44, v28
    v_perm_b32 v29, v39, v37, s35
    v_accvgpr_write_b32 a45, v29
    v_perm_b32 v30, v43, v41, s35
    v_accvgpr_write_b32 a46, v30
    v_perm_b32 v31, v47, v45, s35
    v_accvgpr_write_b32 a47, v31
    s_waitcnt lgkmcnt(0)
    v_perm_b32 v128, v49, v48, s34
    v_perm_b32 v129, v51, v50, s34
    v_perm_b32 v130, v53, v52, s34
    v_perm_b32 v131, v55, v54, s34
    v_perm_b32 v132, v49, v48, s35
    v_perm_b32 v133, v51, v50, s35
    v_perm_b32 v134, v53, v52, s35
    v_perm_b32 v135, v55, v54, s35
    s_waitcnt vmcnt(24)
    s_barrier
    s_lshl_b32 s36, s4, 11
    s_add_u32 m0, s36, 49152
    s_mov_b32 s36, 2097152
    buffer_load_dwordx4 v8, s[16:19], s36 offen lds
    s_add_u32 m0, m0, 1024
    s_mov_b32 s36, 2129920
    buffer_load_dwordx4 v8, s[16:19], s36 offen lds
    s_lshl_b32 s36, s4, 11
    s_add_u32 m0, s36, 57344
    s_mov_b32 s36, 2097152
    buffer_load_dwordx4 v8, s[20:23], s36 offen lds
    s_add_u32 m0, m0, 1024
    s_mov_b32 s36, 2129920
    buffer_load_dwordx4 v8, s[20:23], s36 offen lds
    s_lshl_b32 s36, s4, 11
    s_add_u32 m0, s36, 65536
    s_mov_b32 s36, 2097152
    buffer_load_dwordx4 v8, s[24:27], s36 offen lds
    s_add_u32 m0, m0, 1024
    s_mov_b32 s36, 2129920
    buffer_load_dwordx4 v8, s[24:27], s36 offen lds
    v_add_u32 v9, 73728, v6
    ds_read_b64 v[32:33], v9 offset:0
    ds_read_b64 v[34:35], v9 offset:256
    ds_read_b64 v[36:37], v9 offset:512
    ds_read_b64 v[38:39], v9 offset:768
    ds_read_b64 v[40:41], v9 offset:1024
    ds_read_b64 v[42:43], v9 offset:1280
    ds_read_b64 v[44:45], v9 offset:1536
    ds_read_b64 v[46:47], v9 offset:1792
    v_add_u32 v9, 73728, v7
    ds_read_b32 v48, v9 offset:0
    ds_read_b32 v49, v9 offset:256
    ds_read_b32 v50, v9 offset:512
    ds_read_b32 v51, v9 offset:768
    ds_read_b32 v52, v9 offset:1024
    ds_read_b32 v53, v9 offset:1280
    ds_read_b32 v54, v9 offset:1536
    ds_read_b32 v55, v9 offset:1792
    s_waitcnt lgkmcnt(8)
    v_perm_b32 v24, v34, v32, s34
    v_accvgpr_write_b32 a48, v24
    v_perm_b32 v25, v38, v36, s34
    v_accvgpr_write_b32 a49, v25
    v_perm_b32 v26, v42, v40, s34
    v_accvgpr_write_b32 a50, v26
    v_perm_b32 v27, v46, v44, s34
    v_accvgpr_write_b32 a51, v27
    v_perm_b32 v28, v34, v32, s35
    v_accvgpr_write_b32 a52, v28
    v_perm_b32 v29, v38, v36, s35
    v_accvgpr_write_b32 a53, v29
    v_perm_b32 v30, v42, v40, s35
    v_accvgpr_write_b32 a54, v30
    v_perm_b32 v31, v46, v44, s35
    v_accvgpr_write_b32 a55, v31
    v_perm_b32 v24, v35, v33, s34
    v_accvgpr_write_b32 a56, v24
    v_perm_b32 v25, v39, v37, s34
    v_accvgpr_write_b32 a57, v25
    v_perm_b32 v26, v43, v41, s34
    v_accvgpr_write_b32 a58, v26
    v_perm_b32 v27, v47, v45, s34
    v_accvgpr_write_b32 a59, v27
    v_perm_b32 v28, v35, v33, s35
    v_accvgpr_write_b32 a60, v28
    v_perm_b32 v29, v39, v37, s35
    v_accvgpr_write_b32 a61, v29
    v_perm_b32 v30, v43, v41, s35
    v_accvgpr_write_b32 a62, v30
    v_perm_b32 v31, v47, v45, s35
    v_accvgpr_write_b32 a63, v31
    s_waitcnt lgkmcnt(0)
    v_perm_b32 v136, v49, v48, s34
    v_perm_b32 v137, v51, v50, s34
    v_perm_b32 v138, v53, v52, s34
    v_perm_b32 v139, v55, v54, s34
    v_perm_b32 v140, v49, v48, s35
    v_perm_b32 v141, v51, v50, s35
    v_perm_b32 v142, v53, v52, s35
    v_perm_b32 v143, v55, v54, s35
    s_waitcnt vmcnt(24)
    s_barrier
    s_lshl_b32 s36, s4, 11
    s_add_u32 m0, s36, 73728
    s_mov_b32 s36, 2359296
    buffer_load_dwordx4 v8, s[16:19], s36 offen lds
    s_add_u32 m0, m0, 1024
    s_mov_b32 s36, 2392064
    buffer_load_dwordx4 v8, s[16:19], s36 offen lds
    s_lshl_b32 s36, s4, 11
    s_add_u32 m0, s36, 81920
    s_mov_b32 s36, 2359296
    buffer_load_dwordx4 v8, s[20:23], s36 offen lds
    s_add_u32 m0, m0, 1024
    s_mov_b32 s36, 2392064
    buffer_load_dwordx4 v8, s[20:23], s36 offen lds
    s_lshl_b32 s36, s4, 11
    s_add_u32 m0, s36, 90112
    s_mov_b32 s36, 2359296
    buffer_load_dwordx4 v8, s[24:27], s36 offen lds
    s_add_u32 m0, m0, 1024
    s_mov_b32 s36, 2392064
    buffer_load_dwordx4 v8, s[24:27], s36 offen lds
    v_add_u32 v9, 98304, v6
    ds_read_b64 v[32:33], v9 offset:0
    ds_read_b64 v[34:35], v9 offset:256
    ds_read_b64 v[36:37], v9 offset:512
    ds_read_b64 v[38:39], v9 offset:768
    ds_read_b64 v[40:41], v9 offset:1024
    ds_read_b64 v[42:43], v9 offset:1280
    ds_read_b64 v[44:45], v9 offset:1536
    ds_read_b64 v[46:47], v9 offset:1792
    v_add_u32 v9, 98304, v7
    ds_read_b32 v48, v9 offset:0
    ds_read_b32 v49, v9 offset:256
    ds_read_b32 v50, v9 offset:512
    ds_read_b32 v51, v9 offset:768
    ds_read_b32 v52, v9 offset:1024
    ds_read_b32 v53, v9 offset:1280
    ds_read_b32 v54, v9 offset:1536
    ds_read_b32 v55, v9 offset:1792
    s_waitcnt lgkmcnt(8)
    v_perm_b32 v24, v34, v32, s34
    v_accvgpr_write_b32 a64, v24
    v_perm_b32 v25, v38, v36, s34
    v_accvgpr_write_b32 a65, v25
    v_perm_b32 v26, v42, v40, s34
    v_accvgpr_write_b32 a66, v26
    v_perm_b32 v27, v46, v44, s34
    v_accvgpr_write_b32 a67, v27
    v_perm_b32 v28, v34, v32, s35
    v_accvgpr_write_b32 a68, v28
    v_perm_b32 v29, v38, v36, s35
    v_accvgpr_write_b32 a69, v29
    v_perm_b32 v30, v42, v40, s35
    v_accvgpr_write_b32 a70, v30
    v_perm_b32 v31, v46, v44, s35
    v_accvgpr_write_b32 a71, v31
    v_perm_b32 v24, v35, v33, s34
    v_accvgpr_write_b32 a72, v24
    v_perm_b32 v25, v39, v37, s34
    v_accvgpr_write_b32 a73, v25
    v_perm_b32 v26, v43, v41, s34
    v_accvgpr_write_b32 a74, v26
    v_perm_b32 v27, v47, v45, s34
    v_accvgpr_write_b32 a75, v27
    v_perm_b32 v28, v35, v33, s35
    v_accvgpr_write_b32 a76, v28
    v_perm_b32 v29, v39, v37, s35
    v_accvgpr_write_b32 a77, v29
    v_perm_b32 v30, v43, v41, s35
    v_accvgpr_write_b32 a78, v30
    v_perm_b32 v31, v47, v45, s35
    v_accvgpr_write_b32 a79, v31
    s_waitcnt lgkmcnt(0)
    v_perm_b32 v144, v49, v48, s34
    v_perm_b32 v145, v51, v50, s34
    v_perm_b32 v146, v53, v52, s34
    v_perm_b32 v147, v55, v54, s34
    v_perm_b32 v148, v49, v48, s35
    v_perm_b32 v149, v51, v50, s35
    v_perm_b32 v150, v53, v52, s35
    v_perm_b32 v151, v55, v54, s35
    s_waitcnt vmcnt(24)
    s_barrier
    s_lshl_b32 s36, s4, 11
    s_add_u32 m0, s36, 98304
    s_mov_b32 s36, 2621440
    buffer_load_dwordx4 v8, s[16:19], s36 offen lds
    s_add_u32 m0, m0, 1024
    s_mov_b32 s36, 2654208
    buffer_load_dwordx4 v8, s[16:19], s36 offen lds
    s_lshl_b32 s36, s4, 11
    s_add_u32 m0, s36, 106496
    s_mov_b32 s36, 2621440
    buffer_load_dwordx4 v8, s[20:23], s36 offen lds
    s_add_u32 m0, m0, 1024
    s_mov_b32 s36, 2654208
    buffer_load_dwordx4 v8, s[20:23], s36 offen lds
    s_lshl_b32 s36, s4, 11
    s_add_u32 m0, s36, 114688
    s_mov_b32 s36, 2621440
    buffer_load_dwordx4 v8, s[24:27], s36 offen lds
    s_add_u32 m0, m0, 1024
    s_mov_b32 s36, 2654208
    buffer_load_dwordx4 v8, s[24:27], s36 offen lds
    v_add_u32 v9, 122880, v6
    ds_read_b64 v[32:33], v9 offset:0
    ds_read_b64 v[34:35], v9 offset:256
    ds_read_b64 v[36:37], v9 offset:512
    ds_read_b64 v[38:39], v9 offset:768
    ds_read_b64 v[40:41], v9 offset:1024
    ds_read_b64 v[42:43], v9 offset:1280
    ds_read_b64 v[44:45], v9 offset:1536
    ds_read_b64 v[46:47], v9 offset:1792
    v_add_u32 v9, 122880, v7
    ds_read_b32 v48, v9 offset:0
    ds_read_b32 v49, v9 offset:256
    ds_read_b32 v50, v9 offset:512
    ds_read_b32 v51, v9 offset:768
    ds_read_b32 v52, v9 offset:1024
    ds_read_b32 v53, v9 offset:1280
    ds_read_b32 v54, v9 offset:1536
    ds_read_b32 v55, v9 offset:1792
    s_waitcnt lgkmcnt(8)
    v_perm_b32 v24, v34, v32, s34
    v_accvgpr_write_b32 a80, v24
    v_perm_b32 v25, v38, v36, s34
    v_accvgpr_write_b32 a81, v25
    v_perm_b32 v26, v42, v40, s34
    v_accvgpr_write_b32 a82, v26
    v_perm_b32 v27, v46, v44, s34
    v_accvgpr_write_b32 a83, v27
    v_perm_b32 v28, v34, v32, s35
    v_accvgpr_write_b32 a84, v28
    v_perm_b32 v29, v38, v36, s35
    v_accvgpr_write_b32 a85, v29
    v_perm_b32 v30, v42, v40, s35
    v_accvgpr_write_b32 a86, v30
    v_perm_b32 v31, v46, v44, s35
    v_accvgpr_write_b32 a87, v31
    v_perm_b32 v24, v35, v33, s34
    v_accvgpr_write_b32 a88, v24
    v_perm_b32 v25, v39, v37, s34
    v_accvgpr_write_b32 a89, v25
    v_perm_b32 v26, v43, v41, s34
    v_accvgpr_write_b32 a90, v26
    v_perm_b32 v27, v47, v45, s34
    v_accvgpr_write_b32 a91, v27
    v_perm_b32 v28, v35, v33, s35
    v_accvgpr_write_b32 a92, v28
    v_perm_b32 v29, v39, v37, s35
    v_accvgpr_write_b32 a93, v29
    v_perm_b32 v30, v43, v41, s35
    v_accvgpr_write_b32 a94, v30
    v_perm_b32 v31, v47, v45, s35
    v_accvgpr_write_b32 a95, v31
    s_waitcnt lgkmcnt(0)
    v_perm_b32 v152, v49, v48, s34
    v_perm_b32 v153, v51, v50, s34
    v_perm_b32 v154, v53, v52, s34
    v_perm_b32 v155, v55, v54, s34
    v_perm_b32 v156, v49, v48, s35
    v_perm_b32 v157, v51, v50, s35
    v_perm_b32 v158, v53, v52, s35
    v_perm_b32 v159, v55, v54, s35
    s_waitcnt vmcnt(24)
    s_barrier
    s_lshl_b32 s36, s4, 11
    s_add_u32 m0, s36, 122880
    s_mov_b32 s36, 2883584
    buffer_load_dwordx4 v8, s[16:19], s36 offen lds
    s_add_u32 m0, m0, 1024
    s_mov_b32 s36, 2916352
    buffer_load_dwordx4 v8, s[16:19], s36 offen lds
    s_lshl_b32 s36, s4, 11
    s_add_u32 m0, s36, 131072
    s_mov_b32 s36, 2883584
    buffer_load_dwordx4 v8, s[20:23], s36 offen lds
    s_add_u32 m0, m0, 1024
    s_mov_b32 s36, 2916352
    buffer_load_dwordx4 v8, s[20:23], s36 offen lds
    s_lshl_b32 s36, s4, 11
    s_add_u32 m0, s36, 139264
    s_mov_b32 s36, 2883584
    buffer_load_dwordx4 v8, s[24:27], s36 offen lds
    s_add_u32 m0, m0, 1024
    s_mov_b32 s36, 2916352
    buffer_load_dwordx4 v8, s[24:27], s36 offen lds
    v_add_u32 v9, 0, v6
    ds_read_b64 v[32:33], v9 offset:0
    ds_read_b64 v[34:35], v9 offset:256
    ds_read_b64 v[36:37], v9 offset:512
    ds_read_b64 v[38:39], v9 offset:768
    ds_read_b64 v[40:41], v9 offset:1024
    ds_read_b64 v[42:43], v9 offset:1280
    ds_read_b64 v[44:45], v9 offset:1536
    ds_read_b64 v[46:47], v9 offset:1792
    v_add_u32 v9, 0, v7
    ds_read_b32 v48, v9 offset:0
    ds_read_b32 v49, v9 offset:256
    ds_read_b32 v50, v9 offset:512
    ds_read_b32 v51, v9 offset:768
    ds_read_b32 v52, v9 offset:1024
    ds_read_b32 v53, v9 offset:1280
    ds_read_b32 v54, v9 offset:1536
    ds_read_b32 v55, v9 offset:1792
    s_waitcnt lgkmcnt(8)
    v_perm_b32 v24, v34, v32, s34
    v_accvgpr_write_b32 a96, v24
    v_perm_b32 v25, v38, v36, s34
    v_accvgpr_write_b32 a97, v25
    v_perm_b32 v26, v42, v40, s34
    v_accvgpr_write_b32 a98, v26
    v_perm_b32 v27, v46, v44, s34
    v_accvgpr_write_b32 a99, v27
    v_perm_b32 v28, v34, v32, s35
    v_accvgpr_write_b32 a100, v28
    v_perm_b32 v29, v38, v36, s35
    v_accvgpr_write_b32 a101, v29
    v_perm_b32 v30, v42, v40, s35
    v_accvgpr_write_b32 a102, v30
    v_perm_b32 v31, v46, v44, s35
    v_accvgpr_write_b32 a103, v31
    v_perm_b32 v24, v35, v33, s34
    v_accvgpr_write_b32 a104, v24
    v_perm_b32 v25, v39, v37, s34
    v_accvgpr_write_b32 a105, v25
    v_perm_b32 v26, v43, v41, s34
    v_accvgpr_write_b32 a106, v26
    v_perm_b32 v27, v47, v45, s34
    v_accvgpr_write_b32 a107, v27
    v_perm_b32 v28, v35, v33, s35
    v_accvgpr_write_b32 a108, v28
    v_perm_b32 v29, v39, v37, s35
    v_accvgpr_write_b32 a109, v29
    v_perm_b32 v30, v43, v41, s35
    v_accvgpr_write_b32 a110, v30
    v_perm_b32 v31, v47, v45, s35
    v_accvgpr_write_b32 a111, v31
    s_waitcnt lgkmcnt(0)
    v_perm_b32 v160, v49, v48, s34
    v_perm_b32 v161, v51, v50, s34
    v_perm_b32 v162, v53, v52, s34
    v_perm_b32 v163, v55, v54, s34
    v_perm_b32 v164, v49, v48, s35
    v_perm_b32 v165, v51, v50, s35
    v_perm_b32 v166, v53, v52, s35
    v_perm_b32 v167, v55, v54, s35
    s_waitcnt vmcnt(24)
    s_barrier
    buffer_load_dword v61, off, s[12:15], 0 offset:64 sc1
    s_lshl_b32 s36, s4, 11
    s_add_u32 m0, s36, 0
    s_mov_b32 s36, 3145728
    buffer_load_dwordx4 v8, s[16:19], s36 offen lds
    s_add_u32 m0, m0, 1024
    s_mov_b32 s36, 3178496
    buffer_load_dwordx4 v8, s[16:19], s36 offen lds
    s_lshl_b32 s36, s4, 11
    s_add_u32 m0, s36, 8192
    s_mov_b32 s36, 3145728
    buffer_load_dwordx4 v8, s[20:23], s36 offen lds
    s_add_u32 m0, m0, 1024
    s_mov_b32 s36, 3178496
    buffer_load_dwordx4 v8, s[20:23], s36 offen lds
    s_lshl_b32 s36, s4, 11
    s_add_u32 m0, s36, 16384
    s_mov_b32 s36, 3145728
    buffer_load_dwordx4 v8, s[24:27], s36 offen lds
    s_add_u32 m0, m0, 1024
    s_mov_b32 s36, 3178496
    buffer_load_dwordx4 v8, s[24:27], s36 offen lds
    v_add_u32 v9, 24576, v6
    ds_read_b64 v[32:33], v9 offset:0
    ds_read_b64 v[34:35], v9 offset:256
    ds_read_b64 v[36:37], v9 offset:512
    ds_read_b64 v[38:39], v9 offset:768
    ds_read_b64 v[40:41], v9 offset:1024
    ds_read_b64 v[42:43], v9 offset:1280
    ds_read_b64 v[44:45], v9 offset:1536
    ds_read_b64 v[46:47], v9 offset:1792
    v_add_u32 v9, 24576, v7
    ds_read_b32 v48, v9 offset:0
    ds_read_b32 v49, v9 offset:256
    ds_read_b32 v50, v9 offset:512
    ds_read_b32 v51, v9 offset:768
    ds_read_b32 v52, v9 offset:1024
    ds_read_b32 v53, v9 offset:1280
    ds_read_b32 v54, v9 offset:1536
    ds_read_b32 v55, v9 offset:1792
    s_waitcnt lgkmcnt(8)
    v_perm_b32 v24, v34, v32, s34
    v_accvgpr_write_b32 a112, v24
    v_perm_b32 v25, v38, v36, s34
    v_accvgpr_write_b32 a113, v25
    v_perm_b32 v26, v42, v40, s34
    v_accvgpr_write_b32 a114, v26
    v_perm_b32 v27, v46, v44, s34
    v_accvgpr_write_b32 a115, v27
    v_perm_b32 v28, v34, v32, s35
    v_accvgpr_write_b32 a116, v28
    v_perm_b32 v29, v38, v36, s35
    v_accvgpr_write_b32 a117, v29
    v_perm_b32 v30, v42, v40, s35
    v_accvgpr_write_b32 a118, v30
    v_perm_b32 v31, v46, v44, s35
    v_accvgpr_write_b32 a119, v31
    v_perm_b32 v24, v35, v33, s34
    v_accvgpr_write_b32 a120, v24
    v_perm_b32 v25, v39, v37, s34
    v_accvgpr_write_b32 a121, v25
    v_perm_b32 v26, v43, v41, s34
    v_accvgpr_write_b32 a122, v26
    v_perm_b32 v27, v47, v45, s34
    v_accvgpr_write_b32 a123, v27
    v_perm_b32 v28, v35, v33, s35
    v_accvgpr_write_b32 a124, v28
    v_perm_b32 v29, v39, v37, s35
    v_accvgpr_write_b32 a125, v29
    v_perm_b32 v30, v43, v41, s35
    v_accvgpr_write_b32 a126, v30
    v_perm_b32 v31, v47, v45, s35
    v_accvgpr_write_b32 a127, v31
    s_waitcnt lgkmcnt(0)
    v_perm_b32 v168, v49, v48, s34
    v_perm_b32 v169, v51, v50, s34
    v_perm_b32 v170, v53, v52, s34
    v_perm_b32 v171, v55, v54, s34
    v_perm_b32 v172, v49, v48, s35
    v_perm_b32 v173, v51, v50, s35
    v_perm_b32 v174, v53, v52, s35
    v_perm_b32 v175, v55, v54, s35
    s_waitcnt vmcnt(25)
    s_barrier
    s_lshl_b32 s36, s4, 11
    s_add_u32 m0, s36, 24576
    s_mov_b32 s36, 3407872
    buffer_load_dwordx4 v8, s[16:19], s36 offen lds
    s_add_u32 m0, m0, 1024
    s_mov_b32 s36, 3440640
    buffer_load_dwordx4 v8, s[16:19], s36 offen lds
    s_lshl_b32 s36, s4, 11
    s_add_u32 m0, s36, 32768
    s_mov_b32 s36, 3407872
    buffer_load_dwordx4 v8, s[20:23], s36 offen lds
    s_add_u32 m0, m0, 1024
    s_mov_b32 s36, 3440640
    buffer_load_dwordx4 v8, s[20:23], s36 offen lds
    s_lshl_b32 s36, s4, 11
    s_add_u32 m0, s36, 40960
    s_mov_b32 s36, 3407872
    buffer_load_dwordx4 v8, s[24:27], s36 offen lds
    s_add_u32 m0, m0, 1024
    s_mov_b32 s36, 3440640
    buffer_load_dwordx4 v8, s[24:27], s36 offen lds
    v_add_u32 v9, 49152, v6
    ds_read_b64 v[32:33], v9 offset:0
    ds_read_b64 v[34:35], v9 offset:256
    ds_read_b64 v[36:37], v9 offset:512
    ds_read_b64 v[38:39], v9 offset:768
    ds_read_b64 v[40:41], v9 offset:1024
    ds_read_b64 v[42:43], v9 offset:1280
    ds_read_b64 v[44:45], v9 offset:1536
    ds_read_b64 v[46:47], v9 offset:1792
    v_add_u32 v9, 49152, v7
    ds_read_b32 v48, v9 offset:0
    ds_read_b32 v49, v9 offset:256
    ds_read_b32 v50, v9 offset:512
    ds_read_b32 v51, v9 offset:768
    ds_read_b32 v52, v9 offset:1024
    ds_read_b32 v53, v9 offset:1280
    ds_read_b32 v54, v9 offset:1536
    ds_read_b32 v55, v9 offset:1792
    s_waitcnt lgkmcnt(8)
    v_perm_b32 v24, v34, v32, s34
    v_accvgpr_write_b32 a128, v24
    v_perm_b32 v25, v38, v36, s34
    v_accvgpr_write_b32 a129, v25
    v_perm_b32 v26, v42, v40, s34
    v_accvgpr_write_b32 a130, v26
    v_perm_b32 v27, v46, v44, s34
    v_accvgpr_write_b32 a131, v27
    v_perm_b32 v28, v34, v32, s35
    v_accvgpr_write_b32 a132, v28
    v_perm_b32 v29, v38, v36, s35
    v_accvgpr_write_b32 a133, v29
    v_perm_b32 v30, v42, v40, s35
    v_accvgpr_write_b32 a134, v30
    v_perm_b32 v31, v46, v44, s35
    v_accvgpr_write_b32 a135, v31
    v_perm_b32 v24, v35, v33, s34
    v_accvgpr_write_b32 a136, v24
    v_perm_b32 v25, v39, v37, s34
    v_accvgpr_write_b32 a137, v25
    v_perm_b32 v26, v43, v41, s34
    v_accvgpr_write_b32 a138, v26
    v_perm_b32 v27, v47, v45, s34
    v_accvgpr_write_b32 a139, v27
    v_perm_b32 v28, v35, v33, s35
    v_accvgpr_write_b32 a140, v28
    v_perm_b32 v29, v39, v37, s35
    v_accvgpr_write_b32 a141, v29
    v_perm_b32 v30, v43, v41, s35
    v_accvgpr_write_b32 a142, v30
    v_perm_b32 v31, v47, v45, s35
    v_accvgpr_write_b32 a143, v31
    s_waitcnt lgkmcnt(0)
    v_perm_b32 v176, v49, v48, s34
    v_perm_b32 v177, v51, v50, s34
    v_perm_b32 v178, v53, v52, s34
    v_perm_b32 v179, v55, v54, s34
    v_perm_b32 v180, v49, v48, s35
    v_perm_b32 v181, v51, v50, s35
    v_perm_b32 v182, v53, v52, s35
    v_perm_b32 v183, v55, v54, s35
    s_waitcnt vmcnt(25)
    s_barrier
    s_lshl_b32 s36, s4, 11
    s_add_u32 m0, s36, 49152
    s_mov_b32 s36, 3670016
    buffer_load_dwordx4 v8, s[16:19], s36 offen lds
    s_add_u32 m0, m0, 1024
    s_mov_b32 s36, 3702784
    buffer_load_dwordx4 v8, s[16:19], s36 offen lds
    s_lshl_b32 s36, s4, 11
    s_add_u32 m0, s36, 57344
    s_mov_b32 s36, 3670016
    buffer_load_dwordx4 v8, s[20:23], s36 offen lds
    s_add_u32 m0, m0, 1024
    s_mov_b32 s36, 3702784
    buffer_load_dwordx4 v8, s[20:23], s36 offen lds
    s_lshl_b32 s36, s4, 11
    s_add_u32 m0, s36, 65536
    s_mov_b32 s36, 3670016
    buffer_load_dwordx4 v8, s[24:27], s36 offen lds
    s_add_u32 m0, m0, 1024
    s_mov_b32 s36, 3702784
    buffer_load_dwordx4 v8, s[24:27], s36 offen lds
    v_add_u32 v9, 73728, v6
    ds_read_b64 v[32:33], v9 offset:0
    ds_read_b64 v[34:35], v9 offset:256
    ds_read_b64 v[36:37], v9 offset:512
    ds_read_b64 v[38:39], v9 offset:768
    ds_read_b64 v[40:41], v9 offset:1024
    ds_read_b64 v[42:43], v9 offset:1280
    ds_read_b64 v[44:45], v9 offset:1536
    ds_read_b64 v[46:47], v9 offset:1792
    v_add_u32 v9, 73728, v7
    ds_read_b32 v48, v9 offset:0
    ds_read_b32 v49, v9 offset:256
    ds_read_b32 v50, v9 offset:512
    ds_read_b32 v51, v9 offset:768
    ds_read_b32 v52, v9 offset:1024
    ds_read_b32 v53, v9 offset:1280
    ds_read_b32 v54, v9 offset:1536
    ds_read_b32 v55, v9 offset:1792
    s_waitcnt lgkmcnt(8)
    v_perm_b32 v24, v34, v32, s34
    v_accvgpr_write_b32 a144, v24
    v_perm_b32 v25, v38, v36, s34
    v_accvgpr_write_b32 a145, v25
    v_perm_b32 v26, v42, v40, s34
    v_accvgpr_write_b32 a146, v26
    v_perm_b32 v27, v46, v44, s34
    v_accvgpr_write_b32 a147, v27
    v_perm_b32 v28, v34, v32, s35
    v_accvgpr_write_b32 a148, v28
    v_perm_b32 v29, v38, v36, s35
    v_accvgpr_write_b32 a149, v29
    v_perm_b32 v30, v42, v40, s35
    v_accvgpr_write_b32 a150, v30
    v_perm_b32 v31, v46, v44, s35
    v_accvgpr_write_b32 a151, v31
    v_perm_b32 v24, v35, v33, s34
    v_accvgpr_write_b32 a152, v24
    v_perm_b32 v25, v39, v37, s34
    v_accvgpr_write_b32 a153, v25
    v_perm_b32 v26, v43, v41, s34
    v_accvgpr_write_b32 a154, v26
    v_perm_b32 v27, v47, v45, s34
    v_accvgpr_write_b32 a155, v27
    v_perm_b32 v28, v35, v33, s35
    v_accvgpr_write_b32 a156, v28
    v_perm_b32 v29, v39, v37, s35
    v_accvgpr_write_b32 a157, v29
    v_perm_b32 v30, v43, v41, s35
    v_accvgpr_write_b32 a158, v30
    v_perm_b32 v31, v47, v45, s35
    v_accvgpr_write_b32 a159, v31
    s_waitcnt lgkmcnt(0)
    v_perm_b32 v184, v49, v48, s34
    v_perm_b32 v185, v51, v50, s34
    v_perm_b32 v186, v53, v52, s34
    v_perm_b32 v187, v55, v54, s34
    v_perm_b32 v188, v49, v48, s35
    v_perm_b32 v189, v51, v50, s35
    v_perm_b32 v190, v53, v52, s35
    v_perm_b32 v191, v55, v54, s35
    s_waitcnt vmcnt(25)
    s_barrier
    s_lshl_b32 s36, s4, 11
    s_add_u32 m0, s36, 73728
    s_mov_b32 s36, 3932160
    buffer_load_dwordx4 v8, s[16:19], s36 offen lds
    s_add_u32 m0, m0, 1024
    s_mov_b32 s36, 3964928
    buffer_load_dwordx4 v8, s[16:19], s36 offen lds
    s_lshl_b32 s36, s4, 11
    s_add_u32 m0, s36, 81920
    s_mov_b32 s36, 3932160
    buffer_load_dwordx4 v8, s[20:23], s36 offen lds
    s_add_u32 m0, m0, 1024
    s_mov_b32 s36, 3964928
    buffer_load_dwordx4 v8, s[20:23], s36 offen lds
    s_lshl_b32 s36, s4, 11
    s_add_u32 m0, s36, 90112
    s_mov_b32 s36, 3932160
    buffer_load_dwordx4 v8, s[24:27], s36 offen lds
    s_add_u32 m0, m0, 1024
    s_mov_b32 s36, 3964928
    buffer_load_dwordx4 v8, s[24:27], s36 offen lds
    v_add_u32 v9, 98304, v6
    ds_read_b64 v[32:33], v9 offset:0
    ds_read_b64 v[34:35], v9 offset:256
    ds_read_b64 v[36:37], v9 offset:512
    ds_read_b64 v[38:39], v9 offset:768
    ds_read_b64 v[40:41], v9 offset:1024
    ds_read_b64 v[42:43], v9 offset:1280
    ds_read_b64 v[44:45], v9 offset:1536
    ds_read_b64 v[46:47], v9 offset:1792
    v_add_u32 v9, 98304, v7
    ds_read_b32 v48, v9 offset:0
    ds_read_b32 v49, v9 offset:256
    ds_read_b32 v50, v9 offset:512
    ds_read_b32 v51, v9 offset:768
    ds_read_b32 v52, v9 offset:1024
    ds_read_b32 v53, v9 offset:1280
    ds_read_b32 v54, v9 offset:1536
    ds_read_b32 v55, v9 offset:1792
    s_waitcnt lgkmcnt(8)
    v_perm_b32 v24, v34, v32, s34
    v_accvgpr_write_b32 a160, v24
    v_perm_b32 v25, v38, v36, s34
    v_accvgpr_write_b32 a161, v25
    v_perm_b32 v26, v42, v40, s34
    v_accvgpr_write_b32 a162, v26
    v_perm_b32 v27, v46, v44, s34
    v_accvgpr_write_b32 a163, v27
    v_perm_b32 v28, v34, v32, s35
    v_accvgpr_write_b32 a164, v28
    v_perm_b32 v29, v38, v36, s35
    v_accvgpr_write_b32 a165, v29
    v_perm_b32 v30, v42, v40, s35
    v_accvgpr_write_b32 a166, v30
    v_perm_b32 v31, v46, v44, s35
    v_accvgpr_write_b32 a167, v31
    v_perm_b32 v24, v35, v33, s34
    v_accvgpr_write_b32 a168, v24
    v_perm_b32 v25, v39, v37, s34
    v_accvgpr_write_b32 a169, v25
    v_perm_b32 v26, v43, v41, s34
    v_accvgpr_write_b32 a170, v26
    v_perm_b32 v27, v47, v45, s34
    v_accvgpr_write_b32 a171, v27
    v_perm_b32 v28, v35, v33, s35
    v_accvgpr_write_b32 a172, v28
    v_perm_b32 v29, v39, v37, s35
    v_accvgpr_write_b32 a173, v29
    v_perm_b32 v30, v43, v41, s35
    v_accvgpr_write_b32 a174, v30
    v_perm_b32 v31, v47, v45, s35
    v_accvgpr_write_b32 a175, v31
    s_waitcnt lgkmcnt(0)
    v_perm_b32 v192, v49, v48, s34
    v_perm_b32 v193, v51, v50, s34
    v_perm_b32 v194, v53, v52, s34
    v_perm_b32 v195, v55, v54, s34
    v_perm_b32 v196, v49, v48, s35
    v_perm_b32 v197, v51, v50, s35
    v_perm_b32 v198, v53, v52, s35
    v_perm_b32 v199, v55, v54, s35
    s_waitcnt vmcnt(25)
    s_barrier
    s_lshl_b32 s36, s4, 11
    s_add_u32 m0, s36, 98304
    s_mov_b32 s36, 4194304
    buffer_load_dwordx4 v8, s[16:19], s36 offen lds
    s_add_u32 m0, m0, 1024
    s_mov_b32 s36, 4227072
    buffer_load_dwordx4 v8, s[16:19], s36 offen lds
    s_lshl_b32 s36, s4, 11
    s_add_u32 m0, s36, 106496
    s_mov_b32 s36, 4194304
    buffer_load_dwordx4 v8, s[20:23], s36 offen lds
    s_add_u32 m0, m0, 1024
    s_mov_b32 s36, 4227072
    buffer_load_dwordx4 v8, s[20:23], s36 offen lds
    s_lshl_b32 s36, s4, 11
    s_add_u32 m0, s36, 114688
    s_mov_b32 s36, 4194304
    buffer_load_dwordx4 v8, s[24:27], s36 offen lds
    s_add_u32 m0, m0, 1024
    s_mov_b32 s36, 4227072
    buffer_load_dwordx4 v8, s[24:27], s36 offen lds
    v_add_u32 v9, 122880, v6
    ds_read_b64 v[32:33], v9 offset:0
    ds_read_b64 v[34:35], v9 offset:256
    ds_read_b64 v[36:37], v9 offset:512
    ds_read_b64 v[38:39], v9 offset:768
    ds_read_b64 v[40:41], v9 offset:1024
    ds_read_b64 v[42:43], v9 offset:1280
    ds_read_b64 v[44:45], v9 offset:1536
    ds_read_b64 v[46:47], v9 offset:1792
    v_add_u32 v9, 122880, v7
    ds_read_b32 v48, v9 offset:0
    ds_read_b32 v49, v9 offset:256
    ds_read_b32 v50, v9 offset:512
    ds_read_b32 v51, v9 offset:768
    ds_read_b32 v52, v9 offset:1024
    ds_read_b32 v53, v9 offset:1280
    ds_read_b32 v54, v9 offset:1536
    ds_read_b32 v55, v9 offset:1792
    s_waitcnt lgkmcnt(8)
    v_perm_b32 v24, v34, v32, s34
    v_accvgpr_write_b32 a176, v24
    v_perm_b32 v25, v38, v36, s34
    v_accvgpr_write_b32 a177, v25
    v_perm_b32 v26, v42, v40, s34
    v_accvgpr_write_b32 a178, v26
    v_perm_b32 v27, v46, v44, s34
    v_accvgpr_write_b32 a179, v27
    v_perm_b32 v28, v34, v32, s35
    v_accvgpr_write_b32 a180, v28
    v_perm_b32 v29, v38, v36, s35
    v_accvgpr_write_b32 a181, v29
    v_perm_b32 v30, v42, v40, s35
    v_accvgpr_write_b32 a182, v30
    v_perm_b32 v31, v46, v44, s35
    v_accvgpr_write_b32 a183, v31
    v_perm_b32 v24, v35, v33, s34
    v_accvgpr_write_b32 a184, v24
    v_perm_b32 v25, v39, v37, s34
    v_accvgpr_write_b32 a185, v25
    v_perm_b32 v26, v43, v41, s34
    v_accvgpr_write_b32 a186, v26
    v_perm_b32 v27, v47, v45, s34
    v_accvgpr_write_b32 a187, v27
    v_perm_b32 v28, v35, v33, s35
    v_accvgpr_write_b32 a188, v28
    v_perm_b32 v29, v39, v37, s35
    v_accvgpr_write_b32 a189, v29
    v_perm_b32 v30, v43, v41, s35
    v_accvgpr_write_b32 a190, v30
    v_perm_b32 v31, v47, v45, s35
    v_accvgpr_write_b32 a191, v31
    s_waitcnt lgkmcnt(0)
    v_perm_b32 v200, v49, v48, s34
    v_perm_b32 v201, v51, v50, s34
    v_perm_b32 v202, v53, v52, s34
    v_perm_b32 v203, v55, v54, s34
    v_perm_b32 v204, v49, v48, s35
    v_perm_b32 v205, v51, v50, s35
    v_perm_b32 v206, v53, v52, s35
    v_perm_b32 v207, v55, v54, s35
    s_waitcnt vmcnt(24)
    s_barrier
    s_mov_b32 s38, 0x1f2000
    buffer_load_dword v62, v60, s[8:11], s38 offen sc1
    s_mov_b32 s38, 0x1f4000
    buffer_load_dword v63, v60, s[8:11], s38 offen sc1
    s_lshl_b32 s36, s4, 11
    s_add_u32 m0, s36, 122880
    s_mov_b32 s36, 4456448
    buffer_load_dwordx4 v8, s[16:19], s36 offen lds
    s_add_u32 m0, m0, 1024
    s_mov_b32 s36, 4489216
    buffer_load_dwordx4 v8, s[16:19], s36 offen lds
    s_lshl_b32 s36, s4, 11
    s_add_u32 m0, s36, 131072
    s_mov_b32 s36, 4456448
    buffer_load_dwordx4 v8, s[20:23], s36 offen lds
    s_add_u32 m0, m0, 1024
    s_mov_b32 s36, 4489216
    buffer_load_dwordx4 v8, s[20:23], s36 offen lds
    s_lshl_b32 s36, s4, 11
    s_add_u32 m0, s36, 139264
    s_mov_b32 s36, 4456448
    buffer_load_dwordx4 v8, s[24:27], s36 offen lds
    s_add_u32 m0, m0, 1024
    s_mov_b32 s36, 4489216
    buffer_load_dwordx4 v8, s[24:27], s36 offen lds
    v_add_u32 v9, 0, v6
    ds_read_b64 v[32:33], v9 offset:0
    ds_read_b64 v[34:35], v9 offset:256
    ds_read_b64 v[36:37], v9 offset:512
    ds_read_b64 v[38:39], v9 offset:768
    ds_read_b64 v[40:41], v9 offset:1024
    ds_read_b64 v[42:43], v9 offset:1280
    ds_read_b64 v[44:45], v9 offset:1536
    ds_read_b64 v[46:47], v9 offset:1792
    v_add_u32 v9, 0, v7
    ds_read_b32 v48, v9 offset:0
    ds_read_b32 v49, v9 offset:256
    ds_read_b32 v50, v9 offset:512
    ds_read_b32 v51, v9 offset:768
    ds_read_b32 v52, v9 offset:1024
    ds_read_b32 v53, v9 offset:1280
    ds_read_b32 v54, v9 offset:1536
    ds_read_b32 v55, v9 offset:1792
    s_waitcnt lgkmcnt(8)
    v_perm_b32 v24, v34, v32, s34
    v_accvgpr_write_b32 a192, v24
    v_perm_b32 v25, v38, v36, s34
    v_accvgpr_write_b32 a193, v25
    v_perm_b32 v26, v42, v40, s34
    v_accvgpr_write_b32 a194, v26
    v_perm_b32 v27, v46, v44, s34
    v_accvgpr_write_b32 a195, v27
    v_perm_b32 v28, v34, v32, s35
    v_accvgpr_write_b32 a196, v28
    v_perm_b32 v29, v38, v36, s35
    v_accvgpr_write_b32 a197, v29
    v_perm_b32 v30, v42, v40, s35
    v_accvgpr_write_b32 a198, v30
    v_perm_b32 v31, v46, v44, s35
    v_accvgpr_write_b32 a199, v31
    v_perm_b32 v24, v35, v33, s34
    v_accvgpr_write_b32 a200, v24
    v_perm_b32 v25, v39, v37, s34
    v_accvgpr_write_b32 a201, v25
    v_perm_b32 v26, v43, v41, s34
    v_accvgpr_write_b32 a202, v26
    v_perm_b32 v27, v47, v45, s34
    v_accvgpr_write_b32 a203, v27
    v_perm_b32 v28, v35, v33, s35
    v_accvgpr_write_b32 a204, v28
    v_perm_b32 v29, v39, v37, s35
    v_accvgpr_write_b32 a205, v29
    v_perm_b32 v30, v43, v41, s35
    v_accvgpr_write_b32 a206, v30
    v_perm_b32 v31, v47, v45, s35
    v_accvgpr_write_b32 a207, v31
    s_waitcnt lgkmcnt(0)
    v_perm_b32 v208, v49, v48, s34
    v_perm_b32 v209, v51, v50, s34
    v_perm_b32 v210, v53, v52, s34
    v_perm_b32 v211, v55, v54, s34
    v_perm_b32 v212, v49, v48, s35
    v_perm_b32 v213, v51, v50, s35
    v_perm_b32 v214, v53, v52, s35
    v_perm_b32 v215, v55, v54, s35
    s_waitcnt vmcnt(26)
    s_barrier
    v_add_u32 v9, 24576, v6
    ds_read_b64 v[32:33], v9 offset:0
    ds_read_b64 v[34:35], v9 offset:256
    ds_read_b64 v[36:37], v9 offset:512
    ds_read_b64 v[38:39], v9 offset:768
    ds_read_b64 v[40:41], v9 offset:1024
    ds_read_b64 v[42:43], v9 offset:1280
    ds_read_b64 v[44:45], v9 offset:1536
    ds_read_b64 v[46:47], v9 offset:1792
    v_add_u32 v9, 24576, v7
    ds_read_b32 v48, v9 offset:0
    ds_read_b32 v49, v9 offset:256
    ds_read_b32 v50, v9 offset:512
    ds_read_b32 v51, v9 offset:768
    ds_read_b32 v52, v9 offset:1024
    ds_read_b32 v53, v9 offset:1280
    ds_read_b32 v54, v9 offset:1536
    ds_read_b32 v55, v9 offset:1792
    s_waitcnt lgkmcnt(8)
    v_perm_b32 v24, v34, v32, s34
    v_accvgpr_write_b32 a208, v24
    v_perm_b32 v25, v38, v36, s34
    v_accvgpr_write_b32 a209, v25
    v_perm_b32 v26, v42, v40, s34
    v_accvgpr_write_b32 a210, v26
    v_perm_b32 v27, v46, v44, s34
    v_accvgpr_write_b32 a211, v27
    v_perm_b32 v28, v34, v32, s35
    v_accvgpr_write_b32 a212, v28
    v_perm_b32 v29, v38, v36, s35
    v_accvgpr_write_b32 a213, v29
    v_perm_b32 v30, v42, v40, s35
    v_accvgpr_write_b32 a214, v30
    v_perm_b32 v31, v46, v44, s35
    v_accvgpr_write_b32 a215, v31
    v_perm_b32 v24, v35, v33, s34
    v_accvgpr_write_b32 a216, v24
    v_perm_b32 v25, v39, v37, s34
    v_accvgpr_write_b32 a217, v25
    v_perm_b32 v26, v43, v41, s34
    v_accvgpr_write_b32 a218, v26
    v_perm_b32 v27, v47, v45, s34
    v_accvgpr_write_b32 a219, v27
    v_perm_b32 v28, v35, v33, s35
    v_accvgpr_write_b32 a220, v28
    v_perm_b32 v29, v39, v37, s35
    v_accvgpr_write_b32 a221, v29
    v_perm_b32 v30, v43, v41, s35
    v_accvgpr_write_b32 a222, v30
    v_perm_b32 v31, v47, v45, s35
    v_accvgpr_write_b32 a223, v31
    s_waitcnt lgkmcnt(0)
    v_perm_b32 v216, v49, v48, s34
    v_perm_b32 v217, v51, v50, s34
    v_perm_b32 v218, v53, v52, s34
    v_perm_b32 v219, v55, v54, s34
    v_perm_b32 v220, v49, v48, s35
    v_perm_b32 v221, v51, v50, s35
    v_perm_b32 v222, v53, v52, s35
    v_perm_b32 v223, v55, v54, s35
    s_waitcnt vmcnt(20)
    s_barrier
    v_add_u32 v9, 49152, v6
    ds_read_b64 v[32:33], v9 offset:0
    ds_read_b64 v[34:35], v9 offset:256
    ds_read_b64 v[36:37], v9 offset:512
    ds_read_b64 v[38:39], v9 offset:768
    ds_read_b64 v[40:41], v9 offset:1024
    ds_read_b64 v[42:43], v9 offset:1280
    ds_read_b64 v[44:45], v9 offset:1536
    ds_read_b64 v[46:47], v9 offset:1792
    v_add_u32 v9, 49152, v7
    ds_read_b32 v48, v9 offset:0
    ds_read_b32 v49, v9 offset:256
    ds_read_b32 v50, v9 offset:512
    ds_read_b32 v51, v9 offset:768
    ds_read_b32 v52, v9 offset:1024
    ds_read_b32 v53, v9 offset:1280
    ds_read_b32 v54, v9 offset:1536
    ds_read_b32 v55, v9 offset:1792
    s_waitcnt lgkmcnt(8)
    v_perm_b32 v24, v34, v32, s34
    v_accvgpr_write_b32 a224, v24
    v_perm_b32 v25, v38, v36, s34
    v_accvgpr_write_b32 a225, v25
    v_perm_b32 v26, v42, v40, s34
    v_accvgpr_write_b32 a226, v26
    v_perm_b32 v27, v46, v44, s34
    v_accvgpr_write_b32 a227, v27
    v_perm_b32 v28, v34, v32, s35
    v_accvgpr_write_b32 a228, v28
    v_perm_b32 v29, v38, v36, s35
    v_accvgpr_write_b32 a229, v29
    v_perm_b32 v30, v42, v40, s35
    v_accvgpr_write_b32 a230, v30
    v_perm_b32 v31, v46, v44, s35
    v_accvgpr_write_b32 a231, v31
    v_perm_b32 v24, v35, v33, s34
    v_accvgpr_write_b32 a232, v24
    v_perm_b32 v25, v39, v37, s34
    v_accvgpr_write_b32 a233, v25
    v_perm_b32 v26, v43, v41, s34
    v_accvgpr_write_b32 a234, v26
    v_perm_b32 v27, v47, v45, s34
    v_accvgpr_write_b32 a235, v27
    v_perm_b32 v28, v35, v33, s35
    v_accvgpr_write_b32 a236, v28
    v_perm_b32 v29, v39, v37, s35
    v_accvgpr_write_b32 a237, v29
    v_perm_b32 v30, v43, v41, s35
    v_accvgpr_write_b32 a238, v30
    v_perm_b32 v31, v47, v45, s35
    v_accvgpr_write_b32 a239, v31
    s_waitcnt lgkmcnt(0)
    v_perm_b32 v224, v49, v48, s34
    v_perm_b32 v225, v51, v50, s34
    v_perm_b32 v226, v53, v52, s34
    v_perm_b32 v227, v55, v54, s34
    v_perm_b32 v228, v49, v48, s35
    v_perm_b32 v229, v51, v50, s35
    v_perm_b32 v230, v53, v52, s35
    v_perm_b32 v231, v55, v54, s35
    s_waitcnt vmcnt(14)
    s_barrier
    v_add_u32 v9, 73728, v6
    ds_read_b64 v[32:33], v9 offset:0
    ds_read_b64 v[34:35], v9 offset:256
    ds_read_b64 v[36:37], v9 offset:512
    ds_read_b64 v[38:39], v9 offset:768
    ds_read_b64 v[40:41], v9 offset:1024
    ds_read_b64 v[42:43], v9 offset:1280
    ds_read_b64 v[44:45], v9 offset:1536
    ds_read_b64 v[46:47], v9 offset:1792
    v_add_u32 v9, 73728, v7
    ds_read_b32 v48, v9 offset:0
    ds_read_b32 v49, v9 offset:256
    ds_read_b32 v50, v9 offset:512
    ds_read_b32 v51, v9 offset:768
    ds_read_b32 v52, v9 offset:1024
    ds_read_b32 v53, v9 offset:1280
    ds_read_b32 v54, v9 offset:1536
    ds_read_b32 v55, v9 offset:1792
    s_waitcnt lgkmcnt(8)
    v_perm_b32 v24, v34, v32, s34
    v_accvgpr_write_b32 a240, v24
    v_perm_b32 v25, v38, v36, s34
    v_accvgpr_write_b32 a241, v25
    v_perm_b32 v26, v42, v40, s34
    v_accvgpr_write_b32 a242, v26
    v_perm_b32 v27, v46, v44, s34
    v_accvgpr_write_b32 a243, v27
    v_perm_b32 v28, v34, v32, s35
    v_accvgpr_write_b32 a244, v28
    v_perm_b32 v29, v38, v36, s35
    v_accvgpr_write_b32 a245, v29
    v_perm_b32 v30, v42, v40, s35
    v_accvgpr_write_b32 a246, v30
    v_perm_b32 v31, v46, v44, s35
    v_accvgpr_write_b32 a247, v31
    v_perm_b32 v24, v35, v33, s34
    v_accvgpr_write_b32 a248, v24
    v_perm_b32 v25, v39, v37, s34
    v_accvgpr_write_b32 a249, v25
    v_perm_b32 v26, v43, v41, s34
    v_accvgpr_write_b32 a250, v26
    v_perm_b32 v27, v47, v45, s34
    v_accvgpr_write_b32 a251, v27
    v_perm_b32 v28, v35, v33, s35
    v_accvgpr_write_b32 a252, v28
    v_perm_b32 v29, v39, v37, s35
    v_accvgpr_write_b32 a253, v29
    v_perm_b32 v30, v43, v41, s35
    v_accvgpr_write_b32 a254, v30
    v_perm_b32 v31, v47, v45, s35
    v_accvgpr_write_b32 a255, v31
    s_waitcnt lgkmcnt(0)
    v_perm_b32 v232, v49, v48, s34
    v_perm_b32 v233, v51, v50, s34
    v_perm_b32 v234, v53, v52, s34
    v_perm_b32 v235, v55, v54, s34
    v_perm_b32 v236, v49, v48, s35
    v_perm_b32 v237, v51, v50, s35
    v_perm_b32 v238, v53, v52, s35
    v_perm_b32 v239, v55, v54, s35
    s_waitcnt vmcnt(8)
    s_barrier
    v_add_u32 v9, 98304, v6
    ds_read_b64 v[32:33], v9 offset:0
    ds_read_b64 v[34:35], v9 offset:256
    ds_read_b64 v[36:37], v9 offset:512
    ds_read_b64 v[38:39], v9 offset:768
    ds_read_b64 v[40:41], v9 offset:1024
    ds_read_b64 v[42:43], v9 offset:1280
    ds_read_b64 v[44:45], v9 offset:1536
    ds_read_b64 v[46:47], v9 offset:1792
    v_add_u32 v9, 98304, v7
    ds_read_b32 v48, v9 offset:0
    ds_read_b32 v49, v9 offset:256
    ds_read_b32 v50, v9 offset:512
    ds_read_b32 v51, v9 offset:768
    ds_read_b32 v52, v9 offset:1024
    ds_read_b32 v53, v9 offset:1280
    ds_read_b32 v54, v9 offset:1536
    ds_read_b32 v55, v9 offset:1792
    s_waitcnt lgkmcnt(8)
    v_perm_b32 v80, v34, v32, s34
    v_perm_b32 v81, v38, v36, s34
    v_perm_b32 v82, v42, v40, s34
    v_perm_b32 v83, v46, v44, s34
    v_perm_b32 v84, v34, v32, s35
    v_perm_b32 v85, v38, v36, s35
    v_perm_b32 v86, v42, v40, s35
    v_perm_b32 v87, v46, v44, s35
    v_perm_b32 v88, v35, v33, s34
    v_perm_b32 v89, v39, v37, s34
    v_perm_b32 v90, v43, v41, s34
    v_perm_b32 v91, v47, v45, s34
    v_perm_b32 v92, v35, v33, s35
    v_perm_b32 v93, v39, v37, s35
    v_perm_b32 v94, v43, v41, s35
    v_perm_b32 v95, v47, v45, s35
    s_waitcnt lgkmcnt(0)
    v_perm_b32 v240, v49, v48, s34
    v_perm_b32 v241, v51, v50, s34
    v_perm_b32 v242, v53, v52, s34
    v_perm_b32 v243, v55, v54, s34
    v_perm_b32 v244, v49, v48, s35
    v_perm_b32 v245, v51, v50, s35
    v_perm_b32 v246, v53, v52, s35
    v_perm_b32 v247, v55, v54, s35
    s_waitcnt vmcnt(0)
    s_barrier
    v_min3_u32 v61, v61, v62, v63
    v_cmp_gt_u32 vcc, 1, v61
    s_nop 0
    s_cmp_eq_u64 vcc, 0
    s_cselect_b32 s53, 1, 0
    s_cselect_b32 s37, s30, 0x20000000
    s_lshl_b32 s36, s4, 10
    s_add_u32 m0, s36, s40
    s_nop 0
    buffer_load_dwordx4 v2, s[8:11], s37 offen offset:0 sc1 lds
    s_add_u32 m0, m0, 3968
    s_nop 0
    buffer_load_dwordx4 v2, s[8:11], s37 offen offset:128 sc1 lds
    s_add_u32 m0, m0, 3968
    s_nop 0
    buffer_load_dwordx4 v2, s[8:11], s37 offen offset:256 sc1 lds
    s_add_u32 m0, m0, 3968
    s_nop 0
    buffer_load_dwordx4 v2, s[8:11], s37 offen offset:384 sc1 lds
    s_add_u32 m0, m0, 3968
    s_nop 0
    buffer_load_dwordx4 v2, s[8:11], s37 offen offset:512 sc1 lds
    s_add_u32 m0, m0, 3968
    s_nop 0
    buffer_load_dwordx4 v2, s[8:11], s37 offen offset:640 sc1 lds
    s_add_u32 m0, m0, 3968
    s_nop 0
    buffer_load_dwordx4 v2, s[8:11], s37 offen offset:768 sc1 lds
    s_add_u32 m0, m0, 3968
    s_nop 0
    buffer_load_dwordx4 v2, s[8:11], s37 offen offset:896 sc1 lds
    s_add_u32 m0, m0, 3968
    s_nop 0
    buffer_load_dwordx4 v2, s[8:11], s37 offen offset:1024 sc1 lds
    v_add_u32 v9, 122880, v6
    ds_read_b64 v[32:33], v9 offset:0
    ds_read_b64 v[34:35], v9 offset:256
    ds_read_b64 v[36:37], v9 offset:512
    ds_read_b64 v[38:39], v9 offset:768
    ds_read_b64 v[40:41], v9 offset:1024
    ds_read_b64 v[42:43], v9 offset:1280
    ds_read_b64 v[44:45], v9 offset:1536
    ds_read_b64 v[46:47], v9 offset:1792
    v_add_u32 v9, 122880, v7
    ds_read_b32 v48, v9 offset:0
    ds_read_b32 v49, v9 offset:256
    ds_read_b32 v50, v9 offset:512
    ds_read_b32 v51, v9 offset:768
    ds_read_b32 v52, v9 offset:1024
    ds_read_b32 v53, v9 offset:1280
    ds_read_b32 v54, v9 offset:1536
    ds_read_b32 v55, v9 offset:1792
    s_waitcnt lgkmcnt(8)
    v_perm_b32 v96, v34, v32, s34
    v_perm_b32 v97, v38, v36, s34
    v_perm_b32 v98, v42, v40, s34
    v_perm_b32 v99, v46, v44, s34
    v_perm_b32 v100, v34, v32, s35
    v_perm_b32 v101, v38, v36, s35
    v_perm_b32 v102, v42, v40, s35
    v_perm_b32 v103, v46, v44, s35
    v_perm_b32 v104, v35, v33, s34
    v_perm_b32 v105, v39, v37, s34
    v_perm_b32 v106, v43, v41, s34
    v_perm_b32 v107, v47, v45, s34
    v_perm_b32 v108, v35, v33, s35
    v_perm_b32 v109, v39, v37, s35
    v_perm_b32 v110, v43, v41, s35
    v_perm_b32 v111, v47, v45, s35
    s_waitcnt lgkmcnt(0)
    v_perm_b32 v248, v49, v48, s34
    v_perm_b32 v249, v51, v50, s34
    v_perm_b32 v250, v53, v52, s34
    v_perm_b32 v251, v55, v54, s34
    v_perm_b32 v252, v49, v48, s35
    v_perm_b32 v253, v51, v50, s35
    v_perm_b32 v254, v53, v52, s35
    v_perm_b32 v255, v55, v54, s35
    s_barrier
    s_cmp_lg_u32 s53, 0
    s_cbranch_scc1 A1_go
A1_rdy_19:
    buffer_load_dword v8, off, s[12:15], 0 offset:64 sc1
    s_waitcnt vmcnt(0)
    v_cmp_ne_u32 vcc, 0, v8
    s_cbranch_vccnz A1_rdyok_20
    s_sleep 4
    s_sub_u32 s33, s33, 1
    s_cmp_gt_i32 s33, 0
    s_cbranch_scc1 A1_rdy_19
A1_rdyok_20:
    s_lshl_b32 s38, s43, 8
    s_lshr_b32 s37, s4, 1
    s_lshl_b32 s37, s37, 7
    s_add_u32 s38, s38, s37
    s_add_u32 s38, s38, 0x1f2000
    v_lshlrev_b32 v9, 3, v1
    s_mov_b32 exec_lo, 0x1
    s_mov_b32 exec_hi, 0x0
poll_21:
    buffer_load_dword v8, v9, s[8:11], s38 offen sc1
    s_waitcnt vmcnt(0)
    v_cmp_gt_u32 vcc, s41, v8
    s_cbranch_vccz pollok_22
    s_sleep 4
    s_sub_u32 s33, s33, 1
    s_cmp_gt_i32 s33, 0
    s_cbranch_scc1 poll_21
pollok_22:
    s_mov_b64 exec, -1
    s_lshl_b32 s36, s4, 10
    s_add_u32 m0, s36, s40
    s_nop 0
    buffer_load_dwordx4 v2, s[8:11], s30 offen offset:0 sc1 lds
    s_add_u32 m0, m0, 3968
    s_nop 0
    buffer_load_dwordx4 v2, s[8:11], s30 offen offset:128 sc1 lds
    s_add_u32 m0, m0, 3968
    s_nop 0
    buffer_load_dwordx4 v2, s[8:11], s30 offen offset:256 sc1 lds
    s_add_u32 m0, m0, 3968
    s_nop 0
    buffer_load_dwordx4 v2, s[8:11], s30 offen offset:384 sc1 lds
    s_add_u32 m0, m0, 3968
    s_nop 0
    buffer_load_dwordx4 v2, s[8:11], s30 offen offset:512 sc1 lds
    s_add_u32 m0, m0, 3968
    s_nop 0
    buffer_load_dwordx4 v2, s[8:11], s30 offen offset:640 sc1 lds
    s_add_u32 m0, m0, 3968
    s_nop 0
    buffer_load_dwordx4 v2, s[8:11], s30 offen offset:768 sc1 lds
    s_add_u32 m0, m0, 3968
    s_nop 0
    buffer_load_dwordx4 v2, s[8:11], s30 offen offset:896 sc1 lds
    s_add_u32 m0, m0, 3968
    s_nop 0
    buffer_load_dwordx4 v2, s[8:11], s30 offen offset:1024 sc1 lds
    s_mov_b32 s38, 0x1f2000
    v_lshlrev_b32 v9, 3, v1
    s_mov_b32 exec_lo, 0xffffffff
    s_mov_b32 exec_hi, 0xffffffff
poll_23:
    buffer_load_dword v8, v9, s[8:11], s38 offen sc1
    s_waitcnt vmcnt(0)
    v_cmp_gt_u32 vcc, s41, v8
    s_cbranch_vccz pollok_24
    s_sleep 8
    s_sub_u32 s33, s33, 1
    s_cmp_gt_i32 s33, 0
    s_cbranch_scc1 poll_23
pollok_24:
    s_mov_b64 exec, -1
    s_mov_b32 s38, 0x1f4000
    v_lshlrev_b32 v9, 3, v1
    s_mov_b32 exec_lo, 0xffffffff
    s_mov_b32 exec_hi, 0xffffffff
poll_25:
    buffer_load_dword v8, v9, s[8:11], s38 offen sc1
    s_waitcnt vmcnt(0)
    v_cmp_gt_u32 vcc, s41, v8
    s_cbranch_vccz pollok_26
    s_sleep 8
    s_sub_u32 s33, s33, 1
    s_cmp_gt_i32 s33, 0
    s_cbranch_scc1 poll_25
pollok_26:
    s_mov_b64 exec, -1
A1_go:
    s_waitcnt vmcnt(0)
    s_barrier
A1_loop:
    s_xor_b32 s40, s40, 36864
    s_add_u32 s30, s30, 73728
    s_cmp_lt_u32 s29, 31
    s_cselect_b32 s37, s30, 0x20000000
    s_lshl_b32 s36, s4, 10
    s_add_u32 m0, s36, s40
    s_nop 0
    buffer_load_dwordx4 v2, s[8:11], s37 offen offset:0 sc1 lds
    s_add_u32 m0, m0, 3968
    s_nop 0
    buffer_load_dwordx4 v2, s[8:11], s37 offen offset:128 sc1 lds
    s_add_u32 m0, m0, 3968
    s_nop 0
    buffer_load_dwordx4 v2, s[8:11], s37 offen offset:256 sc1 lds
    s_add_u32 m0, m0, 3968
    s_nop 0
    buffer_load_dwordx4 v2, s[8:11], s37 offen offset:384 sc1 lds
    s_add_u32 m0, m0, 3968
    s_nop 0
    buffer_load_dwordx4 v2, s[8:11], s37 offen offset:512 sc1 lds
    s_add_u32 m0, m0, 3968
    s_nop 0
    buffer_load_dwordx4 v2, s[8:11], s37 offen offset:640 sc1 lds
    s_add_u32 m0, m0, 3968
    s_nop 0
    buffer_load_dwordx4 v2, s[8:11], s37 offen offset:768 sc1 lds
    s_add_u32 m0, m0, 3968
    s_nop 0
    buffer_load_dwordx4 v2, s[8:11], s37 offen offset:896 sc1 lds
    s_add_u32 m0, m0, 3968
    s_nop 0
    buffer_load_dwordx4 v2, s[8:11], s37 offen offset:1024 sc1 lds
    v_mov_b64 v[72:73], -1
    v_mov_b64 v[74:75], -1
    buffer_store_dwordx4 v[72:75], v1, s[8:11], s52 offen sc1
    s_add_u32 s52, s52, 262144
    s_cmp_lg_u32 s29, 24
    s_cbranch_scc1 A1_nofill
    v_lshlrev_b32 v76, 4, v0
    s_mul_i32 s36, s28, 8192
    s_add_u32 s36, s36, 0x6780000
    buffer_store_dwordx4 v[72:75], v76, s[8:11], s36 offen sc1
    s_add_u32 s36, s36, 4096
    buffer_store_dwordx4 v[72:75], v76, s[8:11], s36 offen sc1
    s_add_u32 s36, s36, 4096
    s_mul_i32 s36, s28, 1024
    s_add_u32 s36, s36, 0x6bf0000
    v_mov_b32 v77, 0x20000000
    v_cmp_gt_u32 vcc, 64, v0
    s_nop 1
    v_cndmask_b32 v77, v77, v76, vcc
    buffer_store_dwordx4 v[72:75], v77, s[8:11], s36 offen sc1
    s_add_u32 s36, s36, 4096
    s_mul_i32 s36, s28, 18432
    s_add_u32 s36, s36, 0xb6e0000
    buffer_store_dwordx4 v[72:75], v76, s[8:11], s36 offen sc1
    s_add_u32 s36, s36, 4096
    buffer_store_dwordx4 v[72:75], v76, s[8:11], s36 offen sc1
    s_add_u32 s36, s36, 4096
    buffer_store_dwordx4 v[72:75], v76, s[8:11], s36 offen sc1
    s_add_u32 s36, s36, 4096
    buffer_store_dwordx4 v[72:75], v76, s[8:11], s36 offen sc1
    s_add_u32 s36, s36, 4096
    v_mov_b32 v77, 0x20000000
    v_cmp_gt_u32 vcc, 128, v0
    s_nop 1
    v_cndmask_b32 v77, v77, v76, vcc
    buffer_store_dwordx4 v[72:75], v77, s[8:11], s36 offen sc1
    s_add_u32 s36, s36, 4096
    s_mul_i32 s36, s28, 2304
    s_add_u32 s36, s36, 0xc0dc000
    v_mov_b32 v77, 0x20000000
    v_cmp_gt_u32 vcc, 144, v0
    s_nop 1
    v_cndmask_b32 v77, v77, v76, vcc
    buffer_store_dwordx4 v[72:75], v77, s[8:11], s36 offen sc1
    s_add_u32 s36, s36, 4096
A1_nofill:
    ds_read_b128 v[8:11], v3 offset:0
    ds_read_b128 v[12:15], v3 offset:2048
    ds_read_b128 v[16:19], v4 offset:0
    ds_read_b128 v[20:23], v4 offset:2048
    s_waitcnt lgkmcnt(2)
    v_mfma_f32_16x16x32_bf16 v[24:27], a[0:3], v[8:11], 0
    v_mfma_f32_16x16x32_bf16 v[28:31], a[4:7], v[8:11], 0
    v_mfma_f32_16x16x32_bf16 v[32:35], a[8:11], v[8:11], 0
    v_mfma_f32_16x16x32_bf16 v[36:39], a[12:15], v[8:11], 0
    v_mfma_f32_16x16x32_bf16 v[56:59], v[8:11], v[112:115], 0
    v_mfma_f32_16x16x32_bf16 v[64:67], v[8:11], v[116:119], 0
    v_mfma_f32_16x16x32_bf16 v[40:43], a[0:3], v[12:15], 0
    v_mfma_f32_16x16x32_bf16 v[44:47], a[4:7], v[12:15], 0
    v_mfma_f32_16x16x32_bf16 v[48:51], a[8:11], v[12:15], 0
    v_mfma_f32_16x16x32_bf16 v[52:55], a[12:15], v[12:15], 0
    v_mfma_f32_16x16x32_bf16 v[60:63], v[12:15], v[112:115], 0
    v_mfma_f32_16x16x32_bf16 v[68:71], v[12:15], v[116:119], 0
    ds_read_b128 v[8:11], v3 offset:4096
    ds_read_b128 v[12:15], v3 offset:6144
    s_waitcnt lgkmcnt(2)
    v_mfma_f32_16x16x32_bf16 v[24:27], a[16:19], v[16:19], v[24:27]
    v_mfma_f32_16x16x32_bf16 v[28:31], a[20:23], v[16:19], v[28:31]
    v_mfma_f32_16x16x32_bf16 v[32:35], a[24:27], v[16:19], v[32:35]
    v_mfma_f32_16x16x32_bf16 v[36:39], a[28:31], v[16:19], v[36:39]
    v_mfma_f32_16x16x32_bf16 v[56:59], v[16:19], v[120:123], v[56:59]
    v_mfma_f32_16x16x32_bf16 v[64:67], v[16:19], v[124:127], v[64:67]
    v_mfma_f32_16x16x32_bf16 v[40:43], a[16:19], v[20:23], v[40:43]
    v_mfma_f32_16x16x32_bf16 v[44:47], a[20:23], v[20:23], v[44:47]
    v_mfma_f32_16x16x32_bf16 v[48:51], a[24:27], v[20:23], v[48:51]
    v_mfma_f32_16x16x32_bf16 v[52:55], a[28:31], v[20:23], v[52:55]
    v_mfma_f32_16x16x32_bf16 v[60:63], v[20:23], v[120:123], v[60:63]
    v_mfma_f32_16x16x32_bf16 v[68:71], v[20:23], v[124:127], v[68:71]
    ds_read_b128 v[16:19], v4 offset:4096
    ds_read_b128 v[20:23], v4 offset:6144
    s_waitcnt lgkmcnt(2)
    v_mfma_f32_16x16x32_bf16 v[24:27], a[32:35], v[8:11], v[24:27]
    v_mfma_f32_16x16x32_bf16 v[28:31], a[36:39], v[8:11], v[28:31]
    v_mfma_f32_16x16x32_bf16 v[32:35], a[40:43], v[8:11], v[32:35]
    v_mfma_f32_16x16x32_bf16 v[36:39], a[44:47], v[8:11], v[36:39]
    v_mfma_f32_16x16x32_bf16 v[56:59], v[8:11], v[128:131], v[56:59]
    v_mfma_f32_16x16x32_bf16 v[64:67], v[8:11], v[132:135], v[64:67]
    v_mfma_f32_16x16x32_bf16 v[40:43], a[32:35], v[12:15], v[40:43]
    v_mfma_f32_16x16x32_bf16 v[44:47], a[36:39], v[12:15], v[44:47]
    v_mfma_f32_16x16x32_bf16 v[48:51], a[40:43], v[12:15], v[48:51]
    v_mfma_f32_16x16x32_bf16 v[52:55], a[44:47], v[12:15], v[52:55]
    v_mfma_f32_16x16x32_bf16 v[60:63], v[12:15], v[128:131], v[60:63]
    v_mfma_f32_16x16x32_bf16 v[68:71], v[12:15], v[132:135], v[68:71]
    ds_read_b128 v[8:11], v3 offset:8192
    ds_read_b128 v[12:15], v3 offset:10240
    s_waitcnt lgkmcnt(2)
    v_mfma_f32_16x16x32_bf16 v[24:27], a[48:51], v[16:19], v[24:27]
    v_mfma_f32_16x16x32_bf16 v[28:31], a[52:55], v[16:19], v[28:31]
    v_mfma_f32_16x16x32_bf16 v[32:35], a[56:59], v[16:19], v[32:35]
    v_mfma_f32_16x16x32_bf16 v[36:39], a[60:63], v[16:19], v[36:39]
    v_mfma_f32_16x16x32_bf16 v[56:59], v[16:19], v[136:139], v[56:59]
    v_mfma_f32_16x16x32_bf16 v[64:67], v[16:19], v[140:143], v[64:67]
    v_mfma_f32_16x16x32_bf16 v[40:43], a[48:51], v[20:23], v[40:43]
    v_mfma_f32_16x16x32_bf16 v[44:47], a[52:55], v[20:23], v[44:47]
    v_mfma_f32_16x16x32_bf16 v[48:51], a[56:59], v[20:23], v[48:51]
    v_mfma_f32_16x16x32_bf16 v[52:55], a[60:63], v[20:23], v[52:55]
    v_mfma_f32_16x16x32_bf16 v[60:63], v[20:23], v[136:139], v[60:63]
    v_mfma_f32_16x16x32_bf16 v[68:71], v[20:23], v[140:143], v[68:71]
    ds_read_b128 v[16:19], v4 offset:8192
    ds_read_b128 v[20:23], v4 offset:10240
    s_waitcnt lgkmcnt(2)
    v_mfma_f32_16x16x32_bf16 v[24:27], a[64:67], v[8:11], v[24:27]
    v_mfma_f32_16x16x32_bf16 v[28:31], a[68:71], v[8:11], v[28:31]
    v_mfma_f32_16x16x32_bf16 v[32:35], a[72:75], v[8:11], v[32:35]
    v_mfma_f32_16x16x32_bf16 v[36:39], a[76:79], v[8:11], v[36:39]
    v_mfma_f32_16x16x32_bf16 v[56:59], v[8:11], v[144:147], v[56:59]
    v_mfma_f32_16x16x32_bf16 v[64:67], v[8:11], v[148:151], v[64:67]
    v_mfma_f32_16x16x32_bf16 v[40:43], a[64:67], v[12:15], v[40:43]
    v_mfma_f32_16x16x32_bf16 v[44:47], a[68:71], v[12:15], v[44:47]
    v_mfma_f32_16x16x32_bf16 v[48:51], a[72:75], v[12:15], v[48:51]
    v_mfma_f32_16x16x32_bf16 v[52:55], a[76:79], v[12:15], v[52:55]
    v_mfma_f32_16x16x32_bf16 v[60:63], v[12:15], v[144:147], v[60:63]
    v_mfma_f32_16x16x32_bf16 v[68:71], v[12:15], v[148:151], v[68:71]
    ds_read_b128 v[8:11], v3 offset:12288
    ds_read_b128 v[12:15], v3 offset:14336
    s_waitcnt lgkmcnt(2)
    v_mfma_f32_16x16x32_bf16 v[24:27], a[80:83], v[16:19], v[24:27]
    v_mfma_f32_16x16x32_bf16 v[28:31], a[84:87], v[16:19], v[28:31]
    v_mfma_f32_16x16x32_bf16 v[32:35], a[88:91], v[16:19], v[32:35]
    v_mfma_f32_16x16x32_bf16 v[36:39], a[92:95], v[16:19], v[36:39]
    v_mfma_f32_16x16x32_bf16 v[56:59], v[16:19], v[152:155], v[56:59]
    v_mfma_f32_16x16x32_bf16 v[64:67], v[16:19], v[156:159], v[64:67]
    v_mfma_f32_16x16x32_bf16 v[40:43], a[80:83], v[20:23], v[40:43]
    v_mfma_f32_16x16x32_bf16 v[44:47], a[84:87], v[20:23], v[44:47]
    v_mfma_f32_16x16x32_bf16 v[48:51], a[88:91], v[20:23], v[48:51]
    v_mfma_f32_16x16x32_bf16 v[52:55], a[92:95], v[20:23], v[52:55]
    v_mfma_f32_16x16x32_bf16 v[60:63], v[20:23], v[152:155], v[60:63]
    v_mfma_f32_16x16x32_bf16 v[68:71], v[20:23], v[156:159], v[68:71]
    ds_read_b128 v[16:19], v4 offset:12288
    ds_read_b128 v[20:23], v4 offset:14336
    s_waitcnt lgkmcnt(2)
    v_mfma_f32_16x16x32_bf16 v[24:27], a[96:99], v[8:11], v[24:27]
    v_mfma_f32_16x16x32_bf16 v[28:31], a[100:103], v[8:11], v[28:31]
    v_mfma_f32_16x16x32_bf16 v[32:35], a[104:107], v[8:11], v[32:35]
    v_mfma_f32_16x16x32_bf16 v[36:39], a[108:111], v[8:11], v[36:39]
    v_mfma_f32_16x16x32_bf16 v[56:59], v[8:11], v[160:163], v[56:59]
    v_mfma_f32_16x16x32_bf16 v[64:67], v[8:11], v[164:167], v[64:67]
    v_mfma_f32_16x16x32_bf16 v[40:43], a[96:99], v[12:15], v[40:43]
    v_mfma_f32_16x16x32_bf16 v[44:47], a[100:103], v[12:15], v[44:47]
    v_mfma_f32_16x16x32_bf16 v[48:51], a[104:107], v[12:15], v[48:51]
    v_mfma_f32_16x16x32_bf16 v[52:55], a[108:111], v[12:15], v[52:55]
    v_mfma_f32_16x16x32_bf16 v[60:63], v[12:15], v[160:163], v[60:63]
    v_mfma_f32_16x16x32_bf16 v[68:71], v[12:15], v[164:167], v[68:71]
    ds_read_b128 v[8:11], v3 offset:16384
    ds_read_b128 v[12:15], v3 offset:18432
    s_waitcnt lgkmcnt(2)
    v_mfma_f32_16x16x32_bf16 v[24:27], a[112:115], v[16:19], v[24:27]
    v_mfma_f32_16x16x32_bf16 v[28:31], a[116:119], v[16:19], v[28:31]
    v_mfma_f32_16x16x32_bf16 v[32:35], a[120:123], v[16:19], v[32:35]
    v_mfma_f32_16x16x32_bf16 v[36:39], a[124:127], v[16:19], v[36:39]
    v_mfma_f32_16x16x32_bf16 v[56:59], v[16:19], v[168:171], v[56:59]
    v_mfma_f32_16x16x32_bf16 v[64:67], v[16:19], v[172:175], v[64:67]
    v_mfma_f32_16x16x32_bf16 v[40:43], a[112:115], v[20:23], v[40:43]
    v_mfma_f32_16x16x32_bf16 v[44:47], a[116:119], v[20:23], v[44:47]
    v_mfma_f32_16x16x32_bf16 v[48:51], a[120:123], v[20:23], v[48:51]
    v_mfma_f32_16x16x32_bf16 v[52:55], a[124:127], v[20:23], v[52:55]
    v_mfma_f32_16x16x32_bf16 v[60:63], v[20:23], v[168:171], v[60:63]
    v_mfma_f32_16x16x32_bf16 v[68:71], v[20:23], v[172:175], v[68:71]
    ds_read_b128 v[16:19], v4 offset:16384
    ds_read_b128 v[20:23], v4 offset:18432
    s_waitcnt lgkmcnt(2)
    v_mfma_f32_16x16x32_bf16 v[24:27], a[128:131], v[8:11], v[24:27]
    v_mfma_f32_16x16x32_bf16 v[28:31], a[132:135], v[8:11], v[28:31]
    v_mfma_f32_16x16x32_bf16 v[32:35], a[136:139], v[8:11], v[32:35]
    v_mfma_f32_16x16x32_bf16 v[36:39], a[140:143], v[8:11], v[36:39]
    v_mfma_f32_16x16x32_bf16 v[56:59], v[8:11], v[176:179], v[56:59]
    v_mfma_f32_16x16x32_bf16 v[64:67], v[8:11], v[180:183], v[64:67]
    v_mfma_f32_16x16x32_bf16 v[40:43], a[128:131], v[12:15], v[40:43]
    v_mfma_f32_16x16x32_bf16 v[44:47], a[132:135], v[12:15], v[44:47]
    v_mfma_f32_16x16x32_bf16 v[48:51], a[136:139], v[12:15], v[48:51]
    v_mfma_f32_16x16x32_bf16 v[52:55], a[140:143], v[12:15], v[52:55]
    v_mfma_f32_16x16x32_bf16 v[60:63], v[12:15], v[176:179], v[60:63]
    v_mfma_f32_16x16x32_bf16 v[68:71], v[12:15], v[180:183], v[68:71]
    ds_read_b128 v[8:11], v3 offset:20480
    ds_read_b128 v[12:15], v3 offset:22528
    s_waitcnt lgkmcnt(2)
    v_mfma_f32_16x16x32_bf16 v[24:27], a[144:147], v[16:19], v[24:27]
    v_mfma_f32_16x16x32_bf16 v[28:31], a[148:151], v[16:19], v[28:31]
    v_mfma_f32_16x16x32_bf16 v[32:35], a[152:155], v[16:19], v[32:35]
    v_mfma_f32_16x16x32_bf16 v[36:39], a[156:159], v[16:19], v[36:39]
    v_mfma_f32_16x16x32_bf16 v[56:59], v[16:19], v[184:187], v[56:59]
    v_mfma_f32_16x16x32_bf16 v[64:67], v[16:19], v[188:191], v[64:67]
    v_mfma_f32_16x16x32_bf16 v[40:43], a[144:147], v[20:23], v[40:43]
    v_mfma_f32_16x16x32_bf16 v[44:47], a[148:151], v[20:23], v[44:47]
    v_mfma_f32_16x16x32_bf16 v[48:51], a[152:155], v[20:23], v[48:51]
    v_mfma_f32_16x16x32_bf16 v[52:55], a[156:159], v[20:23], v[52:55]
    v_mfma_f32_16x16x32_bf16 v[60:63], v[20:23], v[184:187], v[60:63]
    v_mfma_f32_16x16x32_bf16 v[68:71], v[20:23], v[188:191], v[68:71]
    ds_read_b128 v[16:19], v4 offset:20480
    ds_read_b128 v[20:23], v4 offset:22528
    s_waitcnt lgkmcnt(2)
    v_mfma_f32_16x16x32_bf16 v[24:27], a[160:163], v[8:11], v[24:27]
    v_mfma_f32_16x16x32_bf16 v[28:31], a[164:167], v[8:11], v[28:31]
    v_mfma_f32_16x16x32_bf16 v[32:35], a[168:171], v[8:11], v[32:35]
    v_mfma_f32_16x16x32_bf16 v[36:39], a[172:175], v[8:11], v[36:39]
    v_mfma_f32_16x16x32_bf16 v[56:59], v[8:11], v[192:195], v[56:59]
    v_mfma_f32_16x16x32_bf16 v[64:67], v[8:11], v[196:199], v[64:67]
    v_mfma_f32_16x16x32_bf16 v[40:43], a[160:163], v[12:15], v[40:43]
    v_mfma_f32_16x16x32_bf16 v[44:47], a[164:167], v[12:15], v[44:47]
    v_mfma_f32_16x16x32_bf16 v[48:51], a[168:171], v[12:15], v[48:51]
    v_mfma_f32_16x16x32_bf16 v[52:55], a[172:175], v[12:15], v[52:55]
    v_mfma_f32_16x16x32_bf16 v[60:63], v[12:15], v[192:195], v[60:63]
    v_mfma_f32_16x16x32_bf16 v[68:71], v[12:15], v[196:199], v[68:71]
    ds_read_b128 v[8:11], v3 offset:24576
    ds_read_b128 v[12:15], v3 offset:26624
    s_waitcnt lgkmcnt(2)
    v_mfma_f32_16x16x32_bf16 v[24:27], a[176:179], v[16:19], v[24:27]
    v_mfma_f32_16x16x32_bf16 v[28:31], a[180:183], v[16:19], v[28:31]
    v_mfma_f32_16x16x32_bf16 v[32:35], a[184:187], v[16:19], v[32:35]
    v_mfma_f32_16x16x32_bf16 v[36:39], a[188:191], v[16:19], v[36:39]
    v_mfma_f32_16x16x32_bf16 v[56:59], v[16:19], v[200:203], v[56:59]
    v_mfma_f32_16x16x32_bf16 v[64:67], v[16:19], v[204:207], v[64:67]
    v_mfma_f32_16x16x32_bf16 v[40:43], a[176:179], v[20:23], v[40:43]
    v_mfma_f32_16x16x32_bf16 v[44:47], a[180:183], v[20:23], v[44:47]
    v_mfma_f32_16x16x32_bf16 v[48:51], a[184:187], v[20:23], v[48:51]
    v_mfma_f32_16x16x32_bf16 v[52:55], a[188:191], v[20:23], v[52:55]
    v_mfma_f32_16x16x32_bf16 v[60:63], v[20:23], v[200:203], v[60:63]
    v_mfma_f32_16x16x32_bf16 v[68:71], v[20:23], v[204:207], v[68:71]
    ds_read_b128 v[16:19], v4 offset:24576
    ds_read_b128 v[20:23], v4 offset:26624
    s_waitcnt lgkmcnt(2)
    v_mfma_f32_16x16x32_bf16 v[24:27], a[192:195], v[8:11], v[24:27]
    v_mfma_f32_16x16x32_bf16 v[28:31], a[196:199], v[8:11], v[28:31]
    v_mfma_f32_16x16x32_bf16 v[32:35], a[200:203], v[8:11], v[32:35]
    v_mfma_f32_16x16x32_bf16 v[36:39], a[204:207], v[8:11], v[36:39]
    v_mfma_f32_16x16x32_bf16 v[56:59], v[8:11], v[208:211], v[56:59]
    v_mfma_f32_16x16x32_bf16 v[64:67], v[8:11], v[212:215], v[64:67]
    v_mfma_f32_16x16x32_bf16 v[40:43], a[192:195], v[12:15], v[40:43]
    v_mfma_f32_16x16x32_bf16 v[44:47], a[196:199], v[12:15], v[44:47]
    v_mfma_f32_16x16x32_bf16 v[48:51], a[200:203], v[12:15], v[48:51]
    v_mfma_f32_16x16x32_bf16 v[52:55], a[204:207], v[12:15], v[52:55]
    v_mfma_f32_16x16x32_bf16 v[60:63], v[12:15], v[208:211], v[60:63]
    v_mfma_f32_16x16x32_bf16 v[68:71], v[12:15], v[212:215], v[68:71]
    ds_read_b128 v[8:11], v3 offset:28672
    ds_read_b128 v[12:15], v3 offset:30720
    s_waitcnt lgkmcnt(2)
    v_mfma_f32_16x16x32_bf16 v[24:27], a[208:211], v[16:19], v[24:27]
    v_mfma_f32_16x16x32_bf16 v[28:31], a[212:215], v[16:19], v[28:31]
    v_mfma_f32_16x16x32_bf16 v[32:35], a[216:219], v[16:19], v[32:35]
    v_mfma_f32_16x16x32_bf16 v[36:39], a[220:223], v[16:19], v[36:39]
    v_mfma_f32_16x16x32_bf16 v[56:59], v[16:19], v[216:219], v[56:59]
    v_mfma_f32_16x16x32_bf16 v[64:67], v[16:19], v[220:223], v[64:67]
    v_mfma_f32_16x16x32_bf16 v[40:43], a[208:211], v[20:23], v[40:43]
    v_mfma_f32_16x16x32_bf16 v[44:47], a[212:215], v[20:23], v[44:47]
    v_mfma_f32_16x16x32_bf16 v[48:51], a[216:219], v[20:23], v[48:51]
    v_mfma_f32_16x16x32_bf16 v[52:55], a[220:223], v[20:23], v[52:55]
    v_mfma_f32_16x16x32_bf16 v[60:63], v[20:23], v[216:219], v[60:63]
    v_mfma_f32_16x16x32_bf16 v[68:71], v[20:23], v[220:223], v[68:71]
    ds_read_b128 v[16:19], v4 offset:28672
    ds_read_b128 v[20:23], v4 offset:30720
    s_waitcnt lgkmcnt(2)
    v_mfma_f32_16x16x32_bf16 v[24:27], a[224:227], v[8:11], v[24:27]
    v_mfma_f32_16x16x32_bf16 v[28:31], a[228:231], v[8:11], v[28:31]
    v_mfma_f32_16x16x32_bf16 v[32:35], a[232:235], v[8:11], v[32:35]
    v_mfma_f32_16x16x32_bf16 v[36:39], a[236:239], v[8:11], v[36:39]
    v_mfma_f32_16x16x32_bf16 v[56:59], v[8:11], v[224:227], v[56:59]
    v_mfma_f32_16x16x32_bf16 v[64:67], v[8:11], v[228:231], v[64:67]
    v_mfma_f32_16x16x32_bf16 v[40:43], a[224:227], v[12:15], v[40:43]
    v_mfma_f32_16x16x32_bf16 v[44:47], a[228:231], v[12:15], v[44:47]
    v_mfma_f32_16x16x32_bf16 v[48:51], a[232:235], v[12:15], v[48:51]
    v_mfma_f32_16x16x32_bf16 v[52:55], a[236:239], v[12:15], v[52:55]
    v_mfma_f32_16x16x32_bf16 v[60:63], v[12:15], v[224:227], v[60:63]
    v_mfma_f32_16x16x32_bf16 v[68:71], v[12:15], v[228:231], v[68:71]
    ds_read_b128 v[8:11], v3 offset:32768
    ds_read_b128 v[12:15], v3 offset:34816
    s_waitcnt lgkmcnt(2)
    v_mfma_f32_16x16x32_bf16 v[24:27], a[240:243], v[16:19], v[24:27]
    v_mfma_f32_16x16x32_bf16 v[28:31], a[244:247], v[16:19], v[28:31]
    v_mfma_f32_16x16x32_bf16 v[32:35], a[248:251], v[16:19], v[32:35]
    v_mfma_f32_16x16x32_bf16 v[36:39], a[252:255], v[16:19], v[36:39]
    v_mfma_f32_16x16x32_bf16 v[56:59], v[16:19], v[232:235], v[56:59]
    v_mfma_f32_16x16x32_bf16 v[64:67], v[16:19], v[236:239], v[64:67]
    v_mfma_f32_16x16x32_bf16 v[40:43], a[240:243], v[20:23], v[40:43]
    v_mfma_f32_16x16x32_bf16 v[44:47], a[244:247], v[20:23], v[44:47]
    v_mfma_f32_16x16x32_bf16 v[48:51], a[248:251], v[20:23], v[48:51]
    v_mfma_f32_16x16x32_bf16 v[52:55], a[252:255], v[20:23], v[52:55]
    v_mfma_f32_16x16x32_bf16 v[60:63], v[20:23], v[232:235], v[60:63]
    v_mfma_f32_16x16x32_bf16 v[68:71], v[20:23], v[236:239], v[68:71]
    ds_read_b128 v[16:19], v4 offset:32768
    ds_read_b128 v[20:23], v4 offset:34816
    s_waitcnt lgkmcnt(2)
    v_mfma_f32_16x16x32_bf16 v[24:27], v[80:83], v[8:11], v[24:27]
    v_mfma_f32_16x16x32_bf16 v[28:31], v[84:87], v[8:11], v[28:31]
    v_mfma_f32_16x16x32_bf16 v[32:35], v[88:91], v[8:11], v[32:35]
    v_mfma_f32_16x16x32_bf16 v[36:39], v[92:95], v[8:11], v[36:39]
    v_mfma_f32_16x16x32_bf16 v[56:59], v[8:11], v[240:243], v[56:59]
    v_mfma_f32_16x16x32_bf16 v[64:67], v[8:11], v[244:247], v[64:67]
    v_mfma_f32_16x16x32_bf16 v[40:43], v[80:83], v[12:15], v[40:43]
    v_mfma_f32_16x16x32_bf16 v[44:47], v[84:87], v[12:15], v[44:47]
    v_mfma_f32_16x16x32_bf16 v[48:51], v[88:91], v[12:15], v[48:51]
    v_mfma_f32_16x16x32_bf16 v[52:55], v[92:95], v[12:15], v[52:55]
    v_mfma_f32_16x16x32_bf16 v[60:63], v[12:15], v[240:243], v[60:63]
    v_mfma_f32_16x16x32_bf16 v[68:71], v[12:15], v[244:247], v[68:71]
    s_waitcnt lgkmcnt(0)
    v_mfma_f32_16x16x32_bf16 v[24:27], v[96:99], v[16:19], v[24:27]
    v_mfma_f32_16x16x32_bf16 v[28:31], v[100:103], v[16:19], v[28:31]
    v_mfma_f32_16x16x32_bf16 v[32:35], v[104:107], v[16:19], v[32:35]
    v_mfma_f32_16x16x32_bf16 v[36:39], v[108:111], v[16:19], v[36:39]
    v_mfma_f32_16x16x32_bf16 v[56:59], v[16:19], v[248:251], v[56:59]
    v_mfma_f32_16x16x32_bf16 v[64:67], v[16:19], v[252:255], v[64:67]
    v_mfma_f32_16x16x32_bf16 v[40:43], v[96:99], v[20:23], v[40:43]
    v_mfma_f32_16x16x32_bf16 v[44:47], v[100:103], v[20:23], v[44:47]
    v_mfma_f32_16x16x32_bf16 v[48:51], v[104:107], v[20:23], v[48:51]
    v_mfma_f32_16x16x32_bf16 v[52:55], v[108:111], v[20:23], v[52:55]
    v_mfma_f32_16x16x32_bf16 v[60:63], v[20:23], v[248:251], v[60:63]
    v_mfma_f32_16x16x32_bf16 v[68:71], v[20:23], v[252:255], v[68:71]
    s_lshl_b32 s36, s40, 1
    s_sub_u32 s36, s36, 36864
    v_add_u32 v3, s36, v3
    v_add_u32 v4, s36, v4
    v_cvt_pk_bf16_f32 v72, v24, v28
    v_cvt_pk_bf16_f32 v73, v32, v36
    v_cvt_pk_bf16_f32 v74, v25, v29
    v_cvt_pk_bf16_f32 v75, v33, v37
    buffer_store_dwordx4 v[72:75], v5, s[8:11], s31 offen offset:0 sc1
    v_cvt_pk_bf16_f32 v76, v26, v30
    v_cvt_pk_bf16_f32 v77, v34, v38
    v_cvt_pk_bf16_f32 v78, v27, v31
    v_cvt_pk_bf16_f32 v79, v35, v39
    buffer_store_dwordx4 v[76:79], v5, s[8:11], s31 offen offset:256 sc1
    v_cvt_pk_bf16_f32 v72, v40, v44
    v_cvt_pk_bf16_f32 v73, v48, v52
    v_cvt_pk_bf16_f32 v74, v41, v45
    v_cvt_pk_bf16_f32 v75, v49, v53
    buffer_store_dwordx4 v[72:75], v5, s[8:11], s31 offen offset:1024 sc1
    v_cvt_pk_bf16_f32 v76, v42, v46
    v_cvt_pk_bf16_f32 v77, v50, v54
    v_cvt_pk_bf16_f32 v78, v43, v47
    v_cvt_pk_bf16_f32 v79, v51, v55
    buffer_store_dwordx4 v[76:79], v5, s[8:11], s31 offen offset:1280 sc1
    s_lshl_b32 s36, s4, 11
    s_add_u32 s36, s36, s31
    s_add_u32 s36, s36, 16384
    v_cvt_pk_bf16_f32 v72, v56, v57
    v_cvt_pk_bf16_f32 v73, v58, v59
    v_cvt_pk_bf16_f32 v74, v60, v61
    v_cvt_pk_bf16_f32 v75, v62, v63
    buffer_store_dwordx4 v[72:75], v1, s[8:11], s36 offen offset:0 sc1
    v_cvt_pk_bf16_f32 v76, v64, v65
    v_cvt_pk_bf16_f32 v77, v66, v67
    v_cvt_pk_bf16_f32 v78, v68, v69
    v_cvt_pk_bf16_f32 v79, v70, v71
    buffer_store_dwordx4 v[76:79], v1, s[8:11], s36 offen offset:1024 sc1
    s_add_u32 s29, s29, 1
    s_add_u32 s31, s31, 1572864
    s_waitcnt vmcnt(0)
    s_barrier
    s_cmp_lg_u32 s4, 0
    s_cbranch_scc1 nosig_27
    v_mov_b32 v8, s29
    s_mov_b64 exec, 1
    buffer_store_dword v8, off, s[8:11], s32 sc1
    s_mov_b64 exec, -1
nosig_27:
    s_cmp_lt_u32 s29, 32
    s_cbranch_scc1 A1_loop
    s_lshl_b32 s60, s4, 6
    s_add_u32 s60, s60, s28
    s_add_u32 s60, s60, 1792
    s_mov_b32 s61, 2048
    s_mov_b32 s62, 256
    s_cmp_lt_u32 s4, 4
    s_cbranch_scc1 CF_common
    s_waitcnt vmcnt(0)
    s_endpgm
A2_entry:
    v_and_b32 v20, 63, v0
    v_and_b32 v21, 15, v20
    v_lshrrev_b32 v22, 4, v20
    v_lshlrev_b32 v1, 4, v20
    s_mov_b32 s34, 0x05040100
    s_mov_b32 s35, 0x07060302
    s_mov_b32 s45, 0xffff0000
    s_mov_b32 s33, 400000
    s_and_b32 s48, s28, 15
    s_lshr_b32 s49, s28, 4
    s_load_dwordx2 s[16:17], s[0:1], 40
    s_mov_b32 s18, 0x480000
    s_mov_b32 s19, 0x20000
    s_lshl_b32 s38, s48, 8
    v_lshlrev_b32 v23, 3, v22
    v_add_u32 v23, s38, v23
    s_mov_b32 s37, 1152
    v_mul_lo_u32 v23, v23, s37
    s_lshl_b32 s36, s4, 8
    v_lshl_add_u32 v24, v21, 4, v23
    v_add_u32 v8, s36, v24
    s_lshl_b32 s36, s4, 5
    s_add_u32 s36, s36, 1024
    v_lshl_add_u32 v24, v21, 1, v23
    v_add_u32 v9, s36, v24
    s_mov_b32 s37, 65536
    v_mul_lo_u32 v23, v22, s37
    v_lshl_add_u32 v23, v21, 4, v23
    s_lshl_b32 s36, s4, 8
    v_add_u32 v2, s36, v23
    v_lshrrev_b32 v23, 2, v21
    v_lshlrev_b32 v23, 8, v23
    v_lshl_add_u32 v23, v22, 5, v23
    v_and_b32 v24, 1, v21
    v_lshl_add_u32 v4, v24, 3, v23
    v_lshrrev_b32 v5, 1, v1
    s_and_b32 s36, s4, 1
    s_lshl_b32 s36, s36, 4
    v_lshlrev_b32 v23, 2, v22
    v_sub_u32 v23, v21, v23
    v_add_u32 v6, s36, v23
    s_waitcnt lgkmcnt(0)
    s_cmp_lg_u32 s4, 0
    s_cbranch_scc1 dwok_29
dw_28:
    buffer_load_dword v244, off, s[12:15], 0 offset:64 sc1
    s_waitcnt vmcnt(0)
    v_readfirstlane_b32 s36, v244
    s_nop 0
    s_cmp_ge_u32 s36, 128
    s_cbranch_scc1 dwok_29
    s_sleep 4
    s_sub_u32 s33, s33, 1
    s_cmp_gt_i32 s33, 0
    s_cbranch_scc1 dw_28
dwok_29:
    s_barrier
    s_mov_b32 s41, 1
    s_and_b32 s39, s28, 31
    s_lshl_b32 s39, s39, 7
    s_add_u32 s39, s39, 0x144000
    v_lshlrev_b32 v245, 3, v1
    s_mov_b32 exec_lo, 0x1
    s_mov_b32 exec_hi, 0x0
poll_30:
    buffer_load_dword v244, v245, s[8:11], s39 offen sc1
    s_waitcnt vmcnt(0)
    v_cmp_gt_u32 vcc, s41, v244
    s_cbranch_vccz pollok_31
    s_sleep 8
    s_sub_u32 s33, s33, 1
    s_cmp_gt_i32 s33, 0
    s_cbranch_scc1 poll_30
pollok_31:
    s_mov_b64 exec, -1
    s_mov_b32 s36, 0
    buffer_load_dwordx4 v[112:115], v8, s[16:19], s36 offen offset:0 nt
    buffer_load_dwordx4 v[116:119], v8, s[16:19], s36 offen offset:1152 nt
    buffer_load_dwordx4 v[120:123], v8, s[16:19], s36 offen offset:2304 nt
    buffer_load_dwordx4 v[124:127], v8, s[16:19], s36 offen offset:3456 nt
    buffer_load_ushort v144, v9, s[16:19], s36 offen offset:0 nt
    buffer_load_ushort v145, v9, s[16:19], s36 offen offset:1152 nt
    buffer_load_ushort v146, v9, s[16:19], s36 offen offset:2304 nt
    buffer_load_ushort v147, v9, s[16:19], s36 offen offset:3456 nt
    s_mov_b32 s36, 4608
    buffer_load_dwordx4 v[128:131], v8, s[16:19], s36 offen offset:0 nt
    buffer_load_dwordx4 v[132:135], v8, s[16:19], s36 offen offset:1152 nt
    buffer_load_dwordx4 v[136:139], v8, s[16:19], s36 offen offset:2304 nt
    buffer_load_dwordx4 v[140:143], v8, s[16:19], s36 offen offset:3456 nt
    buffer_load_ushort v148, v9, s[16:19], s36 offen offset:0 nt
    buffer_load_ushort v149, v9, s[16:19], s36 offen offset:1152 nt
    buffer_load_ushort v150, v9, s[16:19], s36 offen offset:2304 nt
    buffer_load_ushort v151, v9, s[16:19], s36 offen offset:3456 nt
    s_mov_b32 s36, 36864
    buffer_load_dwordx4 v[152:155], v8, s[16:19], s36 offen offset:0 nt
    buffer_load_dwordx4 v[156:159], v8, s[16:19], s36 offen offset:1152 nt
    buffer_load_dwordx4 v[160:163], v8, s[16:19], s36 offen offset:2304 nt
    buffer_load_dwordx4 v[164:167], v8, s[16:19], s36 offen offset:3456 nt
    buffer_load_ushort v184, v9, s[16:19], s36 offen offset:0 nt
    buffer_load_ushort v185, v9, s[16:19], s36 offen offset:1152 nt
    buffer_load_ushort v186, v9, s[16:19], s36 offen offset:2304 nt
    buffer_load_ushort v187, v9, s[16:19], s36 offen offset:3456 nt
    s_mov_b32 s36, 41472
    buffer_load_dwordx4 v[168:171], v8, s[16:19], s36 offen offset:0 nt
    buffer_load_dwordx4 v[172:175], v8, s[16:19], s36 offen offset:1152 nt
    buffer_load_dwordx4 v[176:179], v8, s[16:19], s36 offen offset:2304 nt
    buffer_load_dwordx4 v[180:183], v8, s[16:19], s36 offen offset:3456 nt
    buffer_load_ushort v188, v9, s[16:19], s36 offen offset:0 nt
    buffer_load_ushort v189, v9, s[16:19], s36 offen offset:1152 nt
    buffer_load_ushort v190, v9, s[16:19], s36 offen offset:2304 nt
    buffer_load_ushort v191, v9, s[16:19], s36 offen offset:3456 nt
    s_mov_b32 s36, 73728
    buffer_load_dwordx4 v[192:195], v8, s[16:19], s36 offen offset:0 nt
    buffer_load_dwordx4 v[196:199], v8, s[16:19], s36 offen offset:1152 nt
    buffer_load_dwordx4 v[200:203], v8, s[16:19], s36 offen offset:2304 nt
    buffer_load_dwordx4 v[204:207], v8, s[16:19], s36 offen offset:3456 nt
    buffer_load_ushort v224, v9, s[16:19], s36 offen offset:0 nt
    buffer_load_ushort v225, v9, s[16:19], s36 offen offset:1152 nt
    buffer_load_ushort v226, v9, s[16:19], s36 offen offset:2304 nt
    buffer_load_ushort v227, v9, s[16:19], s36 offen offset:3456 nt
    s_mov_b32 s36, 78336
    buffer_load_dwordx4 v[208:211], v8, s[16:19], s36 offen offset:0 nt
    buffer_load_dwordx4 v[212:215], v8, s[16:19], s36 offen offset:1152 nt
    buffer_load_dwordx4 v[216:219], v8, s[16:19], s36 offen offset:2304 nt
    buffer_load_dwordx4 v[220:223], v8, s[16:19], s36 offen offset:3456 nt
    buffer_load_ushort v228, v9, s[16:19], s36 offen offset:0 nt
    buffer_load_ushort v229, v9, s[16:19], s36 offen offset:1152 nt
    buffer_load_ushort v230, v9, s[16:19], s36 offen offset:2304 nt
    buffer_load_ushort v231, v9, s[16:19], s36 offen offset:3456 nt
    s_waitcnt vmcnt(32)
    v_perm_b32 v24, v116, v112, s34
    v_accvgpr_write_b32 a0, v24
    v_perm_b32 v25, v124, v120, s34
    v_accvgpr_write_b32 a1, v25
    v_perm_b32 v26, v132, v128, s34
    v_accvgpr_write_b32 a2, v26
    v_perm_b32 v27, v140, v136, s34
    v_accvgpr_write_b32 a3, v27
    v_perm_b32 v28, v116, v112, s35
    v_accvgpr_write_b32 a4, v28
    v_perm_b32 v29, v124, v120, s35
    v_accvgpr_write_b32 a5, v29
    v_perm_b32 v30, v132, v128, s35
    v_accvgpr_write_b32 a6, v30
    v_perm_b32 v31, v140, v136, s35
    v_accvgpr_write_b32 a7, v31
    v_perm_b32 v24, v117, v113, s34
    v_accvgpr_write_b32 a8, v24
    v_perm_b32 v25, v125, v121, s34
    v_accvgpr_write_b32 a9, v25
    v_perm_b32 v26, v133, v129, s34
    v_accvgpr_write_b32 a10, v26
    v_perm_b32 v27, v141, v137, s34
    v_accvgpr_write_b32 a11, v27
    v_perm_b32 v28, v117, v113, s35
    v_accvgpr_write_b32 a12, v28
    v_perm_b32 v29, v125, v121, s35
    v_accvgpr_write_b32 a13, v29
    v_perm_b32 v30, v133, v129, s35
    v_accvgpr_write_b32 a14, v30
    v_perm_b32 v31, v141, v137, s35
    v_accvgpr_write_b32 a15, v31
    v_perm_b32 v24, v118, v114, s34
    v_accvgpr_write_b32 a16, v24
    v_perm_b32 v25, v126, v122, s34
    v_accvgpr_write_b32 a17, v25
    v_perm_b32 v26, v134, v130, s34
    v_accvgpr_write_b32 a18, v26
    v_perm_b32 v27, v142, v138, s34
    v_accvgpr_write_b32 a19, v27
    v_perm_b32 v28, v118, v114, s35
    v_accvgpr_write_b32 a20, v28
    v_perm_b32 v29, v126, v122, s35
    v_accvgpr_write_b32 a21, v29
    v_perm_b32 v30, v134, v130, s35
    v_accvgpr_write_b32 a22, v30
    v_perm_b32 v31, v142, v138, s35
    v_accvgpr_write_b32 a23, v31
    v_perm_b32 v24, v119, v115, s34
    v_accvgpr_write_b32 a24, v24
    v_perm_b32 v25, v127, v123, s34
    v_accvgpr_write_b32 a25, v25
    v_perm_b32 v26, v135, v131, s34
    v_accvgpr_write_b32 a26, v26
    v_perm_b32 v27, v143, v139, s34
    v_accvgpr_write_b32 a27, v27
    v_perm_b32 v28, v119, v115, s35
    v_accvgpr_write_b32 a28, v28
    v_perm_b32 v29, v127, v123, s35
    v_accvgpr_write_b32 a29, v29
    v_perm_b32 v30, v135, v131, s35
    v_accvgpr_write_b32 a30, v30
    v_perm_b32 v31, v143, v139, s35
    v_accvgpr_write_b32 a31, v31
    v_lshl_or_b32 v24, v145, 16, v144
    v_accvgpr_write_b32 a32, v24
    v_lshl_or_b32 v25, v147, 16, v146
    v_accvgpr_write_b32 a33, v25
    v_lshl_or_b32 v26, v149, 16, v148
    v_accvgpr_write_b32 a34, v26
    v_lshl_or_b32 v27, v151, 16, v150
    v_accvgpr_write_b32 a35, v27
    s_mov_b32 s36, 110592
    buffer_load_dwordx4 v[112:115], v8, s[16:19], s36 offen offset:0 nt
    buffer_load_dwordx4 v[116:119], v8, s[16:19], s36 offen offset:1152 nt
    buffer_load_dwordx4 v[120:123], v8, s[16:19], s36 offen offset:2304 nt
    buffer_load_dwordx4 v[124:127], v8, s[16:19], s36 offen offset:3456 nt
    buffer_load_ushort v144, v9, s[16:19], s36 offen offset:0 nt
    buffer_load_ushort v145, v9, s[16:19], s36 offen offset:1152 nt
    buffer_load_ushort v146, v9, s[16:19], s36 offen offset:2304 nt
    buffer_load_ushort v147, v9, s[16:19], s36 offen offset:3456 nt
    s_mov_b32 s36, 115200
    buffer_load_dwordx4 v[128:131], v8, s[16:19], s36 offen offset:0 nt
    buffer_load_dwordx4 v[132:135], v8, s[16:19], s36 offen offset:1152 nt
    buffer_load_dwordx4 v[136:139], v8, s[16:19], s36 offen offset:2304 nt
    buffer_load_dwordx4 v[140:143], v8, s[16:19], s36 offen offset:3456 nt
    buffer_load_ushort v148, v9, s[16:19], s36 offen offset:0 nt
    buffer_load_ushort v149, v9, s[16:19], s36 offen offset:1152 nt
    buffer_load_ushort v150, v9, s[16:19], s36 offen offset:2304 nt
    buffer_load_ushort v151, v9, s[16:19], s36 offen offset:3456 nt
    s_waitcnt vmcnt(32)
    v_perm_b32 v24, v156, v152, s34
    v_accvgpr_write_b32 a36, v24
    v_perm_b32 v25, v164, v160, s34
    v_accvgpr_write_b32 a37, v25
    v_perm_b32 v26, v172, v168, s34
    v_accvgpr_write_b32 a38, v26
    v_perm_b32 v27, v180, v176, s34
    v_accvgpr_write_b32 a39, v27
    v_perm_b32 v28, v156, v152, s35
    v_accvgpr_write_b32 a40, v28
    v_perm_b32 v29, v164, v160, s35
    v_accvgpr_write_b32 a41, v29
    v_perm_b32 v30, v172, v168, s35
    v_accvgpr_write_b32 a42, v30
    v_perm_b32 v31, v180, v176, s35
    v_accvgpr_write_b32 a43, v31
    v_perm_b32 v24, v157, v153, s34
    v_accvgpr_write_b32 a44, v24
    v_perm_b32 v25, v165, v161, s34
    v_accvgpr_write_b32 a45, v25
    v_perm_b32 v26, v173, v169, s34
    v_accvgpr_write_b32 a46, v26
    v_perm_b32 v27, v181, v177, s34
    v_accvgpr_write_b32 a47, v27
    v_perm_b32 v28, v157, v153, s35
    v_accvgpr_write_b32 a48, v28
    v_perm_b32 v29, v165, v161, s35
    v_accvgpr_write_b32 a49, v29
    v_perm_b32 v30, v173, v169, s35
    v_accvgpr_write_b32 a50, v30
    v_perm_b32 v31, v181, v177, s35
    v_accvgpr_write_b32 a51, v31
    v_perm_b32 v24, v158, v154, s34
    v_accvgpr_write_b32 a52, v24
    v_perm_b32 v25, v166, v162, s34
    v_accvgpr_write_b32 a53, v25
    v_perm_b32 v26, v174, v170, s34
    v_accvgpr_write_b32 a54, v26
    v_perm_b32 v27, v182, v178, s34
    v_accvgpr_write_b32 a55, v27
    v_perm_b32 v28, v158, v154, s35
    v_accvgpr_write_b32 a56, v28
    v_perm_b32 v29, v166, v162, s35
    v_accvgpr_write_b32 a57, v29
    v_perm_b32 v30, v174, v170, s35
    v_accvgpr_write_b32 a58, v30
    v_perm_b32 v31, v182, v178, s35
    v_accvgpr_write_b32 a59, v31
    v_perm_b32 v24, v159, v155, s34
    v_accvgpr_write_b32 a60, v24
    v_perm_b32 v25, v167, v163, s34
    v_accvgpr_write_b32 a61, v25
    v_perm_b32 v26, v175, v171, s34
    v_accvgpr_write_b32 a62, v26
    v_perm_b32 v27, v183, v179, s34
    v_accvgpr_write_b32 a63, v27
    v_perm_b32 v28, v159, v155, s35
    v_accvgpr_write_b32 a64, v28
    v_perm_b32 v29, v167, v163, s35
    v_accvgpr_write_b32 a65, v29
    v_perm_b32 v30, v175, v171, s35
    v_accvgpr_write_b32 a66, v30
    v_perm_b32 v31, v183, v179, s35
    v_accvgpr_write_b32 a67, v31
    v_lshl_or_b32 v24, v185, 16, v184
    v_accvgpr_write_b32 a68, v24
    v_lshl_or_b32 v25, v187, 16, v186
    v_accvgpr_write_b32 a69, v25
    v_lshl_or_b32 v26, v189, 16, v188
    v_accvgpr_write_b32 a70, v26
    v_lshl_or_b32 v27, v191, 16, v190
    v_accvgpr_write_b32 a71, v27
    s_mov_b32 s36, 147456
    buffer_load_dwordx4 v[152:155], v8, s[16:19], s36 offen offset:0 nt
    buffer_load_dwordx4 v[156:159], v8, s[16:19], s36 offen offset:1152 nt
    buffer_load_dwordx4 v[160:163], v8, s[16:19], s36 offen offset:2304 nt
    buffer_load_dwordx4 v[164:167], v8, s[16:19], s36 offen offset:3456 nt
    buffer_load_ushort v184, v9, s[16:19], s36 offen offset:0 nt
    buffer_load_ushort v185, v9, s[16:19], s36 offen offset:1152 nt
    buffer_load_ushort v186, v9, s[16:19], s36 offen offset:2304 nt
    buffer_load_ushort v187, v9, s[16:19], s36 offen offset:3456 nt
    s_mov_b32 s36, 152064
    buffer_load_dwordx4 v[168:171], v8, s[16:19], s36 offen offset:0 nt
    buffer_load_dwordx4 v[172:175], v8, s[16:19], s36 offen offset:1152 nt
    buffer_load_dwordx4 v[176:179], v8, s[16:19], s36 offen offset:2304 nt
    buffer_load_dwordx4 v[180:183], v8, s[16:19], s36 offen offset:3456 nt
    buffer_load_ushort v188, v9, s[16:19], s36 offen offset:0 nt
    buffer_load_ushort v189, v9, s[16:19], s36 offen offset:1152 nt
    buffer_load_ushort v190, v9, s[16:19], s36 offen offset:2304 nt
    buffer_load_ushort v191, v9, s[16:19], s36 offen offset:3456 nt
    s_waitcnt vmcnt(32)
    v_perm_b32 v24, v196, v192, s34
    v_accvgpr_write_b32 a72, v24
    v_perm_b32 v25, v204, v200, s34
    v_accvgpr_write_b32 a73, v25
    v_perm_b32 v26, v212, v208, s34
    v_accvgpr_write_b32 a74, v26
    v_perm_b32 v27, v220, v216, s34
    v_accvgpr_write_b32 a75, v27
    v_perm_b32 v28, v196, v192, s35
    v_accvgpr_write_b32 a76, v28
    v_perm_b32 v29, v204, v200, s35
    v_accvgpr_write_b32 a77, v29
    v_perm_b32 v30, v212, v208, s35
    v_accvgpr_write_b32 a78, v30
    v_perm_b32 v31, v220, v216, s35
    v_accvgpr_write_b32 a79, v31
    v_perm_b32 v24, v197, v193, s34
    v_accvgpr_write_b32 a80, v24
    v_perm_b32 v25, v205, v201, s34
    v_accvgpr_write_b32 a81, v25
    v_perm_b32 v26, v213, v209, s34
    v_accvgpr_write_b32 a82, v26
    v_perm_b32 v27, v221, v217, s34
    v_accvgpr_write_b32 a83, v27
    v_perm_b32 v28, v197, v193, s35
    v_accvgpr_write_b32 a84, v28
    v_perm_b32 v29, v205, v201, s35
    v_accvgpr_write_b32 a85, v29
    v_perm_b32 v30, v213, v209, s35
    v_accvgpr_write_b32 a86, v30
    v_perm_b32 v31, v221, v217, s35
    v_accvgpr_write_b32 a87, v31
    v_perm_b32 v24, v198, v194, s34
    v_accvgpr_write_b32 a88, v24
    v_perm_b32 v25, v206, v202, s34
    v_accvgpr_write_b32 a89, v25
    v_perm_b32 v26, v214, v210, s34
    v_accvgpr_write_b32 a90, v26
    v_perm_b32 v27, v222, v218, s34
    v_accvgpr_write_b32 a91, v27
    v_perm_b32 v28, v198, v194, s35
    v_accvgpr_write_b32 a92, v28
    v_perm_b32 v29, v206, v202, s35
    v_accvgpr_write_b32 a93, v29
    v_perm_b32 v30, v214, v210, s35
    v_accvgpr_write_b32 a94, v30
    v_perm_b32 v31, v222, v218, s35
    v_accvgpr_write_b32 a95, v31
    v_perm_b32 v24, v199, v195, s34
    v_accvgpr_write_b32 a96, v24
    v_perm_b32 v25, v207, v203, s34
    v_accvgpr_write_b32 a97, v25
    v_perm_b32 v26, v215, v211, s34
    v_accvgpr_write_b32 a98, v26
    v_perm_b32 v27, v223, v219, s34
    v_accvgpr_write_b32 a99, v27
    v_perm_b32 v28, v199, v195, s35
    v_accvgpr_write_b32 a100, v28
    v_perm_b32 v29, v207, v203, s35
    v_accvgpr_write_b32 a101, v29
    v_perm_b32 v30, v215, v211, s35
    v_accvgpr_write_b32 a102, v30
    v_perm_b32 v31, v223, v219, s35
    v_accvgpr_write_b32 a103, v31
    v_lshl_or_b32 v24, v225, 16, v224
    v_accvgpr_write_b32 a104, v24
    v_lshl_or_b32 v25, v227, 16, v226
    v_accvgpr_write_b32 a105, v25
    v_lshl_or_b32 v26, v229, 16, v228
    v_accvgpr_write_b32 a106, v26
    v_lshl_or_b32 v27, v231, 16, v230
    v_accvgpr_write_b32 a107, v27
    s_mov_b32 s36, 184320
    buffer_load_dwordx4 v[192:195], v8, s[16:19], s36 offen offset:0 nt
    buffer_load_dwordx4 v[196:199], v8, s[16:19], s36 offen offset:1152 nt
    buffer_load_dwordx4 v[200:203], v8, s[16:19], s36 offen offset:2304 nt
    buffer_load_dwordx4 v[204:207], v8, s[16:19], s36 offen offset:3456 nt
    buffer_load_ushort v224, v9, s[16:19], s36 offen offset:0 nt
    buffer_load_ushort v225, v9, s[16:19], s36 offen offset:1152 nt
    buffer_load_ushort v226, v9, s[16:19], s36 offen offset:2304 nt
    buffer_load_ushort v227, v9, s[16:19], s36 offen offset:3456 nt
    s_mov_b32 s36, 188928
    buffer_load_dwordx4 v[208:211], v8, s[16:19], s36 offen offset:0 nt
    buffer_load_dwordx4 v[212:215], v8, s[16:19], s36 offen offset:1152 nt
    buffer_load_dwordx4 v[216:219], v8, s[16:19], s36 offen offset:2304 nt
    buffer_load_dwordx4 v[220:223], v8, s[16:19], s36 offen offset:3456 nt
    buffer_load_ushort v228, v9, s[16:19], s36 offen offset:0 nt
    buffer_load_ushort v229, v9, s[16:19], s36 offen offset:1152 nt
    buffer_load_ushort v230, v9, s[16:19], s36 offen offset:2304 nt
    buffer_load_ushort v231, v9, s[16:19], s36 offen offset:3456 nt
    s_waitcnt vmcnt(32)
    v_perm_b32 v24, v116, v112, s34
    v_accvgpr_write_b32 a108, v24
    v_perm_b32 v25, v124, v120, s34
    v_accvgpr_write_b32 a109, v25
    v_perm_b32 v26, v132, v128, s34
    v_accvgpr_write_b32 a110, v26
    v_perm_b32 v27, v140, v136, s34
    v_accvgpr_write_b32 a111, v27
    v_perm_b32 v28, v116, v112, s35
    v_accvgpr_write_b32 a112, v28
    v_perm_b32 v29, v124, v120, s35
    v_accvgpr_write_b32 a113, v29
    v_perm_b32 v30, v132, v128, s35
    v_accvgpr_write_b32 a114, v30
    v_perm_b32 v31, v140, v136, s35
    v_accvgpr_write_b32 a115, v31
    v_perm_b32 v24, v117, v113, s34
    v_accvgpr_write_b32 a116, v24
    v_perm_b32 v25, v125, v121, s34
    v_accvgpr_write_b32 a117, v25
    v_perm_b32 v26, v133, v129, s34
    v_accvgpr_write_b32 a118, v26
    v_perm_b32 v27, v141, v137, s34
    v_accvgpr_write_b32 a119, v27
    v_perm_b32 v28, v117, v113, s35
    v_accvgpr_write_b32 a120, v28
    v_perm_b32 v29, v125, v121, s35
    v_accvgpr_write_b32 a121, v29
    v_perm_b32 v30, v133, v129, s35
    v_accvgpr_write_b32 a122, v30
    v_perm_b32 v31, v141, v137, s35
    v_accvgpr_write_b32 a123, v31
    v_perm_b32 v24, v118, v114, s34
    v_accvgpr_write_b32 a124, v24
    v_perm_b32 v25, v126, v122, s34
    v_accvgpr_write_b32 a125, v25
    v_perm_b32 v26, v134, v130, s34
    v_accvgpr_write_b32 a126, v26
    v_perm_b32 v27, v142, v138, s34
    v_accvgpr_write_b32 a127, v27
    v_perm_b32 v28, v118, v114, s35
    v_accvgpr_write_b32 a128, v28
    v_perm_b32 v29, v126, v122, s35
    v_accvgpr_write_b32 a129, v29
    v_perm_b32 v30, v134, v130, s35
    v_accvgpr_write_b32 a130, v30
    v_perm_b32 v31, v142, v138, s35
    v_accvgpr_write_b32 a131, v31
    v_perm_b32 v24, v119, v115, s34
    v_accvgpr_write_b32 a132, v24
    v_perm_b32 v25, v127, v123, s34
    v_accvgpr_write_b32 a133, v25
    v_perm_b32 v26, v135, v131, s34
    v_accvgpr_write_b32 a134, v26
    v_perm_b32 v27, v143, v139, s34
    v_accvgpr_write_b32 a135, v27
    v_perm_b32 v28, v119, v115, s35
    v_accvgpr_write_b32 a136, v28
    v_perm_b32 v29, v127, v123, s35
    v_accvgpr_write_b32 a137, v29
    v_perm_b32 v30, v135, v131, s35
    v_accvgpr_write_b32 a138, v30
    v_perm_b32 v31, v143, v139, s35
    v_accvgpr_write_b32 a139, v31
    v_lshl_or_b32 v24, v145, 16, v144
    v_accvgpr_write_b32 a140, v24
    v_lshl_or_b32 v25, v147, 16, v146
    v_accvgpr_write_b32 a141, v25
    v_lshl_or_b32 v26, v149, 16, v148
    v_accvgpr_write_b32 a142, v26
    v_lshl_or_b32 v27, v151, 16, v150
    v_accvgpr_write_b32 a143, v27
    s_mov_b32 s36, 221184
    buffer_load_dwordx4 v[112:115], v8, s[16:19], s36 offen offset:0 nt
    buffer_load_dwordx4 v[116:119], v8, s[16:19], s36 offen offset:1152 nt
    buffer_load_dwordx4 v[120:123], v8, s[16:19], s36 offen offset:2304 nt
    buffer_load_dwordx4 v[124:127], v8, s[16:19], s36 offen offset:3456 nt
    buffer_load_ushort v144, v9, s[16:19], s36 offen offset:0 nt
    buffer_load_ushort v145, v9, s[16:19], s36 offen offset:1152 nt
    buffer_load_ushort v146, v9, s[16:19], s36 offen offset:2304 nt
    buffer_load_ushort v147, v9, s[16:19], s36 offen offset:3456 nt
    s_mov_b32 s36, 225792
    buffer_load_dwordx4 v[128:131], v8, s[16:19], s36 offen offset:0 nt
    buffer_load_dwordx4 v[132:135], v8, s[16:19], s36 offen offset:1152 nt
    buffer_load_dwordx4 v[136:139], v8, s[16:19], s36 offen offset:2304 nt
    buffer_load_dwordx4 v[140:143], v8, s[16:19], s36 offen offset:3456 nt
    buffer_load_ushort v148, v9, s[16:19], s36 offen offset:0 nt
    buffer_load_ushort v149, v9, s[16:19], s36 offen offset:1152 nt
    buffer_load_ushort v150, v9, s[16:19], s36 offen offset:2304 nt
    buffer_load_ushort v151, v9, s[16:19], s36 offen offset:3456 nt
    s_waitcnt vmcnt(32)
    v_perm_b32 v24, v156, v152, s34
    v_accvgpr_write_b32 a144, v24
    v_perm_b32 v25, v164, v160, s34
    v_accvgpr_write_b32 a145, v25
    v_perm_b32 v26, v172, v168, s34
    v_accvgpr_write_b32 a146, v26
    v_perm_b32 v27, v180, v176, s34
    v_accvgpr_write_b32 a147, v27
    v_perm_b32 v28, v156, v152, s35
    v_accvgpr_write_b32 a148, v28
    v_perm_b32 v29, v164, v160, s35
    v_accvgpr_write_b32 a149, v29
    v_perm_b32 v30, v172, v168, s35
    v_accvgpr_write_b32 a150, v30
    v_perm_b32 v31, v180, v176, s35
    v_accvgpr_write_b32 a151, v31
    v_perm_b32 v24, v157, v153, s34
    v_accvgpr_write_b32 a152, v24
    v_perm_b32 v25, v165, v161, s34
    v_accvgpr_write_b32 a153, v25
    v_perm_b32 v26, v173, v169, s34
    v_accvgpr_write_b32 a154, v26
    v_perm_b32 v27, v181, v177, s34
    v_accvgpr_write_b32 a155, v27
    v_perm_b32 v28, v157, v153, s35
    v_accvgpr_write_b32 a156, v28
    v_perm_b32 v29, v165, v161, s35
    v_accvgpr_write_b32 a157, v29
    v_perm_b32 v30, v173, v169, s35
    v_accvgpr_write_b32 a158, v30
    v_perm_b32 v31, v181, v177, s35
    v_accvgpr_write_b32 a159, v31
    v_perm_b32 v24, v158, v154, s34
    v_accvgpr_write_b32 a160, v24
    v_perm_b32 v25, v166, v162, s34
    v_accvgpr_write_b32 a161, v25
    v_perm_b32 v26, v174, v170, s34
    v_accvgpr_write_b32 a162, v26
    v_perm_b32 v27, v182, v178, s34
    v_accvgpr_write_b32 a163, v27
    v_perm_b32 v28, v158, v154, s35
    v_accvgpr_write_b32 a164, v28
    v_perm_b32 v29, v166, v162, s35
    v_accvgpr_write_b32 a165, v29
    v_perm_b32 v30, v174, v170, s35
    v_accvgpr_write_b32 a166, v30
    v_perm_b32 v31, v182, v178, s35
    v_accvgpr_write_b32 a167, v31
    v_perm_b32 v24, v159, v155, s34
    v_accvgpr_write_b32 a168, v24
    v_perm_b32 v25, v167, v163, s34
    v_accvgpr_write_b32 a169, v25
    v_perm_b32 v26, v175, v171, s34
    v_accvgpr_write_b32 a170, v26
    v_perm_b32 v27, v183, v179, s34
    v_accvgpr_write_b32 a171, v27
    v_perm_b32 v28, v159, v155, s35
    v_accvgpr_write_b32 a172, v28
    v_perm_b32 v29, v167, v163, s35
    v_accvgpr_write_b32 a173, v29
    v_perm_b32 v30, v175, v171, s35
    v_accvgpr_write_b32 a174, v30
    v_perm_b32 v31, v183, v179, s35
    v_accvgpr_write_b32 a175, v31
    v_lshl_or_b32 v24, v185, 16, v184
    v_accvgpr_write_b32 a176, v24
    v_lshl_or_b32 v25, v187, 16, v186
    v_accvgpr_write_b32 a177, v25
    v_lshl_or_b32 v26, v189, 16, v188
    v_accvgpr_write_b32 a178, v26
    v_lshl_or_b32 v27, v191, 16, v190
    v_accvgpr_write_b32 a179, v27
    s_mov_b32 s36, 258048
    buffer_load_dwordx4 v[152:155], v8, s[16:19], s36 offen offset:0 nt
    buffer_load_dwordx4 v[156:159], v8, s[16:19], s36 offen offset:1152 nt
    buffer_load_dwordx4 v[160:163], v8, s[16:19], s36 offen offset:2304 nt
    buffer_load_dwordx4 v[164:167], v8, s[16:19], s36 offen offset:3456 nt
    buffer_load_ushort v184, v9, s[16:19], s36 offen offset:0 nt
    buffer_load_ushort v185, v9, s[16:19], s36 offen offset:1152 nt
    buffer_load_ushort v186, v9, s[16:19], s36 offen offset:2304 nt
    buffer_load_ushort v187, v9, s[16:19], s36 offen offset:3456 nt
    s_mov_b32 s36, 262656
    buffer_load_dwordx4 v[168:171], v8, s[16:19], s36 offen offset:0 nt
    buffer_load_dwordx4 v[172:175], v8, s[16:19], s36 offen offset:1152 nt
    buffer_load_dwordx4 v[176:179], v8, s[16:19], s36 offen offset:2304 nt
    buffer_load_dwordx4 v[180:183], v8, s[16:19], s36 offen offset:3456 nt
    buffer_load_ushort v188, v9, s[16:19], s36 offen offset:0 nt
    buffer_load_ushort v189, v9, s[16:19], s36 offen offset:1152 nt
    buffer_load_ushort v190, v9, s[16:19], s36 offen offset:2304 nt
    buffer_load_ushort v191, v9, s[16:19], s36 offen offset:3456 nt
    s_waitcnt vmcnt(32)
    v_perm_b32 v24, v196, v192, s34
    v_accvgpr_write_b32 a180, v24
    v_perm_b32 v25, v204, v200, s34
    v_accvgpr_write_b32 a181, v25
    v_perm_b32 v26, v212, v208, s34
    v_accvgpr_write_b32 a182, v26
    v_perm_b32 v27, v220, v216, s34
    v_accvgpr_write_b32 a183, v27
    v_perm_b32 v28, v196, v192, s35
    v_accvgpr_write_b32 a184, v28
    v_perm_b32 v29, v204, v200, s35
    v_accvgpr_write_b32 a185, v29
    v_perm_b32 v30, v212, v208, s35
    v_accvgpr_write_b32 a186, v30
    v_perm_b32 v31, v220, v216, s35
    v_accvgpr_write_b32 a187, v31
    v_perm_b32 v24, v197, v193, s34
    v_accvgpr_write_b32 a188, v24
    v_perm_b32 v25, v205, v201, s34
    v_accvgpr_write_b32 a189, v25
    v_perm_b32 v26, v213, v209, s34
    v_accvgpr_write_b32 a190, v26
    v_perm_b32 v27, v221, v217, s34
    v_accvgpr_write_b32 a191, v27
    v_perm_b32 v28, v197, v193, s35
    v_accvgpr_write_b32 a192, v28
    v_perm_b32 v29, v205, v201, s35
    v_accvgpr_write_b32 a193, v29
    v_perm_b32 v30, v213, v209, s35
    v_accvgpr_write_b32 a194, v30
    v_perm_b32 v31, v221, v217, s35
    v_accvgpr_write_b32 a195, v31
    v_perm_b32 v24, v198, v194, s34
    v_accvgpr_write_b32 a196, v24
    v_perm_b32 v25, v206, v202, s34
    v_accvgpr_write_b32 a197, v25
    v_perm_b32 v26, v214, v210, s34
    v_accvgpr_write_b32 a198, v26
    v_perm_b32 v27, v222, v218, s34
    v_accvgpr_write_b32 a199, v27
    v_perm_b32 v28, v198, v194, s35
    v_accvgpr_write_b32 a200, v28
    v_perm_b32 v29, v206, v202, s35
    v_accvgpr_write_b32 a201, v29
    v_perm_b32 v30, v214, v210, s35
    v_accvgpr_write_b32 a202, v30
    v_perm_b32 v31, v222, v218, s35
    v_accvgpr_write_b32 a203, v31
    v_perm_b32 v24, v199, v195, s34
    v_accvgpr_write_b32 a204, v24
    v_perm_b32 v25, v207, v203, s34
    v_accvgpr_write_b32 a205, v25
    v_perm_b32 v26, v215, v211, s34
    v_accvgpr_write_b32 a206, v26
    v_perm_b32 v27, v223, v219, s34
    v_accvgpr_write_b32 a207, v27
    v_perm_b32 v28, v199, v195, s35
    v_accvgpr_write_b32 a208, v28
    v_perm_b32 v29, v207, v203, s35
    v_accvgpr_write_b32 a209, v29
    v_perm_b32 v30, v215, v211, s35
    v_accvgpr_write_b32 a210, v30
    v_perm_b32 v31, v223, v219, s35
    v_accvgpr_write_b32 a211, v31
    v_lshl_or_b32 v24, v225, 16, v224
    v_accvgpr_write_b32 a212, v24
    v_lshl_or_b32 v25, v227, 16, v226
    v_accvgpr_write_b32 a213, v25
    v_lshl_or_b32 v26, v229, 16, v228
    v_accvgpr_write_b32 a214, v26
    v_lshl_or_b32 v27, v231, 16, v230
    v_accvgpr_write_b32 a215, v27
    s_waitcnt vmcnt(16)
    v_perm_b32 v24, v116, v112, s34
    v_accvgpr_write_b32 a216, v24
    v_perm_b32 v25, v124, v120, s34
    v_accvgpr_write_b32 a217, v25
    v_perm_b32 v26, v132, v128, s34
    v_accvgpr_write_b32 a218, v26
    v_perm_b32 v27, v140, v136, s34
    v_accvgpr_write_b32 a219, v27
    v_perm_b32 v28, v116, v112, s35
    v_accvgpr_write_b32 a220, v28
    v_perm_b32 v29, v124, v120, s35
    v_accvgpr_write_b32 a221, v29
    v_perm_b32 v30, v132, v128, s35
    v_accvgpr_write_b32 a222, v30
    v_perm_b32 v31, v140, v136, s35
    v_accvgpr_write_b32 a223, v31
    v_perm_b32 v24, v117, v113, s34
    v_accvgpr_write_b32 a224, v24
    v_perm_b32 v25, v125, v121, s34
    v_accvgpr_write_b32 a225, v25
    v_perm_b32 v26, v133, v129, s34
    v_accvgpr_write_b32 a226, v26
    v_perm_b32 v27, v141, v137, s34
    v_accvgpr_write_b32 a227, v27
    v_perm_b32 v28, v117, v113, s35
    v_accvgpr_write_b32 a228, v28
    v_perm_b32 v29, v125, v121, s35
    v_accvgpr_write_b32 a229, v29
    v_perm_b32 v30, v133, v129, s35
    v_accvgpr_write_b32 a230, v30
    v_perm_b32 v31, v141, v137, s35
    v_accvgpr_write_b32 a231, v31
    v_perm_b32 v24, v118, v114, s34
    v_accvgpr_write_b32 a232, v24
    v_perm_b32 v25, v126, v122, s34
    v_accvgpr_write_b32 a233, v25
    v_perm_b32 v26, v134, v130, s34
    v_accvgpr_write_b32 a234, v26
    v_perm_b32 v27, v142, v138, s34
    v_accvgpr_write_b32 a235, v27
    v_perm_b32 v28, v118, v114, s35
    v_accvgpr_write_b32 a236, v28
    v_perm_b32 v29, v126, v122, s35
    v_accvgpr_write_b32 a237, v29
    v_perm_b32 v30, v134, v130, s35
    v_accvgpr_write_b32 a238, v30
    v_perm_b32 v31, v142, v138, s35
    v_accvgpr_write_b32 a239, v31
    v_perm_b32 v24, v119, v115, s34
    v_accvgpr_write_b32 a240, v24
    v_perm_b32 v25, v127, v123, s34
    v_accvgpr_write_b32 a241, v25
    v_perm_b32 v26, v135, v131, s34
    v_accvgpr_write_b32 a242, v26
    v_perm_b32 v27, v143, v139, s34
    v_accvgpr_write_b32 a243, v27
    v_perm_b32 v28, v119, v115, s35
    v_accvgpr_write_b32 a244, v28
    v_perm_b32 v29, v127, v123, s35
    v_accvgpr_write_b32 a245, v29
    v_perm_b32 v30, v135, v131, s35
    v_accvgpr_write_b32 a246, v30
    v_perm_b32 v31, v143, v139, s35
    v_accvgpr_write_b32 a247, v31
    v_lshl_or_b32 v24, v145, 16, v144
    v_accvgpr_write_b32 a248, v24
    v_lshl_or_b32 v25, v147, 16, v146
    v_accvgpr_write_b32 a249, v25
    v_lshl_or_b32 v26, v149, 16, v148
    v_accvgpr_write_b32 a250, v26
    v_lshl_or_b32 v27, v151, 16, v150
    v_accvgpr_write_b32 a251, v27
    s_waitcnt vmcnt(0)
    v_perm_b32 v24, v156, v152, s34
    v_accvgpr_write_b32 a252, v24
    v_perm_b32 v25, v164, v160, s34
    v_accvgpr_write_b32 a253, v25
    v_perm_b32 v26, v172, v168, s34
    v_accvgpr_write_b32 a254, v26
    v_perm_b32 v27, v180, v176, s34
    v_accvgpr_write_b32 a255, v27
    v_perm_b32 v80, v156, v152, s35
    v_perm_b32 v81, v164, v160, s35
    v_perm_b32 v82, v172, v168, s35
    v_perm_b32 v83, v180, v176, s35
    v_perm_b32 v84, v157, v153, s34
    v_perm_b32 v85, v165, v161, s34
    v_perm_b32 v86, v173, v169, s34
    v_perm_b32 v87, v181, v177, s34
    v_perm_b32 v88, v157, v153, s35
    v_perm_b32 v89, v165, v161, s35
    v_perm_b32 v90, v173, v169, s35
    v_perm_b32 v91, v181, v177, s35
    v_perm_b32 v92, v158, v154, s34
    v_perm_b32 v93, v166, v162, s34
    v_perm_b32 v94, v174, v170, s34
    v_perm_b32 v95, v182, v178, s34
    v_perm_b32 v96, v158, v154, s35
    v_perm_b32 v97, v166, v162, s35
    v_perm_b32 v98, v174, v170, s35
    v_perm_b32 v99, v182, v178, s35
    v_perm_b32 v100, v159, v155, s34
    v_perm_b32 v101, v167, v163, s34
    v_perm_b32 v102, v175, v171, s34
    v_perm_b32 v103, v183, v179, s34
    v_perm_b32 v104, v159, v155, s35
    v_perm_b32 v105, v167, v163, s35
    v_perm_b32 v106, v175, v171, s35
    v_perm_b32 v107, v183, v179, s35
    v_lshl_or_b32 v108, v185, 16, v184
    v_lshl_or_b32 v109, v187, 16, v186
    v_lshl_or_b32 v110, v189, 16, v188
    v_lshl_or_b32 v111, v191, 16, v190
    v_mov_b32 v23, 0xff800000
    v_cmp_gt_i32 vcc, 0, v6
    s_nop 1
    v_cndmask_b32 v112, 0, v23, vcc
    v_cmp_gt_i32 vcc, 1, v6
    s_nop 1
    v_cndmask_b32 v113, 0, v23, vcc
    v_cmp_gt_i32 vcc, 2, v6
    s_nop 1
    v_cndmask_b32 v114, 0, v23, vcc
    v_cmp_gt_i32 vcc, 3, v6
    s_nop 1
    v_cndmask_b32 v115, 0, v23, vcc
    v_cmp_gt_i32 vcc, 16, v6
    s_nop 1
    v_cndmask_b32 v116, 0, v23, vcc
    v_cmp_gt_i32 vcc, 17, v6
    s_nop 1
    v_cndmask_b32 v117, 0, v23, vcc
    v_cmp_gt_i32 vcc, 18, v6
    s_nop 1
    v_cndmask_b32 v118, 0, v23, vcc
    v_cmp_gt_i32 vcc, 19, v6
    s_nop 1
    v_cndmask_b32 v119, 0, v23, vcc
    s_mov_b32 s44, 0x3fb8aa3b
    s_mov_b32 s50, 0x3db504f3
    s_mov_b32 s29, s49
    s_lshr_b32 s36, s4, 1
    s_lshl_b32 s37, s48, 1
    s_add_u32 s37, s37, s36
    s_lshl_b32 s36, s49, 5
    s_add_u32 s36, s36, s37
    s_mul_i32 s30, s36, 24576
    s_add_u32 s30, s30, 0x1800000
    s_mul_i32 s43, s36, 4096
    s_add_u32 s43, s43, 0x800000
    s_lshl_b32 s51, s37, 7
    s_add_u32 s51, s51, 0x144000
    s_lshl_b32 s52, s37, 7
    s_add_u32 s52, s52, 0x145000
    s_mul_i32 s31, s49, 524288
    s_lshl_b32 s36, s48, 10
    s_add_u32 s31, s31, s36
    s_add_u32 s31, s31, 0x4800000
    s_lshl_b32 s59, s28, 12
    s_lshl_b32 s36, s4, 10
    s_add_u32 s59, s59, s36
    s_add_u32 s59, s59, 0x6800000
    s_lshl_b32 s32, s49, 11
    s_lshl_b32 s36, s48, 7
    s_add_u32 s32, s32, s36
    s_add_u32 s32, s32, 0x20146000
    s_mov_b32 s57, 0xe0000000
    s_mov_b32 s58, 1
    s_mov_b32 s53, 0
    s_mov_b32 s41, s29
A2_a1_32:
    s_cmp_gt_u32 s53, s41
    s_cbranch_scc1 A2_have_33
    buffer_load_dwordx2 v[244:245], off, s[8:11], s51 sc1
    s_waitcnt vmcnt(0)
    v_readfirstlane_b32 s53, v244
    v_readfirstlane_b32 s36, v245
    s_lshl_b32 s53, s53, 1
    s_lshl_b32 s36, s36, 1
    s_add_u32 s36, s36, 1
    s_min_u32 s53, s53, s36
    s_sub_u32 s33, s33, 1
    s_cmp_gt_i32 s33, 0
    s_cbranch_scc1 A2_a1_32
A2_have_33:
    s_and_b32 s54, s4, 1
    s_lshl_b32 s54, s54, 10
    s_add_u32 s54, s54, s30
    s_add_u32 s55, s54, 4096
    buffer_load_dwordx4 v[120:123], v1, s[8:11], s54 offen offset:0 sc1
    buffer_load_dwordx4 v[124:127], v1, s[8:11], s54 offen offset:2048 sc1
    buffer_load_dwordx4 v[128:131], v1, s[8:11], s55 offen offset:0 sc1
    buffer_load_dwordx4 v[132:135], v1, s[8:11], s55 offen offset:2048 sc1
    s_add_u32 s56, s30, 8192
    buffer_load_dwordx4 v[136:139], v1, s[8:11], s56 offen offset:0 sc1
    buffer_load_dwordx4 v[140:143], v1, s[8:11], s56 offen offset:1024 sc1
    buffer_load_dwordx4 v[144:147], v1, s[8:11], s56 offen offset:2048 sc1
    buffer_load_dwordx4 v[148:151], v1, s[8:11], s56 offen offset:3072 sc1
    s_add_u32 s56, s30, 12288
    buffer_load_dwordx4 v[152:155], v1, s[8:11], s56 offen offset:0 sc1
    buffer_load_dwordx4 v[156:159], v1, s[8:11], s56 offen offset:1024 sc1
    buffer_load_dwordx4 v[160:163], v1, s[8:11], s56 offen offset:2048 sc1
    buffer_load_dwordx4 v[164:167], v1, s[8:11], s56 offen offset:3072 sc1
    s_add_u32 s56, s30, 16384
    buffer_load_dwordx4 v[168:171], v1, s[8:11], s56 offen offset:0 sc1
    buffer_load_dwordx4 v[172:175], v1, s[8:11], s56 offen offset:1024 sc1
    buffer_load_dwordx4 v[176:179], v1, s[8:11], s56 offen offset:2048 sc1
    buffer_load_dwordx4 v[180:183], v1, s[8:11], s56 offen offset:3072 sc1
    s_add_u32 s56, s30, 20480
    buffer_load_dwordx4 v[184:187], v1, s[8:11], s56 offen offset:0 sc1
    buffer_load_dwordx4 v[188:191], v1, s[8:11], s56 offen offset:1024 sc1
    buffer_load_dwordx4 v[192:195], v1, s[8:11], s56 offen offset:2048 sc1
    buffer_load_dwordx4 v[196:199], v1, s[8:11], s56 offen offset:3072 sc1
    s_waitcnt vmcnt(0)
A2_loop:
    s_waitcnt vmcnt(9)
    v_mfma_f32_16x16x32_bf16 v[224:227], v[136:139], v[120:123], v[112:115]
    v_mfma_f32_16x16x32_bf16 v[228:231], v[140:143], v[120:123], v[116:119]
    v_mfma_f32_16x16x32_bf16 v[224:227], v[144:147], v[124:127], v[224:227]
    v_mfma_f32_16x16x32_bf16 v[228:231], v[148:151], v[124:127], v[228:231]
    v_mfma_f32_16x16x32_bf16 v[224:227], v[152:155], v[128:131], v[224:227]
    v_mfma_f32_16x16x32_bf16 v[228:231], v[156:159], v[128:131], v[228:231]
    v_mfma_f32_16x16x32_bf16 v[224:227], v[160:163], v[132:135], v[224:227]
    v_mfma_f32_16x16x32_bf16 v[228:231], v[164:167], v[132:135], v[228:231]
    s_mov_b64 exec, 1
    buffer_load_dword v40, off, s[8:11], s43 offset:2040 sc1
    s_mov_b64 exec, -1
    s_nop 3
    v_cvt_pk_bf16_f32 v44, v224, v225
    v_lshlrev_b32 v224, 16, v44
    v_and_b32 v225, s45, v44
    v_cvt_pk_bf16_f32 v45, v226, v227
    v_lshlrev_b32 v226, 16, v45
    v_and_b32 v227, s45, v45
    v_cvt_pk_bf16_f32 v46, v228, v229
    v_lshlrev_b32 v228, 16, v46
    v_and_b32 v229, s45, v46
    v_cvt_pk_bf16_f32 v47, v230, v231
    v_lshlrev_b32 v230, 16, v47
    v_and_b32 v231, s45, v47
    v_mul_f32 v224, s50, v224
    v_mul_f32 v225, s50, v225
    v_mul_f32 v226, s50, v226
    v_mul_f32 v227, s50, v227
    v_mul_f32 v228, s50, v228
    v_mul_f32 v229, s50, v229
    v_mul_f32 v230, s50, v230
    v_mul_f32 v231, s50, v231
    v_cvt_pk_bf16_f32 v44, v224, v225
    v_lshlrev_b32 v224, 16, v44
    v_and_b32 v225, s45, v44
    v_cvt_pk_bf16_f32 v45, v226, v227
    v_lshlrev_b32 v226, 16, v45
    v_and_b32 v227, s45, v45
    v_cvt_pk_bf16_f32 v46, v228, v229
    v_lshlrev_b32 v228, 16, v46
    v_and_b32 v229, s45, v46
    v_cvt_pk_bf16_f32 v47, v230, v231
    v_lshlrev_b32 v230, 16, v47
    v_and_b32 v231, s45, v47
    s_waitcnt vmcnt(0)
    s_waitcnt vmcnt(0)
    s_barrier
    s_cmp_lg_u32 s4, 0
    s_cbranch_scc1 nosig_34
    v_mov_b32 v42, s58
    s_mov_b64 exec, 1
    buffer_store_dword v42, off, s[8:11], s32 sc1
    s_mov_b64 exec, -1
nosig_34:
    s_cmp_ge_u32 s29, 63
    s_cbranch_scc1 A2_fetch
    s_mov_b64 exec, 1
A2_watch:
    v_cmp_ne_u32 vcc, -1, v40
    s_cbranch_vccnz A2_seen
    s_sleep 1
    buffer_load_dword v40, off, s[8:11], s43 offset:2040 sc1
    s_waitcnt vmcnt(0)
    s_sub_u32 s33, s33, 1
    s_cmp_gt_i32 s33, 0
    s_cbranch_scc1 A2_watch
A2_seen:
    s_mov_b64 exec, -1
A2_fetch:
    buffer_load_dwordx2 v[200:201], v4, s[8:11], s43 offen offset:0 sc1
    buffer_load_dwordx2 v[202:203], v4, s[8:11], s43 offen offset:16 sc1
    buffer_load_dwordx2 v[204:205], v4, s[8:11], s43 offen offset:128 sc1
    buffer_load_dwordx2 v[206:207], v4, s[8:11], s43 offen offset:144 sc1
    buffer_load_dwordx2 v[208:209], v4, s[8:11], s43 offen offset:1024 sc1
    buffer_load_dwordx2 v[210:211], v4, s[8:11], s43 offen offset:1040 sc1
    buffer_load_dwordx2 v[212:213], v4, s[8:11], s43 offen offset:1152 sc1
    buffer_load_dwordx2 v[214:215], v4, s[8:11], s43 offen offset:1168 sc1
    buffer_load_dwordx2 v[216:217], v5, s[8:11], s43 offen offset:2048 sc1
    buffer_load_dwordx2 v[218:219], v5, s[8:11], s43 offen offset:2560 sc1
    buffer_load_dwordx2 v[220:221], v5, s[8:11], s43 offen offset:3072 sc1
    buffer_load_dwordx2 v[222:223], v5, s[8:11], s43 offen offset:3584 sc1
    s_waitcnt vmcnt(0)
    v_max3_u32 v40, v200, v202, v204
    v_max_u32 v40, v40, v206
    v_max3_u32 v41, v208, v210, v212
    v_max_u32 v41, v41, v214
    v_max3_u32 v42, v216, v218, v220
    v_max_u32 v42, v42, v222
    v_max3_u32 v40, v40, v41, v42
    v_cmp_eq_u32 vcc, -1, v40
    s_cbranch_vccz A2_have_m
    s_sub_u32 s33, s33, 1
    s_cmp_gt_i32 s33, 0
    s_cbranch_scc1 A2_fetch
A2_have_m:
    v_mfma_f32_16x16x32_bf16 v[232:235], v[200:203], v[120:123], 0
    v_mfma_f32_16x16x32_bf16 v[232:235], v[204:207], v[124:127], v[232:235]
    v_mfma_f32_16x16x32_bf16 v[232:235], v[208:211], v[128:131], v[232:235]
    v_mfma_f32_16x16x32_bf16 v[232:235], v[212:215], v[132:135], v[232:235]
    s_nop 7
    v_cvt_pk_bf16_f32 v44, v232, v233
    v_lshlrev_b32 v232, 16, v44
    v_and_b32 v233, s45, v44
    v_mul_f32 v232, s50, v232
    v_mul_f32 v233, s50, v233
    v_cvt_pk_bf16_f32 v44, v232, v233
    v_lshlrev_b32 v232, 16, v44
    v_and_b32 v233, s45, v44
    v_max3_f32 v40, v224, v225, v226
    v_max3_f32 v41, v227, v228, v229
    v_max3_f32 v40, v40, v230, v231
    v_max3_f32 v41, v41, v232, v233
    v_max_f32 v42, v40, v41
    v_max_f32 v43, v40, v41
    s_nop 1
    v_permlane16_swap_b32 v42, v43
    v_max_f32 v40, v42, v43
    v_max_f32 v41, v42, v43
    s_nop 1
    v_permlane32_swap_b32 v40, v41
    v_max_f32 v42, v40, v41
    v_sub_f32 v224, v224, v42
    v_sub_f32 v225, v225, v42
    v_sub_f32 v226, v226, v42
    v_sub_f32 v227, v227, v42
    v_sub_f32 v228, v228, v42
    v_sub_f32 v229, v229, v42
    v_sub_f32 v230, v230, v42
    v_sub_f32 v231, v231, v42
    v_sub_f32 v232, v232, v42
    v_sub_f32 v233, v233, v42
    v_mul_f32 v224, s44, v224
    v_mul_f32 v225, s44, v225
    v_mul_f32 v226, s44, v226
    v_mul_f32 v227, s44, v227
    v_mul_f32 v228, s44, v228
    v_mul_f32 v229, s44, v229
    v_mul_f32 v230, s44, v230
    v_mul_f32 v231, s44, v231
    v_mul_f32 v232, s44, v232
    v_mul_f32 v233, s44, v233
    v_exp_f32 v224, v224
    v_exp_f32 v225, v225
    v_exp_f32 v226, v226
    v_exp_f32 v227, v227
    v_exp_f32 v228, v228
    v_exp_f32 v229, v229
    v_exp_f32 v230, v230
    v_exp_f32 v231, v231
    v_exp_f32 v232, v232
    v_exp_f32 v233, v233
    v_add_f32 v40, v224, v225
    v_add_f32 v41, v226, v227
    v_add_f32 v40, v40, v228
    v_add_f32 v41, v41, v229
    v_add_f32 v40, v40, v230
    v_add_f32 v41, v41, v231
    v_add_f32 v40, v40, v232
    v_add_f32 v41, v41, v233
    v_add_f32 v42, v40, v41
    v_add_f32 v43, v40, v41
    s_nop 1
    v_permlane16_swap_b32 v42, v43
    v_add_f32 v40, v42, v43
    v_add_f32 v41, v42, v43
    s_nop 1
    v_permlane32_swap_b32 v40, v41
    v_add_f32 v42, v40, v41
    v_rcp_f32 v42, v42
    s_nop 0
    v_mul_f32 v224, v224, v42
    v_mul_f32 v225, v225, v42
    v_mul_f32 v226, v226, v42
    v_mul_f32 v227, v227, v42
    v_mul_f32 v228, v228, v42
    v_mul_f32 v229, v229, v42
    v_mul_f32 v230, v230, v42
    v_mul_f32 v231, v231, v42
    v_mul_f32 v232, v232, v42
    v_mul_f32 v233, v233, v42
    v_cvt_pk_bf16_f32 v236, v224, v225
    v_cvt_pk_bf16_f32 v237, v226, v227
    v_cvt_pk_bf16_f32 v238, v228, v229
    v_cvt_pk_bf16_f32 v239, v230, v231
    v_cvt_pk_bf16_f32 v240, v232, v233
    v_mov_b32 v241, 0
    v_mov_b32 v242, 0
    v_mov_b32 v243, v240
    s_waitcnt vmcnt(0)
    v_mfma_f32_16x16x32_bf16 v[8:11], v[168:171], v[236:239], 0
    v_mfma_f32_16x16x32_bf16 v[12:15], v[172:175], v[236:239], 0
    v_mfma_f32_16x16x32_bf16 v[16:19], v[176:179], v[236:239], 0
    v_mfma_f32_16x16x32_bf16 v[20:23], v[180:183], v[236:239], 0
    v_mfma_f32_16x16x32_bf16 v[24:27], v[184:187], v[236:239], 0
    v_mfma_f32_16x16x32_bf16 v[28:31], v[188:191], v[236:239], 0
    v_mfma_f32_16x16x32_bf16 v[32:35], v[192:195], v[236:239], 0
    v_mfma_f32_16x16x32_bf16 v[36:39], v[196:199], v[236:239], 0
    v_mfma_f32_16x16x16_bf16 v[8:11], v[216:217], v[240:241], v[8:11]
    v_mfma_f32_16x16x16_bf16 v[12:15], v[216:217], v[242:243], v[12:15]
    v_mfma_f32_16x16x16_bf16 v[16:19], v[218:219], v[240:241], v[16:19]
    v_mfma_f32_16x16x16_bf16 v[20:23], v[218:219], v[242:243], v[20:23]
    v_mfma_f32_16x16x16_bf16 v[24:27], v[220:221], v[240:241], v[24:27]
    v_mfma_f32_16x16x16_bf16 v[28:31], v[220:221], v[242:243], v[28:31]
    v_mfma_f32_16x16x16_bf16 v[32:35], v[222:223], v[240:241], v[32:35]
    v_mfma_f32_16x16x16_bf16 v[36:39], v[222:223], v[242:243], v[36:39]
    s_lshr_b32 s36, s4, 1
    s_lshl_b32 s36, s36, 13
    s_and_b32 s37, s4, 1
    s_lshl_b32 s37, s37, 10
    s_add_u32 s36, s36, s37
    v_add_u32 v40, s36, v1
    v_cvt_pk_bf16_f32 v44, v8, v12
    v_cvt_pk_bf16_f32 v45, v9, v13
    v_cvt_pk_bf16_f32 v46, v10, v14
    v_cvt_pk_bf16_f32 v47, v11, v15
    ds_write_b128 v40, v[44:47] offset:0
    v_cvt_pk_bf16_f32 v48, v16, v20
    v_cvt_pk_bf16_f32 v49, v17, v21
    v_cvt_pk_bf16_f32 v50, v18, v22
    v_cvt_pk_bf16_f32 v51, v19, v23
    ds_write_b128 v40, v[48:51] offset:2048
    v_cvt_pk_bf16_f32 v52, v24, v28
    v_cvt_pk_bf16_f32 v53, v25, v29
    v_cvt_pk_bf16_f32 v54, v26, v30
    v_cvt_pk_bf16_f32 v55, v27, v31
    ds_write_b128 v40, v[52:55] offset:4096
    v_cvt_pk_bf16_f32 v56, v32, v36
    v_cvt_pk_bf16_f32 v57, v33, v37
    v_cvt_pk_bf16_f32 v58, v34, v38
    v_cvt_pk_bf16_f32 v59, v35, v39
    ds_write_b128 v40, v[56:59] offset:6144
    s_add_u32 s29, s29, 3
    s_add_u32 s30, s30, 2359296
    s_add_u32 s43, s43, 393216
    s_min_u32 s41, s29, 63
    s_cmp_lt_u32 s29, 64
    s_cselect_b32 s30, s30, 0x20000000
A2_a1_35:
    s_cmp_gt_u32 s53, s41
    s_cbranch_scc1 A2_have_36
    buffer_load_dwordx2 v[244:245], off, s[8:11], s51 sc1
    s_waitcnt vmcnt(0)
    v_readfirstlane_b32 s53, v244
    v_readfirstlane_b32 s36, v245
    s_lshl_b32 s53, s53, 1
    s_lshl_b32 s36, s36, 1
    s_add_u32 s36, s36, 1
    s_min_u32 s53, s53, s36
    s_sub_u32 s33, s33, 1
    s_cmp_gt_i32 s33, 0
    s_cbranch_scc1 A2_a1_35
A2_have_36:
    s_and_b32 s54, s4, 1
    s_lshl_b32 s54, s54, 10
    s_add_u32 s54, s54, s30
    s_add_u32 s55, s54, 4096
    s_waitcnt lgkmcnt(0)
    s_barrier
    ds_read_b128 v[200:203], v1 offset:0
    ds_read_b128 v[204:207], v1 offset:2048
    ds_read_b128 v[208:211], v1 offset:4096
    ds_read_b128 v[212:215], v1 offset:6144
    ds_read_b128 v[216:219], v1 offset:8192
    ds_read_b128 v[220:223], v1 offset:10240
    ds_read_b128 v[224:227], v1 offset:12288
    ds_read_b128 v[228:231], v1 offset:14336
    s_waitcnt lgkmcnt(7)
    v_mfma_f32_16x16x32_bf16 v[8:11], v[200:203], a[0:3], 0
    v_mfma_f32_16x16x32_bf16 v[12:15], v[200:203], a[4:7], 0
    v_mfma_f32_16x16x32_bf16 v[16:19], v[200:203], a[8:11], 0
    buffer_load_dwordx4 v[120:123], v1, s[8:11], s54 offen offset:0 sc1
    v_mfma_f32_16x16x32_bf16 v[20:23], v[200:203], a[12:15], 0
    v_mfma_f32_16x16x32_bf16 v[24:27], v[200:203], a[16:19], 0
    v_mfma_f32_16x16x32_bf16 v[28:31], v[200:203], a[20:23], 0
    buffer_load_dwordx4 v[124:127], v1, s[8:11], s54 offen offset:2048 sc1
    v_mfma_f32_16x16x32_bf16 v[32:35], v[200:203], a[24:27], 0
    v_mfma_f32_16x16x32_bf16 v[36:39], v[200:203], a[28:31], 0
    v_mfma_f32_16x16x32_bf16 v[40:43], a[32:35], v[200:203], 0
    buffer_load_dwordx4 v[128:131], v1, s[8:11], s55 offen offset:0 sc1
    ds_read_b128 v[200:203], v1 offset:1024
    s_waitcnt lgkmcnt(7)
    v_mfma_f32_16x16x32_bf16 v[8:11], v[204:207], a[36:39], v[8:11]
    v_mfma_f32_16x16x32_bf16 v[12:15], v[204:207], a[40:43], v[12:15]
    v_mfma_f32_16x16x32_bf16 v[16:19], v[204:207], a[44:47], v[16:19]
    buffer_load_dwordx4 v[132:135], v1, s[8:11], s55 offen offset:2048 sc1
    v_mfma_f32_16x16x32_bf16 v[20:23], v[204:207], a[48:51], v[20:23]
    v_mfma_f32_16x16x32_bf16 v[24:27], v[204:207], a[52:55], v[24:27]
    v_mfma_f32_16x16x32_bf16 v[28:31], v[204:207], a[56:59], v[28:31]
    s_add_u32 s56, s30, 8192
    buffer_load_dwordx4 v[136:139], v1, s[8:11], s56 offen offset:0 sc1
    v_mfma_f32_16x16x32_bf16 v[32:35], v[204:207], a[60:63], v[32:35]
    v_mfma_f32_16x16x32_bf16 v[36:39], v[204:207], a[64:67], v[36:39]
    v_mfma_f32_16x16x32_bf16 v[40:43], a[68:71], v[204:207], v[40:43]
    buffer_load_dwordx4 v[140:143], v1, s[8:11], s56 offen offset:1024 sc1
    ds_read_b128 v[204:207], v1 offset:3072
    s_waitcnt lgkmcnt(7)
    v_mfma_f32_16x16x32_bf16 v[8:11], v[208:211], a[72:75], v[8:11]
    v_mfma_f32_16x16x32_bf16 v[12:15], v[208:211], a[76:79], v[12:15]
    v_mfma_f32_16x16x32_bf16 v[16:19], v[208:211], a[80:83], v[16:19]
    buffer_load_dwordx4 v[144:147], v1, s[8:11], s56 offen offset:2048 sc1
    v_mfma_f32_16x16x32_bf16 v[20:23], v[208:211], a[84:87], v[20:23]
    v_mfma_f32_16x16x32_bf16 v[24:27], v[208:211], a[88:91], v[24:27]
    v_mfma_f32_16x16x32_bf16 v[28:31], v[208:211], a[92:95], v[28:31]
    buffer_load_dwordx4 v[148:151], v1, s[8:11], s56 offen offset:3072 sc1
    v_mfma_f32_16x16x32_bf16 v[32:35], v[208:211], a[96:99], v[32:35]
    v_mfma_f32_16x16x32_bf16 v[36:39], v[208:211], a[100:103], v[36:39]
    v_mfma_f32_16x16x32_bf16 v[40:43], a[104:107], v[208:211], v[40:43]
    s_add_u32 s56, s30, 12288
    buffer_load_dwordx4 v[152:155], v1, s[8:11], s56 offen offset:0 sc1
    ds_read_b128 v[208:211], v1 offset:5120
    s_waitcnt lgkmcnt(7)
    v_mfma_f32_16x16x32_bf16 v[8:11], v[212:215], a[108:111], v[8:11]
    v_mfma_f32_16x16x32_bf16 v[12:15], v[212:215], a[112:115], v[12:15]
    v_mfma_f32_16x16x32_bf16 v[16:19], v[212:215], a[116:119], v[16:19]
    buffer_load_dwordx4 v[156:159], v1, s[8:11], s56 offen offset:1024 sc1
    v_mfma_f32_16x16x32_bf16 v[20:23], v[212:215], a[120:123], v[20:23]
    v_mfma_f32_16x16x32_bf16 v[24:27], v[212:215], a[124:127], v[24:27]
    v_mfma_f32_16x16x32_bf16 v[28:31], v[212:215], a[128:131], v[28:31]
    buffer_load_dwordx4 v[160:163], v1, s[8:11], s56 offen offset:2048 sc1
    v_mfma_f32_16x16x32_bf16 v[32:35], v[212:215], a[132:135], v[32:35]
    v_mfma_f32_16x16x32_bf16 v[36:39], v[212:215], a[136:139], v[36:39]
    v_mfma_f32_16x16x32_bf16 v[40:43], a[140:143], v[212:215], v[40:43]
    buffer_load_dwordx4 v[164:167], v1, s[8:11], s56 offen offset:3072 sc1
    ds_read_b128 v[212:215], v1 offset:7168
    s_waitcnt lgkmcnt(7)
    v_mfma_f32_16x16x32_bf16 v[8:11], v[216:219], a[144:147], v[8:11]
    v_mfma_f32_16x16x32_bf16 v[12:15], v[216:219], a[148:151], v[12:15]
    v_mfma_f32_16x16x32_bf16 v[16:19], v[216:219], a[152:155], v[16:19]
    s_add_u32 s56, s30, 16384
    buffer_load_dwordx4 v[168:171], v1, s[8:11], s56 offen offset:0 sc1
    v_mfma_f32_16x16x32_bf16 v[20:23], v[216:219], a[156:159], v[20:23]
    v_mfma_f32_16x16x32_bf16 v[24:27], v[216:219], a[160:163], v[24:27]
    v_mfma_f32_16x16x32_bf16 v[28:31], v[216:219], a[164:167], v[28:31]
    buffer_load_dwordx4 v[172:175], v1, s[8:11], s56 offen offset:1024 sc1
    v_mfma_f32_16x16x32_bf16 v[32:35], v[216:219], a[168:171], v[32:35]
    v_mfma_f32_16x16x32_bf16 v[36:39], v[216:219], a[172:175], v[36:39]
    v_mfma_f32_16x16x32_bf16 v[40:43], a[176:179], v[216:219], v[40:43]
    buffer_load_dwordx4 v[176:179], v1, s[8:11], s56 offen offset:2048 sc1
    ds_read_b128 v[216:219], v1 offset:9216
    s_waitcnt lgkmcnt(7)
    v_mfma_f32_16x16x32_bf16 v[8:11], v[220:223], a[180:183], v[8:11]
    v_mfma_f32_16x16x32_bf16 v[12:15], v[220:223], a[184:187], v[12:15]
    v_mfma_f32_16x16x32_bf16 v[16:19], v[220:223], a[188:191], v[16:19]
    buffer_load_dwordx4 v[180:183], v1, s[8:11], s56 offen offset:3072 sc1
    v_mfma_f32_16x16x32_bf16 v[20:23], v[220:223], a[192:195], v[20:23]
    v_mfma_f32_16x16x32_bf16 v[24:27], v[220:223], a[196:199], v[24:27]
    v_mfma_f32_16x16x32_bf16 v[28:31], v[220:223], a[200:203], v[28:31]
    s_add_u32 s56, s30, 20480
    buffer_load_dwordx4 v[184:187], v1, s[8:11], s56 offen offset:0 sc1
    v_mfma_f32_16x16x32_bf16 v[32:35], v[220:223], a[204:207], v[32:35]
    v_mfma_f32_16x16x32_bf16 v[36:39], v[220:223], a[208:211], v[36:39]
    v_mfma_f32_16x16x32_bf16 v[40:43], a[212:215], v[220:223], v[40:43]
    buffer_load_dwordx4 v[188:191], v1, s[8:11], s56 offen offset:1024 sc1
    ds_read_b128 v[220:223], v1 offset:11264
    s_waitcnt lgkmcnt(7)
    v_mfma_f32_16x16x32_bf16 v[8:11], v[224:227], a[216:219], v[8:11]
    v_mfma_f32_16x16x32_bf16 v[12:15], v[224:227], a[220:223], v[12:15]
    v_mfma_f32_16x16x32_bf16 v[16:19], v[224:227], a[224:227], v[16:19]
    buffer_load_dwordx4 v[192:195], v1, s[8:11], s56 offen offset:2048 sc1
    v_mfma_f32_16x16x32_bf16 v[20:23], v[224:227], a[228:231], v[20:23]
    v_mfma_f32_16x16x32_bf16 v[24:27], v[224:227], a[232:235], v[24:27]
    v_mfma_f32_16x16x32_bf16 v[28:31], v[224:227], a[236:239], v[28:31]
    buffer_load_dwordx4 v[196:199], v1, s[8:11], s56 offen offset:3072 sc1
    v_mfma_f32_16x16x32_bf16 v[32:35], v[224:227], a[240:243], v[32:35]
    v_mfma_f32_16x16x32_bf16 v[36:39], v[224:227], a[244:247], v[36:39]
    v_mfma_f32_16x16x32_bf16 v[40:43], a[248:251], v[224:227], v[40:43]
    ds_read_b128 v[224:227], v1 offset:13312
    s_waitcnt lgkmcnt(7)
    v_mfma_f32_16x16x32_bf16 v[8:11], v[228:231], a[252:255], v[8:11]
    v_mfma_f32_16x16x32_bf16 v[12:15], v[228:231], v[80:83], v[12:15]
    v_mfma_f32_16x16x32_bf16 v[16:19], v[228:231], v[84:87], v[16:19]
    v_mfma_f32_16x16x32_bf16 v[20:23], v[228:231], v[88:91], v[20:23]
    v_mfma_f32_16x16x32_bf16 v[24:27], v[228:231], v[92:95], v[24:27]
    v_mfma_f32_16x16x32_bf16 v[28:31], v[228:231], v[96:99], v[28:31]
    v_mfma_f32_16x16x32_bf16 v[32:35], v[228:231], v[100:103], v[32:35]
    v_mfma_f32_16x16x32_bf16 v[36:39], v[228:231], v[104:107], v[36:39]
    v_mfma_f32_16x16x32_bf16 v[40:43], v[108:111], v[228:231], v[40:43]
    ds_read_b128 v[228:231], v1 offset:15360
    s_waitcnt lgkmcnt(7)
    v_mfma_f32_16x16x32_bf16 v[44:47], v[200:203], a[0:3], 0
    v_mfma_f32_16x16x32_bf16 v[48:51], v[200:203], a[4:7], 0
    v_mfma_f32_16x16x32_bf16 v[52:55], v[200:203], a[8:11], 0
    v_mfma_f32_16x16x32_bf16 v[56:59], v[200:203], a[12:15], 0
    v_mfma_f32_16x16x32_bf16 v[60:63], v[200:203], a[16:19], 0
    v_cvt_pk_bf16_f32 v248, v8, v12
    v_cvt_pk_bf16_f32 v249, v16, v20
    v_mfma_f32_16x16x32_bf16 v[64:67], v[200:203], a[20:23], 0
    v_mfma_f32_16x16x32_bf16 v[68:71], v[200:203], a[24:27], 0
    v_mfma_f32_16x16x32_bf16 v[72:75], v[200:203], a[28:31], 0
    v_mfma_f32_16x16x32_bf16 v[76:79], a[32:35], v[200:203], 0
    s_waitcnt lgkmcnt(6)
    v_mfma_f32_16x16x32_bf16 v[44:47], v[204:207], a[36:39], v[44:47]
    v_cvt_pk_bf16_f32 v250, v24, v28
    v_cvt_pk_bf16_f32 v251, v32, v36
    v_mfma_f32_16x16x32_bf16 v[48:51], v[204:207], a[40:43], v[48:51]
    v_mfma_f32_16x16x32_bf16 v[52:55], v[204:207], a[44:47], v[52:55]
    v_mfma_f32_16x16x32_bf16 v[56:59], v[204:207], a[48:51], v[56:59]
    v_mfma_f32_16x16x32_bf16 v[60:63], v[204:207], a[52:55], v[60:63]
    v_mfma_f32_16x16x32_bf16 v[64:67], v[204:207], a[56:59], v[64:67]
    s_add_u32 s36, s31, 0
    buffer_store_dwordx4 v[248:251], v2, s[8:11], s36 offen sc1
    v_mfma_f32_16x16x32_bf16 v[68:71], v[204:207], a[60:63], v[68:71]
    v_mfma_f32_16x16x32_bf16 v[72:75], v[204:207], a[64:67], v[72:75]
    v_mfma_f32_16x16x32_bf16 v[76:79], a[68:71], v[204:207], v[76:79]
    s_waitcnt lgkmcnt(5)
    v_mfma_f32_16x16x32_bf16 v[44:47], v[208:211], a[72:75], v[44:47]
    v_mfma_f32_16x16x32_bf16 v[48:51], v[208:211], a[76:79], v[48:51]
    v_cvt_pk_bf16_f32 v252, v9, v13
    v_cvt_pk_bf16_f32 v253, v17, v21
    v_mfma_f32_16x16x32_bf16 v[52:55], v[208:211], a[80:83], v[52:55]
    v_mfma_f32_16x16x32_bf16 v[56:59], v[208:211], a[84:87], v[56:59]
    v_mfma_f32_16x16x32_bf16 v[60:63], v[208:211], a[88:91], v[60:63]
    v_mfma_f32_16x16x32_bf16 v[64:67], v[208:211], a[92:95], v[64:67]
    v_mfma_f32_16x16x32_bf16 v[68:71], v[208:211], a[96:99], v[68:71]
    v_cvt_pk_bf16_f32 v254, v25, v29
    v_cvt_pk_bf16_f32 v255, v33, v37
    v_mfma_f32_16x16x32_bf16 v[72:75], v[208:211], a[100:103], v[72:75]
    v_mfma_f32_16x16x32_bf16 v[76:79], a[104:107], v[208:211], v[76:79]
    s_waitcnt lgkmcnt(4)
    v_mfma_f32_16x16x32_bf16 v[44:47], v[212:215], a[108:111], v[44:47]
    v_mfma_f32_16x16x32_bf16 v[48:51], v[212:215], a[112:115], v[48:51]
    v_mfma_f32_16x16x32_bf16 v[52:55], v[212:215], a[116:119], v[52:55]
    s_add_u32 s36, s31, 16384
    buffer_store_dwordx4 v[252:255], v2, s[8:11], s36 offen sc1
    v_mfma_f32_16x16x32_bf16 v[56:59], v[212:215], a[120:123], v[56:59]
    v_mfma_f32_16x16x32_bf16 v[60:63], v[212:215], a[124:127], v[60:63]
    v_mfma_f32_16x16x32_bf16 v[64:67], v[212:215], a[128:131], v[64:67]
    v_mfma_f32_16x16x32_bf16 v[68:71], v[212:215], a[132:135], v[68:71]
    v_mfma_f32_16x16x32_bf16 v[72:75], v[212:215], a[136:139], v[72:75]
    v_cvt_pk_bf16_f32 v248, v10, v14
    v_cvt_pk_bf16_f32 v249, v18, v22
    v_mfma_f32_16x16x32_bf16 v[76:79], a[140:143], v[212:215], v[76:79]
    s_waitcnt lgkmcnt(3)
    v_mfma_f32_16x16x32_bf16 v[44:47], v[216:219], a[144:147], v[44:47]
    v_mfma_f32_16x16x32_bf16 v[48:51], v[216:219], a[148:151], v[48:51]
    v_mfma_f32_16x16x32_bf16 v[52:55], v[216:219], a[152:155], v[52:55]
    v_mfma_f32_16x16x32_bf16 v[56:59], v[216:219], a[156:159], v[56:59]
    v_cvt_pk_bf16_f32 v250, v26, v30
    v_cvt_pk_bf16_f32 v251, v34, v38
    v_mfma_f32_16x16x32_bf16 v[60:63], v[216:219], a[160:163], v[60:63]
    v_mfma_f32_16x16x32_bf16 v[64:67], v[216:219], a[164:167], v[64:67]
    v_mfma_f32_16x16x32_bf16 v[68:71], v[216:219], a[168:171], v[68:71]
    v_mfma_f32_16x16x32_bf16 v[72:75], v[216:219], a[172:175], v[72:75]
    v_mfma_f32_16x16x32_bf16 v[76:79], a[176:179], v[216:219], v[76:79]
    s_add_u32 s36, s31, 32768
    buffer_store_dwordx4 v[248:251], v2, s[8:11], s36 offen sc1
    s_waitcnt lgkmcnt(2)
    v_mfma_f32_16x16x32_bf16 v[44:47], v[220:223], a[180:183], v[44:47]
    v_mfma_f32_16x16x32_bf16 v[48:51], v[220:223], a[184:187], v[48:51]
    v_mfma_f32_16x16x32_bf16 v[52:55], v[220:223], a[188:191], v[52:55]
    v_mfma_f32_16x16x32_bf16 v[56:59], v[220:223], a[192:195], v[56:59]
    v_mfma_f32_16x16x32_bf16 v[60:63], v[220:223], a[196:199], v[60:63]
    v_cvt_pk_bf16_f32 v252, v11, v15
    v_cvt_pk_bf16_f32 v253, v19, v23
    v_mfma_f32_16x16x32_bf16 v[64:67], v[220:223], a[200:203], v[64:67]
    v_mfma_f32_16x16x32_bf16 v[68:71], v[220:223], a[204:207], v[68:71]
    v_mfma_f32_16x16x32_bf16 v[72:75], v[220:223], a[208:211], v[72:75]
    v_mfma_f32_16x16x32_bf16 v[76:79], a[212:215], v[220:223], v[76:79]
    s_waitcnt lgkmcnt(1)
    v_mfma_f32_16x16x32_bf16 v[44:47], v[224:227], a[216:219], v[44:47]
    v_cvt_pk_bf16_f32 v254, v27, v31
    v_cvt_pk_bf16_f32 v255, v35, v39
    v_mfma_f32_16x16x32_bf16 v[48:51], v[224:227], a[220:223], v[48:51]
    v_mfma_f32_16x16x32_bf16 v[52:55], v[224:227], a[224:227], v[52:55]
    v_mfma_f32_16x16x32_bf16 v[56:59], v[224:227], a[228:231], v[56:59]
    v_mfma_f32_16x16x32_bf16 v[60:63], v[224:227], a[232:235], v[60:63]
    v_mfma_f32_16x16x32_bf16 v[64:67], v[224:227], a[236:239], v[64:67]
    s_add_u32 s36, s31, 49152
    buffer_store_dwordx4 v[252:255], v2, s[8:11], s36 offen sc1
    v_mfma_f32_16x16x32_bf16 v[68:71], v[224:227], a[240:243], v[68:71]
    v_mfma_f32_16x16x32_bf16 v[72:75], v[224:227], a[244:247], v[72:75]
    v_mfma_f32_16x16x32_bf16 v[76:79], a[248:251], v[224:227], v[76:79]
    s_waitcnt lgkmcnt(0)
    v_mfma_f32_16x16x32_bf16 v[44:47], v[228:231], a[252:255], v[44:47]
    v_mfma_f32_16x16x32_bf16 v[48:51], v[228:231], v[80:83], v[48:51]
    v_cvt_pk_bf16_f32 v244, v40, v41
    v_cvt_pk_bf16_f32 v245, v42, v43
    v_mfma_f32_16x16x32_bf16 v[52:55], v[228:231], v[84:87], v[52:55]
    v_mfma_f32_16x16x32_bf16 v[56:59], v[228:231], v[88:91], v[56:59]
    v_mfma_f32_16x16x32_bf16 v[60:63], v[228:231], v[92:95], v[60:63]
    v_mfma_f32_16x16x32_bf16 v[64:67], v[228:231], v[96:99], v[64:67]
    v_mfma_f32_16x16x32_bf16 v[68:71], v[228:231], v[100:103], v[68:71]
    v_mfma_f32_16x16x32_bf16 v[72:75], v[228:231], v[104:107], v[72:75]
    v_mfma_f32_16x16x32_bf16 v[76:79], v[108:111], v[228:231], v[76:79]
    v_cvt_pk_bf16_f32 v248, v44, v48
    s_nop 1
    v_cvt_pk_bf16_f32 v249, v52, v56
    s_nop 0
    v_cvt_pk_bf16_f32 v250, v60, v64
    s_nop 0
    v_cvt_pk_bf16_f32 v251, v68, v72
    s_add_u32 s36, s31, 262144
    buffer_store_dwordx4 v[248:251], v2, s[8:11], s36 offen sc1
    v_cvt_pk_bf16_f32 v252, v45, v49
    v_cvt_pk_bf16_f32 v253, v53, v57
    v_cvt_pk_bf16_f32 v254, v61, v65
    v_cvt_pk_bf16_f32 v255, v69, v73
    s_add_u32 s36, s31, 278528
    buffer_store_dwordx4 v[252:255], v2, s[8:11], s36 offen sc1
    v_cvt_pk_bf16_f32 v248, v46, v50
    v_cvt_pk_bf16_f32 v249, v54, v58
    v_cvt_pk_bf16_f32 v250, v62, v66
    v_cvt_pk_bf16_f32 v251, v70, v74
    s_add_u32 s36, s31, 294912
    buffer_store_dwordx4 v[248:251], v2, s[8:11], s36 offen sc1
    v_cvt_pk_bf16_f32 v252, v47, v51
    v_cvt_pk_bf16_f32 v253, v55, v59
    v_cvt_pk_bf16_f32 v254, v63, v67
    v_cvt_pk_bf16_f32 v255, v71, v75
    s_add_u32 s36, s31, 311296
    buffer_store_dwordx4 v[252:255], v2, s[8:11], s36 offen sc1
    v_cvt_pk_bf16_f32 v246, v76, v77
    v_cvt_pk_bf16_f32 v247, v78, v79
    s_nop 0
    v_permlane16_swap_b32 v244, v246
    v_permlane16_swap_b32 v245, v247
    buffer_store_dwordx4 v[244:247], v1, s[8:11], s59 offen sc1
    s_add_u32 s31, s31, 1572864
    s_add_u32 s59, s59, 196608
    s_add_u32 s32, s32, s57
    s_mov_b32 s57, 6144
    s_cmp_lt_u32 s29, 64
    s_cbranch_scc1 A2_loop
    s_waitcnt vmcnt(0)
    s_barrier
    s_cmp_lg_u32 s4, 0
    s_cbranch_scc1 nosig_37
    v_mov_b32 v42, s58
    s_mov_b64 exec, 1
    buffer_store_dword v42, off, s[8:11], s32 sc1
    s_mov_b64 exec, -1
nosig_37:
    s_waitcnt vmcnt(0)
    s_endpgm
CF_entry:
    s_mov_b32 s33, 400000
    s_cmp_lg_u32 s4, 0
    s_cbranch_scc1 dwok_39
dw_38:
    buffer_load_dword v23, off, s[12:15], 0 offset:64 sc1
    s_waitcnt vmcnt(0)
    v_readfirstlane_b32 s36, v23
    s_nop 0
    s_cmp_ge_u32 s36, 128
    s_cbranch_scc1 dwok_39
    s_sleep 32
    s_sub_u32 s33, s33, 1
    s_cmp_gt_i32 s33, 0
    s_cbranch_scc1 dw_38
dwok_39:
    s_barrier
    s_mul_i32 s60, s4, 40
    s_add_u32 s60, s60, s28
    s_mov_b32 s61, 1792
    s_mov_b32 s62, 160
CF_common:
    v_and_b32 v20, 63, v0
    v_and_b32 v21, 15, v20
    v_lshrrev_b32 v22, 4, v20
    v_lshlrev_b32 v1, 4, v20
    s_mov_b32 s34, 0x05040100
    s_mov_b32 s35, 0x07060302
    s_mov_b32 s45, 0xffff0000
    s_mov_b32 s33, 400000
    s_load_dwordx2 s[16:17], s[0:1], 0
    s_mov_b32 s18, 0x240000
    s_mov_b32 s19, 0x20000
    s_load_dwordx2 s[20:21], s[0:1], 104
    s_mov_b32 s22, 0x240000
    s_mov_b32 s23, 0x20000
    v_and_b32 v23, 1, v22
    v_lshlrev_b32 v24, 10, v23
    v_lshrrev_b32 v25, 1, v22
    v_lshl_add_u32 v25, v25, 4, v21
    v_lshl_add_u32 v2, v25, 4, v24
    v_lshlrev_b32 v26, 9, v23
    v_lshl_add_u32 v124, v25, 4, v26
    v_lshlrev_b32 v26, 12, v23
    v_lshl_add_u32 v26, v21, 9, v26
    v_mov_b32 v24, 0x20000000
    v_cmp_gt_u32 vcc, 8, v20
    s_nop 1
    v_cndmask_b32 v125, v24, v124, vcc
    v_cmp_gt_u32 s[46:47], 8, v25
    s_nop 1
    v_cndmask_b32 v3, v24, v26, s[46:47]
    v_lshlrev_b32 v25, 4, v25
    v_lshl_add_u32 v4, v23, 3, v25
    v_cndmask_b32 v5, v24, v4, s[46:47]
    v_and_b32 v23, 16, v1
    v_mov_b32 v24, 0x3f80
    v_lshlrev_b32 v23, v23, v24
    v_lshrrev_b32 v24, 1, v21
    v_lshrrev_b32 v25, 1, v22
    v_lshlrev_b32 v25, 2, v25
    v_xor_b32 v24, v24, v25
    v_cmp_eq_u32 vcc, 0, v24
    s_nop 1
    v_cndmask_b32 v12, 0, v23, vcc
    v_cmp_eq_u32 vcc, 1, v24
    s_nop 1
    v_cndmask_b32 v13, 0, v23, vcc
    v_cmp_eq_u32 vcc, 2, v24
    s_nop 1
    v_cndmask_b32 v14, 0, v23, vcc
    v_cmp_eq_u32 vcc, 3, v24
    s_nop 1
    v_cndmask_b32 v15, 0, v23, vcc
    s_mov_b32 s41, 1
    s_mov_b32 s38, 0x1ee000
    v_lshlrev_b32 v25, 3, v1
    s_mov_b32 exec_lo, 0xffffffff
    s_mov_b32 exec_hi, 0x3fffff
poll_40:
    buffer_load_dword v24, v25, s[8:11], s38 offen sc1
    s_waitcnt vmcnt(0)
    v_cmp_gt_u32 vcc, s41, v24
    s_cbranch_vccz pollok_41
    s_sleep 2
    s_sub_u32 s33, s33, 1
    s_cmp_gt_i32 s33, 0
    s_cbranch_scc1 poll_40
pollok_41:
    s_mov_b64 exec, -1
    s_mov_b32 s38, 0x1efb00
    v_lshlrev_b32 v25, 3, v1
    s_mov_b32 exec_lo, 0xffffffff
    s_mov_b32 exec_hi, 0x3fffff
poll_42:
    buffer_load_dword v24, v25, s[8:11], s38 offen sc1
    s_waitcnt vmcnt(0)
    v_cmp_gt_u32 vcc, s41, v24
    s_cbranch_vccz pollok_43
    s_sleep 2
    s_sub_u32 s33, s33, 1
    s_cmp_gt_i32 s33, 0
    s_cbranch_scc1 poll_42
pollok_43:
    s_mov_b64 exec, -1
    v_lshlrev_b32 v23, 1, v4
    v_lshlrev_b32 v24, 1, v5
    s_mov_b32 s36, 0x141200
    buffer_load_dwordx4 v[28:31], v23, s[8:11], s36 offen offset:0 sc1
    buffer_load_dwordx4 v[32:35], v23, s[8:11], s36 offen offset:1024 sc1
    buffer_load_dwordx4 v[36:39], v24, s[8:11], s36 offen offset:2048 sc1
    s_mov_b32 s36, 0x141b00
    buffer_load_dwordx4 v[52:55], v23, s[8:11], s36 offen offset:0 sc1
    buffer_load_dwordx4 v[56:59], v23, s[8:11], s36 offen offset:1024 sc1
    buffer_load_dwordx4 v[60:63], v24, s[8:11], s36 offen offset:2048 sc1
    s_mov_b32 s36, 0x142400
    buffer_load_dwordx4 v[40:43], v23, s[8:11], s36 offen offset:0 sc1
    buffer_load_dwordx4 v[44:47], v23, s[8:11], s36 offen offset:1024 sc1
    buffer_load_dwordx4 v[48:51], v24, s[8:11], s36 offen offset:2048 sc1
    s_mov_b32 s36, 0x142d00
    buffer_load_dwordx4 v[64:67], v23, s[8:11], s36 offen offset:0 sc1
    buffer_load_dwordx4 v[68:71], v23, s[8:11], s36 offen offset:1024 sc1
    buffer_load_dwordx4 v[72:75], v24, s[8:11], s36 offen offset:2048 sc1
    s_waitcnt vmcnt(0) lgkmcnt(0)
    v_add_f32 v40, 1.0, v40
    v_add_f32 v41, 1.0, v41
    v_add_f32 v42, 1.0, v42
    v_add_f32 v43, 1.0, v43
    v_add_f32 v44, 1.0, v44
    v_add_f32 v45, 1.0, v45
    v_add_f32 v46, 1.0, v46
    v_add_f32 v47, 1.0, v47
    v_add_f32 v48, 1.0, v48
    v_add_f32 v49, 1.0, v49
    v_add_f32 v50, 1.0, v50
    v_add_f32 v51, 1.0, v51
    v_cvt_pk_bf16_f32 v23, v40, v41
    v_lshlrev_b32 v40, 16, v23
    v_and_b32 v41, s45, v23
    v_cvt_pk_bf16_f32 v23, v42, v43
    v_lshlrev_b32 v42, 16, v23
    v_and_b32 v43, s45, v23
    v_cvt_pk_bf16_f32 v23, v44, v45
    v_lshlrev_b32 v44, 16, v23
    v_and_b32 v45, s45, v23
    v_cvt_pk_bf16_f32 v23, v46, v47
    v_lshlrev_b32 v46, 16, v23
    v_and_b32 v47, s45, v23
    v_cvt_pk_bf16_f32 v23, v48, v49
    v_lshlrev_b32 v48, 16, v23
    v_and_b32 v49, s45, v23
    v_cvt_pk_bf16_f32 v23, v50, v51
    v_lshlrev_b32 v50, 16, v23
    v_and_b32 v51, s45, v23
    s_mov_b32 s29, s60
    s_mov_b32 s50, -1
    s_mov_b32 s51, -1
    s_mov_b32 s41, 1
CF_loop:
    s_cmp_ge_u32 s29, s61
    s_cbranch_scc1 CF_skipC
    s_mul_i32 s48, s29, 1152
    buffer_load_dwordx2 v[88:89], v4, s[16:19], s48 offen offset:0
    buffer_load_dwordx2 v[90:91], v4, s[16:19], s48 offen offset:512
    buffer_load_dwordx2 v[92:93], v5, s[16:19], s48 offen offset:1024
    s_lshr_b32 s49, s29, 5
    s_min_u32 s42, s49, 62
    s_mul_i32 s42, s42, 2048
    s_add_u32 s42, s42, 0x146000
    s_waitcnt vmcnt(0)
    v_lshlrev_b32 v76, 16, v88
    v_and_b32 v77, s45, v88
    v_lshlrev_b32 v78, 16, v89
    v_and_b32 v79, s45, v89
    v_lshlrev_b32 v80, 16, v90
    v_and_b32 v81, s45, v90
    v_lshlrev_b32 v82, 16, v91
    v_and_b32 v83, s45, v91
    v_lshlrev_b32 v84, 16, v92
    v_and_b32 v85, s45, v92
    v_lshlrev_b32 v86, 16, v93
    v_and_b32 v87, s45, v93
    v_lshlrev_b32 v11, 3, v1
    s_mov_b32 exec_lo, 0xffff
    s_mov_b32 exec_hi, 0x0
poll_44:
    buffer_load_dword v10, v11, s[8:11], s42 offen sc1
    s_waitcnt vmcnt(0)
    v_cmp_gt_u32 vcc, s41, v10
    s_cbranch_vccz pollok_45
    s_sleep 16
    s_sub_u32 s33, s33, 1
    s_cmp_gt_i32 s33, 0
    s_cbranch_scc1 poll_44
pollok_45:
    s_mov_b64 exec, -1
CF_againC:
    s_mul_i32 s30, s29, 16384
    s_add_u32 s30, s30, 0x4800000
    s_mul_i32 s43, s49, 65536
    s_and_b32 s36, s29, 31
    s_lshl_b32 s36, s36, 4
    s_add_u32 s43, s43, s36
    s_add_u32 s43, s43, 0x6800000
    buffer_load_dwordx4 a[0:3], v2, s[8:11], s30 offen offset:0 sc1
    buffer_load_dwordx4 a[4:7], v2, s[8:11], s30 offen offset:512 sc1
    buffer_load_dwordx4 a[8:11], v3, s[8:11], s43 offen sc1
    buffer_load_dwordx4 a[12:15], v2, s[8:11], s30 offen offset:2048 sc1
    buffer_load_dwordx4 a[16:19], v2, s[8:11], s30 offen offset:2560 sc1
    s_add_u32 s43, s43, 8192
    buffer_load_dwordx4 a[20:23], v3, s[8:11], s43 offen sc1
    s_add_u32 s30, s30, 4096
    buffer_load_dwordx4 a[24:27], v2, s[8:11], s30 offen offset:0 sc1
    buffer_load_dwordx4 a[28:31], v2, s[8:11], s30 offen offset:512 sc1
    s_add_u32 s43, s43, 8192
    buffer_load_dwordx4 a[32:35], v3, s[8:11], s43 offen sc1
    buffer_load_dwordx4 a[36:39], v2, s[8:11], s30 offen offset:2048 sc1
    buffer_load_dwordx4 a[40:43], v2, s[8:11], s30 offen offset:2560 sc1
    s_add_u32 s43, s43, 8192
    buffer_load_dwordx4 a[44:47], v3, s[8:11], s43 offen sc1
    s_add_u32 s30, s30, 4096
    buffer_load_dwordx4 a[48:51], v2, s[8:11], s30 offen offset:0 sc1
    buffer_load_dwordx4 a[52:55], v2, s[8:11], s30 offen offset:512 sc1
    s_add_u32 s43, s43, 8192
    buffer_load_dwordx4 a[56:59], v3, s[8:11], s43 offen sc1
    buffer_load_dwordx4 a[60:63], v2, s[8:11], s30 offen offset:2048 sc1
    buffer_load_dwordx4 a[64:67], v2, s[8:11], s30 offen offset:2560 sc1
    s_add_u32 s43, s43, 8192
    buffer_load_dwordx4 a[68:71], v3, s[8:11], s43 offen sc1
    s_add_u32 s30, s30, 4096
    buffer_load_dwordx4 a[72:75], v2, s[8:11], s30 offen offset:0 sc1
    buffer_load_dwordx4 a[76:79], v2, s[8:11], s30 offen offset:512 sc1
    s_add_u32 s43, s43, 8192
    buffer_load_dwordx4 a[80:83], v3, s[8:11], s43 offen sc1
    buffer_load_dwordx4 a[84:87], v2, s[8:11], s30 offen offset:2048 sc1
    buffer_load_dwordx4 a[88:91], v2, s[8:11], s30 offen offset:2560 sc1
    s_add_u32 s43, s43, 8192
    buffer_load_dwordx4 a[92:95], v3, s[8:11], s43 offen sc1
    s_waitcnt vmcnt(23)
    v_mfma_f32_16x16x32_bf16 v[96:99], v[12:15], a[0:3], 0
    s_waitcnt vmcnt(22)
    v_mfma_f32_16x16x32_bf16 v[100:103], v[12:15], a[4:7], 0
    s_waitcnt vmcnt(21)
    v_mfma_f32_16x16x32_bf16 v[104:107], v[12:15], a[8:11], 0
    s_waitcnt vmcnt(20)
    v_mfma_f32_16x16x32_bf16 v[96:99], v[12:15], a[12:15], v[96:99]
    s_waitcnt vmcnt(19)
    v_mfma_f32_16x16x32_bf16 v[100:103], v[12:15], a[16:19], v[100:103]
    s_waitcnt vmcnt(18)
    v_mfma_f32_16x16x32_bf16 v[104:107], v[12:15], a[20:23], v[104:107]
    s_waitcnt vmcnt(17)
    v_mfma_f32_16x16x32_bf16 v[96:99], v[12:15], a[24:27], v[96:99]
    s_waitcnt vmcnt(16)
    v_mfma_f32_16x16x32_bf16 v[100:103], v[12:15], a[28:31], v[100:103]
    s_waitcnt vmcnt(15)
    v_mfma_f32_16x16x32_bf16 v[104:107], v[12:15], a[32:35], v[104:107]
    s_waitcnt vmcnt(14)
    v_mfma_f32_16x16x32_bf16 v[96:99], v[12:15], a[36:39], v[96:99]
    s_waitcnt vmcnt(13)
    v_mfma_f32_16x16x32_bf16 v[100:103], v[12:15], a[40:43], v[100:103]
    s_waitcnt vmcnt(12)
    v_mfma_f32_16x16x32_bf16 v[104:107], v[12:15], a[44:47], v[104:107]
    s_waitcnt vmcnt(11)
    v_mfma_f32_16x16x32_bf16 v[96:99], v[12:15], a[48:51], v[96:99]
    s_waitcnt vmcnt(10)
    v_mfma_f32_16x16x32_bf16 v[100:103], v[12:15], a[52:55], v[100:103]
    s_waitcnt vmcnt(9)
    v_mfma_f32_16x16x32_bf16 v[104:107], v[12:15], a[56:59], v[104:107]
    s_waitcnt vmcnt(8)
    v_mfma_f32_16x16x32_bf16 v[96:99], v[12:15], a[60:63], v[96:99]
    s_waitcnt vmcnt(7)
    v_mfma_f32_16x16x32_bf16 v[100:103], v[12:15], a[64:67], v[100:103]
    s_waitcnt vmcnt(6)
    v_mfma_f32_16x16x32_bf16 v[104:107], v[12:15], a[68:71], v[104:107]
    s_waitcnt vmcnt(5)
    v_mfma_f32_16x16x32_bf16 v[96:99], v[12:15], a[72:75], v[96:99]
    s_waitcnt vmcnt(4)
    v_mfma_f32_16x16x32_bf16 v[100:103], v[12:15], a[76:79], v[100:103]
    s_waitcnt vmcnt(3)
    v_mfma_f32_16x16x32_bf16 v[104:107], v[12:15], a[80:83], v[104:107]
    s_waitcnt vmcnt(2)
    v_mfma_f32_16x16x32_bf16 v[96:99], v[12:15], a[84:87], v[96:99]
    s_waitcnt vmcnt(1)
    v_mfma_f32_16x16x32_bf16 v[100:103], v[12:15], a[88:91], v[100:103]
    s_waitcnt vmcnt(0)
    v_mfma_f32_16x16x32_bf16 v[104:107], v[12:15], a[92:95], v[104:107]
    s_nop 5
    v_cmp_u_f32 vcc, v96, v100
    s_nop 0
    v_cmp_u_f32 s[56:57], v104, v104
    s_nop 0
    s_or_b64 vcc, vcc, s[56:57]
    s_cbranch_scc0 CF_ok_46
    s_cmp_lt_u32 s29, 2016
    s_cbranch_scc1 CF_ok_46
    s_sub_u32 s33, s33, 64
    s_cmp_gt_i32 s33, 0
    s_cbranch_scc1 CF_againC
CF_ok_46:
    v_cvt_pk_bf16_f32 v108, v96, v97
    v_lshlrev_b32 v96, 16, v108
    v_and_b32 v97, s45, v108
    v_cvt_pk_bf16_f32 v108, v98, v99
    v_lshlrev_b32 v98, 16, v108
    v_and_b32 v99, s45, v108
    v_cvt_pk_bf16_f32 v108, v100, v101
    v_lshlrev_b32 v100, 16, v108
    v_and_b32 v101, s45, v108
    v_cvt_pk_bf16_f32 v108, v102, v103
    v_lshlrev_b32 v102, 16, v108
    v_and_b32 v103, s45, v108
    v_cvt_pk_bf16_f32 v108, v104, v105
    v_lshlrev_b32 v104, 16, v108
    v_and_b32 v105, s45, v108
    v_cvt_pk_bf16_f32 v108, v106, v107
    v_lshlrev_b32 v106, 16, v108
    v_and_b32 v107, s45, v108
    v_mul_f32 v96, v96, v28
    v_mul_f32 v97, v97, v29
    v_mul_f32 v98, v98, v30
    v_mul_f32 v99, v99, v31
    v_mul_f32 v100, v100, v32
    v_mul_f32 v101, v101, v33
    v_mul_f32 v102, v102, v34
    v_mul_f32 v103, v103, v35
    v_mul_f32 v104, v104, v36
    v_mul_f32 v105, v105, v37
    v_mul_f32 v106, v106, v38
    v_mul_f32 v107, v107, v39
    v_cvt_pk_bf16_f32 v108, v96, v97
    v_lshlrev_b32 v96, 16, v108
    v_and_b32 v97, s45, v108
    v_cvt_pk_bf16_f32 v108, v98, v99
    v_lshlrev_b32 v98, 16, v108
    v_and_b32 v99, s45, v108
    v_cvt_pk_bf16_f32 v108, v100, v101
    v_lshlrev_b32 v100, 16, v108
    v_and_b32 v101, s45, v108
    v_cvt_pk_bf16_f32 v108, v102, v103
    v_lshlrev_b32 v102, 16, v108
    v_and_b32 v103, s45, v108
    v_cvt_pk_bf16_f32 v108, v104, v105
    v_lshlrev_b32 v104, 16, v108
    v_and_b32 v105, s45, v108
    v_cvt_pk_bf16_f32 v108, v106, v107
    v_lshlrev_b32 v106, 16, v108
    v_and_b32 v107, s45, v108
    v_add_f32 v76, v76, v96
    v_add_f32 v77, v77, v97
    v_add_f32 v78, v78, v98
    v_add_f32 v79, v79, v99
    v_add_f32 v80, v80, v100
    v_add_f32 v81, v81, v101
    v_add_f32 v82, v82, v102
    v_add_f32 v83, v83, v103
    v_add_f32 v84, v84, v104
    v_add_f32 v85, v85, v105
    v_add_f32 v86, v86, v106
    v_add_f32 v87, v87, v107
    v_cvt_pk_bf16_f32 v88, v76, v77
    v_lshlrev_b32 v76, 16, v88
    v_and_b32 v77, s45, v88
    v_cvt_pk_bf16_f32 v89, v78, v79
    v_lshlrev_b32 v78, 16, v89
    v_and_b32 v79, s45, v89
    v_cvt_pk_bf16_f32 v90, v80, v81
    v_lshlrev_b32 v80, 16, v90
    v_and_b32 v81, s45, v90
    v_cvt_pk_bf16_f32 v91, v82, v83
    v_lshlrev_b32 v82, 16, v91
    v_and_b32 v83, s45, v91
    v_cvt_pk_bf16_f32 v92, v84, v85
    v_lshlrev_b32 v84, 16, v92
    v_and_b32 v85, s45, v92
    v_cvt_pk_bf16_f32 v93, v86, v87
    v_lshlrev_b32 v86, 16, v93
    v_and_b32 v87, s45, v93
    v_add_f32 v108, v76, v77
    v_add_f32 v108, v108, v78
    v_add_f32 v108, v108, v79
    v_add_f32 v108, v108, v80
    v_add_f32 v108, v108, v81
    v_add_f32 v108, v108, v82
    v_add_f32 v108, v108, v83
    v_add_f32 v108, v108, v84
    v_add_f32 v108, v108, v85
    v_add_f32 v108, v108, v86
    v_add_f32 v108, v108, v87
    s_nop 1
    v_add_f32_dpp v108, v108, v108 row_ror:8 row_mask:0xf bank_mask:0xf
    s_nop 1
    v_add_f32_dpp v108, v108, v108 row_ror:4 row_mask:0xf bank_mask:0xf
    s_nop 1
    v_add_f32_dpp v108, v108, v108 row_ror:2 row_mask:0xf bank_mask:0xf
    s_nop 1
    v_add_f32_dpp v108, v108, v108 row_ror:1 row_mask:0xf bank_mask:0xf
    v_mov_b32 v10, v108
    s_nop 1
    v_permlane16_swap_b32 v108, v10
    v_add_f32 v108, v108, v10
    v_mov_b32 v10, v108
    s_nop 1
    v_permlane32_swap_b32 v108, v10
    v_add_f32 v108, v108, v10
    v_mul_f32 v109, 0x3ae38e39, v108
    v_sub_f32 v112, v76, v109
    v_sub_f32 v113, v77, v109
    v_sub_f32 v114, v78, v109
    v_sub_f32 v115, v79, v109
    v_sub_f32 v116, v80, v109
    v_sub_f32 v117, v81, v109
    v_sub_f32 v118, v82, v109
    v_sub_f32 v119, v83, v109
    v_sub_f32 v120, v84, v109
    v_sub_f32 v121, v85, v109
    v_sub_f32 v122, v86, v109
    v_sub_f32 v123, v87, v109
    v_mul_f32 v108, v120, v120
    v_fmac_f32 v108, v121, v121
    v_fmac_f32 v108, v122, v122
    v_fmac_f32 v108, v123, v123
    v_cndmask_b32 v108, 0, v108, s[46:47]
    v_fmac_f32 v108, v112, v112
    v_fmac_f32 v108, v113, v113
    v_fmac_f32 v108, v114, v114
    v_fmac_f32 v108, v115, v115
    v_fmac_f32 v108, v116, v116
    v_fmac_f32 v108, v117, v117
    v_fmac_f32 v108, v118, v118
    v_fmac_f32 v108, v119, v119
    s_nop 1
    v_add_f32_dpp v108, v108, v108 row_ror:8 row_mask:0xf bank_mask:0xf
    s_nop 1
    v_add_f32_dpp v108, v108, v108 row_ror:4 row_mask:0xf bank_mask:0xf
    s_nop 1
    v_add_f32_dpp v108, v108, v108 row_ror:2 row_mask:0xf bank_mask:0xf
    s_nop 1
    v_add_f32_dpp v108, v108, v108 row_ror:1 row_mask:0xf bank_mask:0xf
    v_mov_b32 v10, v108
    s_nop 1
    v_permlane16_swap_b32 v108, v10
    v_add_f32 v108, v108, v10
    v_mov_b32 v10, v108
    s_nop 1
    v_permlane32_swap_b32 v108, v10
    v_add_f32 v108, v108, v10
    v_cvt_pk_bf16_f32 v109, v109, v109
    v_lshlrev_b32 v109, 16, v109
    v_sub_f32 v112, v76, v109
    v_sub_f32 v113, v77, v109
    v_sub_f32 v114, v78, v109
    v_sub_f32 v115, v79, v109
    v_sub_f32 v116, v80, v109
    v_sub_f32 v117, v81, v109
    v_sub_f32 v118, v82, v109
    v_sub_f32 v119, v83, v109
    v_sub_f32 v120, v84, v109
    v_sub_f32 v121, v85, v109
    v_sub_f32 v122, v86, v109
    v_sub_f32 v123, v87, v109
    v_mul_f32 v108, 0x3ae38e39, v108
    v_cvt_pk_bf16_f32 v108, v108, v108
    v_lshlrev_b32 v108, 16, v108
    v_add_f32 v108, 0x3727c5ac, v108
    v_cvt_pk_bf16_f32 v108, v108, v108
    v_lshlrev_b32 v108, 16, v108
    v_sqrt_f32 v108, v108
    s_nop 0
    v_cvt_pk_bf16_f32 v108, v108, v108
    v_lshlrev_b32 v108, 16, v108
    v_rcp_f32 v108, v108
    v_cvt_pk_bf16_f32 v110, v112, v113
    v_lshlrev_b32 v112, 16, v110
    v_and_b32 v113, s45, v110
    v_cvt_pk_bf16_f32 v110, v114, v115
    v_lshlrev_b32 v114, 16, v110
    v_and_b32 v115, s45, v110
    v_cvt_pk_bf16_f32 v110, v116, v117
    v_lshlrev_b32 v116, 16, v110
    v_and_b32 v117, s45, v110
    v_cvt_pk_bf16_f32 v110, v118, v119
    v_lshlrev_b32 v118, 16, v110
    v_and_b32 v119, s45, v110
    v_cvt_pk_bf16_f32 v110, v120, v121
    v_lshlrev_b32 v120, 16, v110
    v_and_b32 v121, s45, v110
    v_cvt_pk_bf16_f32 v110, v122, v123
    v_lshlrev_b32 v122, 16, v110
    v_and_b32 v123, s45, v110
    v_mul_f32 v112, v112, v108
    v_mul_f32 v113, v113, v108
    v_mul_f32 v114, v114, v108
    v_mul_f32 v115, v115, v108
    v_mul_f32 v116, v116, v108
    v_mul_f32 v117, v117, v108
    v_mul_f32 v118, v118, v108
    v_mul_f32 v119, v119, v108
    v_mul_f32 v120, v120, v108
    v_mul_f32 v121, v121, v108
    v_mul_f32 v122, v122, v108
    v_mul_f32 v123, v123, v108
    v_cvt_pk_bf16_f32 v110, v112, v113
    v_lshlrev_b32 v112, 16, v110
    v_and_b32 v113, s45, v110
    v_cvt_pk_bf16_f32 v110, v114, v115
    v_lshlrev_b32 v114, 16, v110
    v_and_b32 v115, s45, v110
    v_cvt_pk_bf16_f32 v110, v116, v117
    v_lshlrev_b32 v116, 16, v110
    v_and_b32 v117, s45, v110
    v_cvt_pk_bf16_f32 v110, v118, v119
    v_lshlrev_b32 v118, 16, v110
    v_and_b32 v119, s45, v110
    v_cvt_pk_bf16_f32 v110, v120, v121
    v_lshlrev_b32 v120, 16, v110
    v_and_b32 v121, s45, v110
    v_cvt_pk_bf16_f32 v110, v122, v123
    v_lshlrev_b32 v122, 16, v110
    v_and_b32 v123, s45, v110
    v_mul_f32 v112, v112, v40
    v_mul_f32 v113, v113, v41
    v_mul_f32 v114, v114, v42
    v_mul_f32 v115, v115, v43
    v_mul_f32 v116, v116, v44
    v_mul_f32 v117, v117, v45
    v_mul_f32 v118, v118, v46
    v_mul_f32 v119, v119, v47
    v_mul_f32 v120, v120, v48
    v_mul_f32 v121, v121, v49
    v_mul_f32 v122, v122, v50
    v_mul_f32 v123, v123, v51
    v_cvt_pk_bf16_f32 v110, v112, v113
    v_lshlrev_b32 v112, 16, v110
    v_and_b32 v113, s45, v110
    v_cvt_pk_bf16_f32 v110, v114, v115
    v_lshlrev_b32 v114, 16, v110
    v_and_b32 v115, s45, v110
    v_cvt_pk_bf16_f32 v110, v116, v117
    v_lshlrev_b32 v116, 16, v110
    v_and_b32 v117, s45, v110
    v_cvt_pk_bf16_f32 v110, v118, v119
    v_lshlrev_b32 v118, 16, v110
    v_and_b32 v119, s45, v110
    v_cvt_pk_bf16_f32 v110, v120, v121
    v_lshlrev_b32 v120, 16, v110
    v_and_b32 v121, s45, v110
    v_cvt_pk_bf16_f32 v110, v122, v123
    v_lshlrev_b32 v122, 16, v110
    v_and_b32 v123, s45, v110
    v_add_f32 v112, v112, v52
    v_add_f32 v113, v113, v53
    v_add_f32 v114, v114, v54
    v_add_f32 v115, v115, v55
    v_add_f32 v116, v116, v56
    v_add_f32 v117, v117, v57
    v_add_f32 v118, v118, v58
    v_add_f32 v119, v119, v59
    v_add_f32 v120, v120, v60
    v_add_f32 v121, v121, v61
    v_add_f32 v122, v122, v62
    v_add_f32 v123, v123, v63
    v_cvt_pk_bf16_f32 v96, v112, v113
    v_cvt_pk_bf16_f32 v97, v114, v115
    v_cvt_pk_bf16_f32 v98, v116, v117
    v_cvt_pk_bf16_f32 v99, v118, v119
    v_cvt_pk_bf16_f32 v100, v120, v121
    v_cvt_pk_bf16_f32 v101, v122, v123
    s_add_u32 s36, s48, 0x500000
    v_mov_b64 v[102:103], v[100:101]
    v_permlane16_swap_b32 v96, v98
    v_permlane16_swap_b32 v97, v99
    v_permlane16_swap_b32 v100, v102
    v_permlane16_swap_b32 v101, v103
    buffer_store_dwordx4 v[96:99], v124, s[8:11], s36 offen sc1
    buffer_store_dwordx4 v[100:103], v125, s[8:11], s36 offen offset:1024 sc1
    s_lshl_b32 s32, s29, 7
    s_add_u32 s32, s32, 0x166000
    v_mov_b32 v10, 1
    s_waitcnt vmcnt(0)
    s_mov_b64 exec, 1
    buffer_store_dword v10, off, s[8:11], s32 sc1
    s_mov_b64 exec, -1
CF_skipC:
    s_cmp_ge_u32 s50, s61
    s_cbranch_scc1 CF_skipF
    s_lshr_b32 s49, s50, 5
    s_min_u32 s42, s49, 62
    s_mul_i32 s42, s42, 4608
    s_add_u32 s42, s42, 0x1a6000
    v_lshlrev_b32 v76, 16, v16
    v_and_b32 v77, s45, v16
    v_lshlrev_b32 v78, 16, v17
    v_and_b32 v79, s45, v17
    v_lshlrev_b32 v80, 16, v18
    v_and_b32 v81, s45, v18
    v_lshlrev_b32 v82, 16, v19
    v_and_b32 v83, s45, v19
    v_lshlrev_b32 v84, 16, v20
    v_and_b32 v85, s45, v20
    v_lshlrev_b32 v86, 16, v21
    v_and_b32 v87, s45, v21
    v_lshlrev_b32 v11, 3, v1
    s_mov_b32 exec_lo, 0xffffffff
    s_mov_b32 exec_hi, 0xf
poll_47:
    buffer_load_dword v10, v11, s[8:11], s42 offen sc1
    s_waitcnt vmcnt(0)
    v_cmp_gt_u32 vcc, s41, v10
    s_cbranch_vccz pollok_48
    s_sleep 16
    s_sub_u32 s33, s33, 1
    s_cmp_gt_i32 s33, 0
    s_cbranch_scc1 poll_47
pollok_48:
    s_mov_b64 exec, -1
CF_againF:
    s_mul_i32 s30, s50, 36864
    s_add_u32 s30, s30, 0x7000000
    s_mul_i32 s43, s49, 147456
    s_and_b32 s36, s50, 31
    s_lshl_b32 s36, s36, 4
    s_add_u32 s43, s43, s36
    s_add_u32 s43, s43, 0xb800000
    buffer_load_dwordx4 a[0:3], v2, s[8:11], s30 offen offset:0 sc1
    buffer_load_dwordx4 a[4:7], v2, s[8:11], s30 offen offset:512 sc1
    buffer_load_dwordx4 a[8:11], v3, s[8:11], s43 offen sc1
    buffer_load_dwordx4 a[12:15], v2, s[8:11], s30 offen offset:2048 sc1
    buffer_load_dwordx4 a[16:19], v2, s[8:11], s30 offen offset:2560 sc1
    s_add_u32 s43, s43, 8192
    buffer_load_dwordx4 a[20:23], v3, s[8:11], s43 offen sc1
    s_add_u32 s30, s30, 4096
    buffer_load_dwordx4 a[24:27], v2, s[8:11], s30 offen offset:0 sc1
    buffer_load_dwordx4 a[28:31], v2, s[8:11], s30 offen offset:512 sc1
    s_add_u32 s43, s43, 8192
    buffer_load_dwordx4 a[32:35], v3, s[8:11], s43 offen sc1
    buffer_load_dwordx4 a[36:39], v2, s[8:11], s30 offen offset:2048 sc1
    buffer_load_dwordx4 a[40:43], v2, s[8:11], s30 offen offset:2560 sc1
    s_add_u32 s43, s43, 8192
    buffer_load_dwordx4 a[44:47], v3, s[8:11], s43 offen sc1
    s_add_u32 s30, s30, 4096
    buffer_load_dwordx4 a[48:51], v2, s[8:11], s30 offen offset:0 sc1
    buffer_load_dwordx4 a[52:55], v2, s[8:11], s30 offen offset:512 sc1
    s_add_u32 s43, s43, 8192
    buffer_load_dwordx4 a[56:59], v3, s[8:11], s43 offen sc1
    buffer_load_dwordx4 a[60:63], v2, s[8:11], s30 offen offset:2048 sc1
    buffer_load_dwordx4 a[64:67], v2, s[8:11], s30 offen offset:2560 sc1
    s_add_u32 s43, s43, 8192
    buffer_load_dwordx4 a[68:71], v3, s[8:11], s43 offen sc1
    s_add_u32 s30, s30, 4096
    buffer_load_dwordx4 a[72:75], v2, s[8:11], s30 offen offset:0 sc1
    buffer_load_dwordx4 a[76:79], v2, s[8:11], s30 offen offset:512 sc1
    s_add_u32 s43, s43, 8192
    buffer_load_dwordx4 a[80:83], v3, s[8:11], s43 offen sc1
    buffer_load_dwordx4 a[84:87], v2, s[8:11], s30 offen offset:2048 sc1
    buffer_load_dwordx4 a[88:91], v2, s[8:11], s30 offen offset:2560 sc1
    s_add_u32 s43, s43, 8192
    buffer_load_dwordx4 a[92:95], v3, s[8:11], s43 offen sc1
    s_add_u32 s30, s30, 4096
    buffer_load_dwordx4 a[96:99], v2, s[8:11], s30 offen offset:0 sc1
    buffer_load_dwordx4 a[100:103], v2, s[8:11], s30 offen offset:512 sc1
    s_add_u32 s43, s43, 8192
    buffer_load_dwordx4 a[104:107], v3, s[8:11], s43 offen sc1
    buffer_load_dwordx4 a[108:111], v2, s[8:11], s30 offen offset:2048 sc1
    buffer_load_dwordx4 a[112:115], v2, s[8:11], s30 offen offset:2560 sc1
    s_add_u32 s43, s43, 8192
    buffer_load_dwordx4 a[116:119], v3, s[8:11], s43 offen sc1
    s_add_u32 s30, s30, 4096
    buffer_load_dwordx4 a[120:123], v2, s[8:11], s30 offen offset:0 sc1
    buffer_load_dwordx4 a[124:127], v2, s[8:11], s30 offen offset:512 sc1
    s_add_u32 s43, s43, 8192
    buffer_load_dwordx4 a[128:131], v3, s[8:11], s43 offen sc1
    buffer_load_dwordx4 a[132:135], v2, s[8:11], s30 offen offset:2048 sc1
    buffer_load_dwordx4 a[136:139], v2, s[8:11], s30 offen offset:2560 sc1
    s_add_u32 s43, s43, 8192
    buffer_load_dwordx4 a[140:143], v3, s[8:11], s43 offen sc1
    s_add_u32 s30, s30, 4096
    buffer_load_dwordx4 a[144:147], v2, s[8:11], s30 offen offset:0 sc1
    buffer_load_dwordx4 a[148:151], v2, s[8:11], s30 offen offset:512 sc1
    s_add_u32 s43, s43, 8192
    buffer_load_dwordx4 a[152:155], v3, s[8:11], s43 offen sc1
    buffer_load_dwordx4 a[156:159], v2, s[8:11], s30 offen offset:2048 sc1
    buffer_load_dwordx4 a[160:163], v2, s[8:11], s30 offen offset:2560 sc1
    s_add_u32 s43, s43, 8192
    buffer_load_dwordx4 a[164:167], v3, s[8:11], s43 offen sc1
    s_add_u32 s30, s30, 4096
    buffer_load_dwordx4 a[168:171], v2, s[8:11], s30 offen offset:0 sc1
    buffer_load_dwordx4 a[172:175], v2, s[8:11], s30 offen offset:512 sc1
    s_add_u32 s43, s43, 8192
    buffer_load_dwordx4 a[176:179], v3, s[8:11], s43 offen sc1
    buffer_load_dwordx4 a[180:183], v2, s[8:11], s30 offen offset:2048 sc1
    buffer_load_dwordx4 a[184:187], v2, s[8:11], s30 offen offset:2560 sc1
    s_add_u32 s43, s43, 8192
    buffer_load_dwordx4 a[188:191], v3, s[8:11], s43 offen sc1
    s_add_u32 s30, s30, 4096
    buffer_load_dwordx4 a[192:195], v2, s[8:11], s30 offen offset:0 sc1
    buffer_load_dwordx4 a[196:199], v2, s[8:11], s30 offen offset:512 sc1
    s_add_u32 s43, s43, 8192
    buffer_load_dwordx4 a[200:203], v3, s[8:11], s43 offen sc1
    buffer_load_dwordx4 a[204:207], v2, s[8:11], s30 offen offset:2048 sc1
    buffer_load_dwordx4 a[208:211], v2, s[8:11], s30 offen offset:2560 sc1
    s_add_u32 s43, s43, 8192
    buffer_load_dwordx4 a[212:215], v3, s[8:11], s43 offen sc1
    s_waitcnt vmcnt(53)
    v_mfma_f32_16x16x32_bf16 v[96:99], v[12:15], a[0:3], 0
    s_waitcnt vmcnt(52)
    v_mfma_f32_16x16x32_bf16 v[100:103], v[12:15], a[4:7], 0
    s_waitcnt vmcnt(51)
    v_mfma_f32_16x16x32_bf16 v[104:107], v[12:15], a[8:11], 0
    s_waitcnt vmcnt(50)
    v_mfma_f32_16x16x32_bf16 v[96:99], v[12:15], a[12:15], v[96:99]
    s_waitcnt vmcnt(49)
    v_mfma_f32_16x16x32_bf16 v[100:103], v[12:15], a[16:19], v[100:103]
    s_waitcnt vmcnt(48)
    v_mfma_f32_16x16x32_bf16 v[104:107], v[12:15], a[20:23], v[104:107]
    s_waitcnt vmcnt(47)
    v_mfma_f32_16x16x32_bf16 v[96:99], v[12:15], a[24:27], v[96:99]
    s_waitcnt vmcnt(46)
    v_mfma_f32_16x16x32_bf16 v[100:103], v[12:15], a[28:31], v[100:103]
    s_waitcnt vmcnt(45)
    v_mfma_f32_16x16x32_bf16 v[104:107], v[12:15], a[32:35], v[104:107]
    s_waitcnt vmcnt(44)
    v_mfma_f32_16x16x32_bf16 v[96:99], v[12:15], a[36:39], v[96:99]
    s_waitcnt vmcnt(43)
    v_mfma_f32_16x16x32_bf16 v[100:103], v[12:15], a[40:43], v[100:103]
    s_waitcnt vmcnt(42)
    v_mfma_f32_16x16x32_bf16 v[104:107], v[12:15], a[44:47], v[104:107]
    s_waitcnt vmcnt(41)
    v_mfma_f32_16x16x32_bf16 v[96:99], v[12:15], a[48:51], v[96:99]
    s_waitcnt vmcnt(40)
    v_mfma_f32_16x16x32_bf16 v[100:103], v[12:15], a[52:55], v[100:103]
    s_waitcnt vmcnt(39)
    v_mfma_f32_16x16x32_bf16 v[104:107], v[12:15], a[56:59], v[104:107]
    s_waitcnt vmcnt(38)
    v_mfma_f32_16x16x32_bf16 v[96:99], v[12:15], a[60:63], v[96:99]
    s_waitcnt vmcnt(37)
    v_mfma_f32_16x16x32_bf16 v[100:103], v[12:15], a[64:67], v[100:103]
    s_waitcnt vmcnt(36)
    v_mfma_f32_16x16x32_bf16 v[104:107], v[12:15], a[68:71], v[104:107]
    s_waitcnt vmcnt(35)
    v_mfma_f32_16x16x32_bf16 v[96:99], v[12:15], a[72:75], v[96:99]
    s_waitcnt vmcnt(34)
    v_mfma_f32_16x16x32_bf16 v[100:103], v[12:15], a[76:79], v[100:103]
    s_waitcnt vmcnt(33)
    v_mfma_f32_16x16x32_bf16 v[104:107], v[12:15], a[80:83], v[104:107]
    s_waitcnt vmcnt(32)
    v_mfma_f32_16x16x32_bf16 v[96:99], v[12:15], a[84:87], v[96:99]
    s_waitcnt vmcnt(31)
    v_mfma_f32_16x16x32_bf16 v[100:103], v[12:15], a[88:91], v[100:103]
    s_waitcnt vmcnt(30)
    v_mfma_f32_16x16x32_bf16 v[104:107], v[12:15], a[92:95], v[104:107]
    s_waitcnt vmcnt(29)
    v_mfma_f32_16x16x32_bf16 v[96:99], v[12:15], a[96:99], v[96:99]
    s_waitcnt vmcnt(28)
    v_mfma_f32_16x16x32_bf16 v[100:103], v[12:15], a[100:103], v[100:103]
    s_waitcnt vmcnt(27)
    v_mfma_f32_16x16x32_bf16 v[104:107], v[12:15], a[104:107], v[104:107]
    s_waitcnt vmcnt(26)
    v_mfma_f32_16x16x32_bf16 v[96:99], v[12:15], a[108:111], v[96:99]
    s_waitcnt vmcnt(25)
    v_mfma_f32_16x16x32_bf16 v[100:103], v[12:15], a[112:115], v[100:103]
    s_waitcnt vmcnt(24)
    v_mfma_f32_16x16x32_bf16 v[104:107], v[12:15], a[116:119], v[104:107]
    s_waitcnt vmcnt(23)
    v_mfma_f32_16x16x32_bf16 v[96:99], v[12:15], a[120:123], v[96:99]
    s_waitcnt vmcnt(22)
    v_mfma_f32_16x16x32_bf16 v[100:103], v[12:15], a[124:127], v[100:103]
    s_waitcnt vmcnt(21)
    v_mfma_f32_16x16x32_bf16 v[104:107], v[12:15], a[128:131], v[104:107]
    s_waitcnt vmcnt(20)
    v_mfma_f32_16x16x32_bf16 v[96:99], v[12:15], a[132:135], v[96:99]
    s_waitcnt vmcnt(19)
    v_mfma_f32_16x16x32_bf16 v[100:103], v[12:15], a[136:139], v[100:103]
    s_waitcnt vmcnt(18)
    v_mfma_f32_16x16x32_bf16 v[104:107], v[12:15], a[140:143], v[104:107]
    s_waitcnt vmcnt(17)
    v_mfma_f32_16x16x32_bf16 v[96:99], v[12:15], a[144:147], v[96:99]
    s_waitcnt vmcnt(16)
    v_mfma_f32_16x16x32_bf16 v[100:103], v[12:15], a[148:151], v[100:103]
    s_waitcnt vmcnt(15)
    v_mfma_f32_16x16x32_bf16 v[104:107], v[12:15], a[152:155], v[104:107]
    s_waitcnt vmcnt(14)
    v_mfma_f32_16x16x32_bf16 v[96:99], v[12:15], a[156:159], v[96:99]
    s_waitcnt vmcnt(13)
    v_mfma_f32_16x16x32_bf16 v[100:103], v[12:15], a[160:163], v[100:103]
    s_waitcnt vmcnt(12)
    v_mfma_f32_16x16x32_bf16 v[104:107], v[12:15], a[164:167], v[104:107]
    s_waitcnt vmcnt(11)
    v_mfma_f32_16x16x32_bf16 v[96:99], v[12:15], a[168:171], v[96:99]
    s_waitcnt vmcnt(10)
    v_mfma_f32_16x16x32_bf16 v[100:103], v[12:15], a[172:175], v[100:103]
    s_waitcnt vmcnt(9)
    v_mfma_f32_16x16x32_bf16 v[104:107], v[12:15], a[176:179], v[104:107]
    s_waitcnt vmcnt(8)
    v_mfma_f32_16x16x32_bf16 v[96:99], v[12:15], a[180:183], v[96:99]
    s_waitcnt vmcnt(7)
    v_mfma_f32_16x16x32_bf16 v[100:103], v[12:15], a[184:187], v[100:103]
    s_waitcnt vmcnt(6)
    v_mfma_f32_16x16x32_bf16 v[104:107], v[12:15], a[188:191], v[104:107]
    s_waitcnt vmcnt(5)
    v_mfma_f32_16x16x32_bf16 v[96:99], v[12:15], a[192:195], v[96:99]
    s_waitcnt vmcnt(4)
    v_mfma_f32_16x16x32_bf16 v[100:103], v[12:15], a[196:199], v[100:103]
    s_waitcnt vmcnt(3)
    v_mfma_f32_16x16x32_bf16 v[104:107], v[12:15], a[200:203], v[104:107]
    s_waitcnt vmcnt(2)
    v_mfma_f32_16x16x32_bf16 v[96:99], v[12:15], a[204:207], v[96:99]
    s_waitcnt vmcnt(1)
    v_mfma_f32_16x16x32_bf16 v[100:103], v[12:15], a[208:211], v[100:103]
    s_waitcnt vmcnt(0)
    v_mfma_f32_16x16x32_bf16 v[104:107], v[12:15], a[212:215], v[104:107]
    s_nop 5
    v_cmp_u_f32 vcc, v96, v100
    s_nop 0
    v_cmp_u_f32 s[56:57], v104, v104
    s_nop 0
    s_or_b64 vcc, vcc, s[56:57]
    s_cbranch_scc0 CF_ok_49
    s_cmp_lt_u32 s50, 2016
    s_cbranch_scc1 CF_ok_49
    s_sub_u32 s33, s33, 64
    s_cmp_gt_i32 s33, 0
    s_cbranch_scc1 CF_againF
CF_ok_49:
    v_cvt_pk_bf16_f32 v108, v96, v97
    v_lshlrev_b32 v96, 16, v108
    v_and_b32 v97, s45, v108
    v_cvt_pk_bf16_f32 v108, v98, v99
    v_lshlrev_b32 v98, 16, v108
    v_and_b32 v99, s45, v108
    v_cvt_pk_bf16_f32 v108, v100, v101
    v_lshlrev_b32 v100, 16, v108
    v_and_b32 v101, s45, v108
    v_cvt_pk_bf16_f32 v108, v102, v103
    v_lshlrev_b32 v102, 16, v108
    v_and_b32 v103, s45, v108
    v_cvt_pk_bf16_f32 v108, v104, v105
    v_lshlrev_b32 v104, 16, v108
    v_and_b32 v105, s45, v108
    v_cvt_pk_bf16_f32 v108, v106, v107
    v_lshlrev_b32 v106, 16, v108
    v_and_b32 v107, s45, v108
    v_mul_f32 v96, v96, v64
    v_mul_f32 v97, v97, v65
    v_mul_f32 v98, v98, v66
    v_mul_f32 v99, v99, v67
    v_mul_f32 v100, v100, v68
    v_mul_f32 v101, v101, v69
    v_mul_f32 v102, v102, v70
    v_mul_f32 v103, v103, v71
    v_mul_f32 v104, v104, v72
    v_mul_f32 v105, v105, v73
    v_mul_f32 v106, v106, v74
    v_mul_f32 v107, v107, v75
    v_cvt_pk_bf16_f32 v108, v96, v97
    v_lshlrev_b32 v96, 16, v108
    v_and_b32 v97, s45, v108
    v_cvt_pk_bf16_f32 v108, v98, v99
    v_lshlrev_b32 v98, 16, v108
    v_and_b32 v99, s45, v108
    v_cvt_pk_bf16_f32 v108, v100, v101
    v_lshlrev_b32 v100, 16, v108
    v_and_b32 v101, s45, v108
    v_cvt_pk_bf16_f32 v108, v102, v103
    v_lshlrev_b32 v102, 16, v108
    v_and_b32 v103, s45, v108
    v_cvt_pk_bf16_f32 v108, v104, v105
    v_lshlrev_b32 v104, 16, v108
    v_and_b32 v105, s45, v108
    v_cvt_pk_bf16_f32 v108, v106, v107
    v_lshlrev_b32 v106, 16, v108
    v_and_b32 v107, s45, v108
    v_add_f32 v76, v76, v96
    v_add_f32 v77, v77, v97
    v_add_f32 v78, v78, v98
    v_add_f32 v79, v79, v99
    v_add_f32 v80, v80, v100
    v_add_f32 v81, v81, v101
    v_add_f32 v82, v82, v102
    v_add_f32 v83, v83, v103
    v_add_f32 v84, v84, v104
    v_add_f32 v85, v85, v105
    v_add_f32 v86, v86, v106
    v_add_f32 v87, v87, v107
    v_cvt_pk_bf16_f32 v16, v76, v77
    v_lshlrev_b32 v76, 16, v16
    v_and_b32 v77, s45, v16
    v_cvt_pk_bf16_f32 v17, v78, v79
    v_lshlrev_b32 v78, 16, v17
    v_and_b32 v79, s45, v17
    v_cvt_pk_bf16_f32 v18, v80, v81
    v_lshlrev_b32 v80, 16, v18
    v_and_b32 v81, s45, v18
    v_cvt_pk_bf16_f32 v19, v82, v83
    v_lshlrev_b32 v82, 16, v19
    v_and_b32 v83, s45, v19
    v_cvt_pk_bf16_f32 v20, v84, v85
    v_lshlrev_b32 v84, 16, v20
    v_and_b32 v85, s45, v20
    v_cvt_pk_bf16_f32 v21, v86, v87
    v_lshlrev_b32 v86, 16, v21
    v_and_b32 v87, s45, v21
    s_mul_i32 s48, s50, 1152
    v_mov_b64 v[22:23], v[20:21]
    v_permlane16_swap_b32 v16, v18
    v_permlane16_swap_b32 v17, v19
    v_permlane16_swap_b32 v20, v22
    v_permlane16_swap_b32 v21, v23
    buffer_store_dwordx4 v[16:19], v124, s[20:23], s48 offen
    buffer_store_dwordx4 v[20:23], v125, s[20:23], s48 offen offset:1024
CF_skipF:
    s_nop 0
    v_mov_b64 v[16:17], v[248:249]
    v_mov_b64 v[248:249], v[88:89]
    v_mov_b64 v[18:19], v[250:251]
    v_mov_b64 v[250:251], v[90:91]
    v_mov_b64 v[20:21], v[252:253]
    v_mov_b64 v[252:253], v[92:93]
    s_mov_b32 s50, s51
    s_mov_b32 s51, s29
    s_add_u32 s29, s29, s62
    s_min_u32 s36, s50, s51
    s_cmp_lt_u32 s36, s61
    s_cbranch_scc1 CF_loop
    s_waitcnt vmcnt(0)
    s_endpgm
DE_entry:
    v_and_b32 v20, 63, v0
    v_and_b32 v21, 15, v20
    v_lshrrev_b32 v22, 4, v20
    v_lshlrev_b32 v1, 4, v20
    s_mov_b32 s34, 0x05040100
    s_mov_b32 s35, 0x07060302
    s_mov_b32 s45, 0xffff0000
    s_mov_b32 s33, 400000
    v_lshrrev_b32 v23, 3, v20
    s_lshl_b32 s36, s4, 3
    v_add_u32 v23, s36, v23
    v_bfe_u32 v24, v23, 1, 3
    v_and_b32 v25, 7, v20
    v_xor_b32 v24, v24, v25
    v_mul_u32_u24 v23, 1152, v23
    v_lshl_add_u32 v2, v24, 4, v23
    v_lshrrev_b32 v23, 3, v21
    v_lshlrev_b32 v23, 10, v23
    v_and_b32 v24, 7, v21
    v_lshl_add_u32 v23, v24, 7, v23
    v_bfe_u32 v24, v21, 1, 3
    v_xor_b32 v24, v24, v22
    v_lshl_add_u32 v3, v24, 4, v23
    v_xor_b32 v4, 64, v3
    s_cmp_ge_u32 s28, 36
    s_cselect_b32 s49, 1, 0
    s_mul_i32 s36, s49, 36
    s_sub_u32 s48, s28, s36
    s_load_dwordx2 s[16:17], s[0:1], 80
    s_mov_b32 s18, 0x510000
    s_mov_b32 s19, 0x20000
    s_load_dwordx2 s[20:21], s[0:1], 64
    s_mov_b32 s22, 0x510000
    s_mov_b32 s23, 0x20000
    s_load_dwordx2 s[24:25], s[0:1], 72
    s_mov_b32 s26, 0x510000
    s_mov_b32 s27, 0x20000
    s_lshl_b32 s38, s48, 7
    v_lshlrev_b32 v23, 3, v22
    v_add_u32 v23, s38, v23
    s_mov_b32 s37, 1152
    v_mul_lo_u32 v23, v23, s37
    s_lshl_b32 s36, s4, 8
    v_lshl_add_u32 v24, v21, 4, v23
    v_add_u32 v8, s36, v24
    s_lshl_b32 s36, s4, 5
    s_add_u32 s36, s36, 1024
    v_lshl_add_u32 v24, v21, 1, v23
    v_add_u32 v9, s36, v24
    s_mov_b32 s37, 147456
    v_mul_lo_u32 v23, v22, s37
    v_lshl_add_u32 v23, v21, 4, v23
    s_lshl_b32 s36, s4, 8
    v_add_u32 v5, s36, v23
    s_lshl_b32 s36, s4, 3
    v_add_u32 v23, s36, v22
    v_mul_u32_u24 v23, 9216, v23
    v_lshl_add_u32 v23, v21, 4, v23
    s_lshl_b32 s36, s48, 8
    v_add_u32 v10, s36, v23
    v_lshlrev_b32 v23, 11, v22
    v_lshl_add_u32 v23, v21, 2, v23
    s_lshl_b32 s36, s4, 6
    v_add_u32 v11, s36, v23
    v_add_u32 v12, 8192, v11
    s_lshl_b32 s36, s4, 11
    s_add_u32 s36, s36, 0
    v_add_u32 v7, s36, v1
    s_waitcnt lgkmcnt(0)
    s_cmp_lg_u32 s4, 0
    s_cbranch_scc1 dwok_51
dw_50:
    buffer_load_dword v244, off, s[12:15], 0 offset:64 sc1
    s_waitcnt vmcnt(0)
    v_readfirstlane_b32 s36, v244
    s_nop 0
    s_cmp_ge_u32 s36, 128
    s_cbranch_scc1 dwok_51
    s_sleep 4
    s_sub_u32 s33, s33, 1
    s_cmp_gt_i32 s33, 0
    s_cbranch_scc1 dw_50
dwok_51:
    s_barrier
    s_mov_b32 s41, 1
    s_and_b32 s39, s28, 31
    s_lshl_b32 s39, s39, 7
    s_add_u32 s39, s39, 0x144000
    v_lshlrev_b32 v245, 3, v1
    s_mov_b32 exec_lo, 0x1
    s_mov_b32 exec_hi, 0x0
poll_52:
    buffer_load_dword v244, v245, s[8:11], s39 offen sc1
    s_waitcnt vmcnt(0)
    v_cmp_gt_u32 vcc, s41, v244
    s_cbranch_vccz pollok_53
    s_sleep 8
    s_sub_u32 s33, s33, 1
    s_cmp_gt_i32 s33, 0
    s_cbranch_scc1 poll_52
pollok_53:
    s_mov_b64 exec, -1
    s_mov_b32 s36, 0
    buffer_load_dwordx4 v[112:115], v8, s[16:19], s36 offen offset:0 nt
    buffer_load_dwordx4 v[116:119], v8, s[16:19], s36 offen offset:1152 nt
    buffer_load_dwordx4 v[120:123], v8, s[16:19], s36 offen offset:2304 nt
    buffer_load_dwordx4 v[124:127], v8, s[16:19], s36 offen offset:3456 nt
    buffer_load_ushort v144, v9, s[16:19], s36 offen offset:0 nt
    buffer_load_ushort v145, v9, s[16:19], s36 offen offset:1152 nt
    buffer_load_ushort v146, v9, s[16:19], s36 offen offset:2304 nt
    buffer_load_ushort v147, v9, s[16:19], s36 offen offset:3456 nt
    s_mov_b32 s36, 4608
    buffer_load_dwordx4 v[128:131], v8, s[16:19], s36 offen offset:0 nt
    buffer_load_dwordx4 v[132:135], v8, s[16:19], s36 offen offset:1152 nt
    buffer_load_dwordx4 v[136:139], v8, s[16:19], s36 offen offset:2304 nt
    buffer_load_dwordx4 v[140:143], v8, s[16:19], s36 offen offset:3456 nt
    buffer_load_ushort v148, v9, s[16:19], s36 offen offset:0 nt
    buffer_load_ushort v149, v9, s[16:19], s36 offen offset:1152 nt
    buffer_load_ushort v150, v9, s[16:19], s36 offen offset:2304 nt
    buffer_load_ushort v151, v9, s[16:19], s36 offen offset:3456 nt
    s_mov_b32 s36, 36864
    buffer_load_dwordx4 v[152:155], v8, s[16:19], s36 offen offset:0 nt
    buffer_load_dwordx4 v[156:159], v8, s[16:19], s36 offen offset:1152 nt
    buffer_load_dwordx4 v[160:163], v8, s[16:19], s36 offen offset:2304 nt
    buffer_load_dwordx4 v[164:167], v8, s[16:19], s36 offen offset:3456 nt
    buffer_load_ushort v184, v9, s[16:19], s36 offen offset:0 nt
    buffer_load_ushort v185, v9, s[16:19], s36 offen offset:1152 nt
    buffer_load_ushort v186, v9, s[16:19], s36 offen offset:2304 nt
    buffer_load_ushort v187, v9, s[16:19], s36 offen offset:3456 nt
    s_mov_b32 s36, 41472
    buffer_load_dwordx4 v[168:171], v8, s[16:19], s36 offen offset:0 nt
    buffer_load_dwordx4 v[172:175], v8, s[16:19], s36 offen offset:1152 nt
    buffer_load_dwordx4 v[176:179], v8, s[16:19], s36 offen offset:2304 nt
    buffer_load_dwordx4 v[180:183], v8, s[16:19], s36 offen offset:3456 nt
    buffer_load_ushort v188, v9, s[16:19], s36 offen offset:0 nt
    buffer_load_ushort v189, v9, s[16:19], s36 offen offset:1152 nt
    buffer_load_ushort v190, v9, s[16:19], s36 offen offset:2304 nt
    buffer_load_ushort v191, v9, s[16:19], s36 offen offset:3456 nt
    s_mov_b32 s36, 73728
    buffer_load_dwordx4 v[192:195], v8, s[16:19], s36 offen offset:0 nt
    buffer_load_dwordx4 v[196:199], v8, s[16:19], s36 offen offset:1152 nt
    buffer_load_dwordx4 v[200:203], v8, s[16:19], s36 offen offset:2304 nt
    buffer_load_dwordx4 v[204:207], v8, s[16:19], s36 offen offset:3456 nt
    buffer_load_ushort v224, v9, s[16:19], s36 offen offset:0 nt
    buffer_load_ushort v225, v9, s[16:19], s36 offen offset:1152 nt
    buffer_load_ushort v226, v9, s[16:19], s36 offen offset:2304 nt
    buffer_load_ushort v227, v9, s[16:19], s36 offen offset:3456 nt
    s_mov_b32 s36, 78336
    buffer_load_dwordx4 v[208:211], v8, s[16:19], s36 offen offset:0 nt
    buffer_load_dwordx4 v[212:215], v8, s[16:19], s36 offen offset:1152 nt
    buffer_load_dwordx4 v[216:219], v8, s[16:19], s36 offen offset:2304 nt
    buffer_load_dwordx4 v[220:223], v8, s[16:19], s36 offen offset:3456 nt
    buffer_load_ushort v228, v9, s[16:19], s36 offen offset:0 nt
    buffer_load_ushort v229, v9, s[16:19], s36 offen offset:1152 nt
    buffer_load_ushort v230, v9, s[16:19], s36 offen offset:2304 nt
    buffer_load_ushort v231, v9, s[16:19], s36 offen offset:3456 nt
    s_waitcnt vmcnt(32)
    v_perm_b32 v24, v116, v112, s34
    v_accvgpr_write_b32 a0, v24
    v_perm_b32 v25, v124, v120, s34
    v_accvgpr_write_b32 a1, v25
    v_perm_b32 v26, v132, v128, s34
    v_accvgpr_write_b32 a2, v26
    v_perm_b32 v27, v140, v136, s34
    v_accvgpr_write_b32 a3, v27
    v_perm_b32 v28, v116, v112, s35
    v_accvgpr_write_b32 a4, v28
    v_perm_b32 v29, v124, v120, s35
    v_accvgpr_write_b32 a5, v29
    v_perm_b32 v30, v132, v128, s35
    v_accvgpr_write_b32 a6, v30
    v_perm_b32 v31, v140, v136, s35
    v_accvgpr_write_b32 a7, v31
    v_perm_b32 v24, v117, v113, s34
    v_accvgpr_write_b32 a8, v24
    v_perm_b32 v25, v125, v121, s34
    v_accvgpr_write_b32 a9, v25
    v_perm_b32 v26, v133, v129, s34
    v_accvgpr_write_b32 a10, v26
    v_perm_b32 v27, v141, v137, s34
    v_accvgpr_write_b32 a11, v27
    v_perm_b32 v28, v117, v113, s35
    v_accvgpr_write_b32 a12, v28
    v_perm_b32 v29, v125, v121, s35
    v_accvgpr_write_b32 a13, v29
    v_perm_b32 v30, v133, v129, s35
    v_accvgpr_write_b32 a14, v30
    v_perm_b32 v31, v141, v137, s35
    v_accvgpr_write_b32 a15, v31
    v_perm_b32 v24, v118, v114, s34
    v_accvgpr_write_b32 a16, v24
    v_perm_b32 v25, v126, v122, s34
    v_accvgpr_write_b32 a17, v25
    v_perm_b32 v26, v134, v130, s34
    v_accvgpr_write_b32 a18, v26
    v_perm_b32 v27, v142, v138, s34
    v_accvgpr_write_b32 a19, v27
    v_perm_b32 v28, v118, v114, s35
    v_accvgpr_write_b32 a20, v28
    v_perm_b32 v29, v126, v122, s35
    v_accvgpr_write_b32 a21, v29
    v_perm_b32 v30, v134, v130, s35
    v_accvgpr_write_b32 a22, v30
    v_perm_b32 v31, v142, v138, s35
    v_accvgpr_write_b32 a23, v31
    v_perm_b32 v24, v119, v115, s34
    v_accvgpr_write_b32 a24, v24
    v_perm_b32 v25, v127, v123, s34
    v_accvgpr_write_b32 a25, v25
    v_perm_b32 v26, v135, v131, s34
    v_accvgpr_write_b32 a26, v26
    v_perm_b32 v27, v143, v139, s34
    v_accvgpr_write_b32 a27, v27
    v_perm_b32 v28, v119, v115, s35
    v_accvgpr_write_b32 a28, v28
    v_perm_b32 v29, v127, v123, s35
    v_accvgpr_write_b32 a29, v29
    v_perm_b32 v30, v135, v131, s35
    v_accvgpr_write_b32 a30, v30
    v_perm_b32 v31, v143, v139, s35
    v_accvgpr_write_b32 a31, v31
    v_lshl_or_b32 v24, v145, 16, v144
    v_accvgpr_write_b32 a32, v24
    v_lshl_or_b32 v25, v147, 16, v146
    v_accvgpr_write_b32 a33, v25
    v_lshl_or_b32 v26, v149, 16, v148
    v_accvgpr_write_b32 a34, v26
    v_lshl_or_b32 v27, v151, 16, v150
    v_accvgpr_write_b32 a35, v27
    s_mov_b32 s36, 110592
    buffer_load_dwordx4 v[112:115], v8, s[16:19], s36 offen offset:0 nt
    buffer_load_dwordx4 v[116:119], v8, s[16:19], s36 offen offset:1152 nt
    buffer_load_dwordx4 v[120:123], v8, s[16:19], s36 offen offset:2304 nt
    buffer_load_dwordx4 v[124:127], v8, s[16:19], s36 offen offset:3456 nt
    buffer_load_ushort v144, v9, s[16:19], s36 offen offset:0 nt
    buffer_load_ushort v145, v9, s[16:19], s36 offen offset:1152 nt
    buffer_load_ushort v146, v9, s[16:19], s36 offen offset:2304 nt
    buffer_load_ushort v147, v9, s[16:19], s36 offen offset:3456 nt
    s_mov_b32 s36, 115200
    buffer_load_dwordx4 v[128:131], v8, s[16:19], s36 offen offset:0 nt
    buffer_load_dwordx4 v[132:135], v8, s[16:19], s36 offen offset:1152 nt
    buffer_load_dwordx4 v[136:139], v8, s[16:19], s36 offen offset:2304 nt
    buffer_load_dwordx4 v[140:143], v8, s[16:19], s36 offen offset:3456 nt
    buffer_load_ushort v148, v9, s[16:19], s36 offen offset:0 nt
    buffer_load_ushort v149, v9, s[16:19], s36 offen offset:1152 nt
    buffer_load_ushort v150, v9, s[16:19], s36 offen offset:2304 nt
    buffer_load_ushort v151, v9, s[16:19], s36 offen offset:3456 nt
    s_waitcnt vmcnt(32)
    v_perm_b32 v24, v156, v152, s34
    v_accvgpr_write_b32 a36, v24
    v_perm_b32 v25, v164, v160, s34
    v_accvgpr_write_b32 a37, v25
    v_perm_b32 v26, v172, v168, s34
    v_accvgpr_write_b32 a38, v26
    v_perm_b32 v27, v180, v176, s34
    v_accvgpr_write_b32 a39, v27
    v_perm_b32 v28, v156, v152, s35
    v_accvgpr_write_b32 a40, v28
    v_perm_b32 v29, v164, v160, s35
    v_accvgpr_write_b32 a41, v29
    v_perm_b32 v30, v172, v168, s35
    v_accvgpr_write_b32 a42, v30
    v_perm_b32 v31, v180, v176, s35
    v_accvgpr_write_b32 a43, v31
    v_perm_b32 v24, v157, v153, s34
    v_accvgpr_write_b32 a44, v24
    v_perm_b32 v25, v165, v161, s34
    v_accvgpr_write_b32 a45, v25
    v_perm_b32 v26, v173, v169, s34
    v_accvgpr_write_b32 a46, v26
    v_perm_b32 v27, v181, v177, s34
    v_accvgpr_write_b32 a47, v27
    v_perm_b32 v28, v157, v153, s35
    v_accvgpr_write_b32 a48, v28
    v_perm_b32 v29, v165, v161, s35
    v_accvgpr_write_b32 a49, v29
    v_perm_b32 v30, v173, v169, s35
    v_accvgpr_write_b32 a50, v30
    v_perm_b32 v31, v181, v177, s35
    v_accvgpr_write_b32 a51, v31
    v_perm_b32 v24, v158, v154, s34
    v_accvgpr_write_b32 a52, v24
    v_perm_b32 v25, v166, v162, s34
    v_accvgpr_write_b32 a53, v25
    v_perm_b32 v26, v174, v170, s34
    v_accvgpr_write_b32 a54, v26
    v_perm_b32 v27, v182, v178, s34
    v_accvgpr_write_b32 a55, v27
    v_perm_b32 v28, v158, v154, s35
    v_accvgpr_write_b32 a56, v28
    v_perm_b32 v29, v166, v162, s35
    v_accvgpr_write_b32 a57, v29
    v_perm_b32 v30, v174, v170, s35
    v_accvgpr_write_b32 a58, v30
    v_perm_b32 v31, v182, v178, s35
    v_accvgpr_write_b32 a59, v31
    v_perm_b32 v24, v159, v155, s34
    v_accvgpr_write_b32 a60, v24
    v_perm_b32 v25, v167, v163, s34
    v_accvgpr_write_b32 a61, v25
    v_perm_b32 v26, v175, v171, s34
    v_accvgpr_write_b32 a62, v26
    v_perm_b32 v27, v183, v179, s34
    v_accvgpr_write_b32 a63, v27
    v_perm_b32 v28, v159, v155, s35
    v_accvgpr_write_b32 a64, v28
    v_perm_b32 v29, v167, v163, s35
    v_accvgpr_write_b32 a65, v29
    v_perm_b32 v30, v175, v171, s35
    v_accvgpr_write_b32 a66, v30
    v_perm_b32 v31, v183, v179, s35
    v_accvgpr_write_b32 a67, v31
    v_lshl_or_b32 v24, v185, 16, v184
    v_accvgpr_write_b32 a68, v24
    v_lshl_or_b32 v25, v187, 16, v186
    v_accvgpr_write_b32 a69, v25
    v_lshl_or_b32 v26, v189, 16, v188
    v_accvgpr_write_b32 a70, v26
    v_lshl_or_b32 v27, v191, 16, v190
    v_accvgpr_write_b32 a71, v27
    s_waitcnt vmcnt(16)
    v_perm_b32 v24, v196, v192, s34
    v_accvgpr_write_b32 a72, v24
    v_perm_b32 v25, v204, v200, s34
    v_accvgpr_write_b32 a73, v25
    v_perm_b32 v26, v212, v208, s34
    v_accvgpr_write_b32 a74, v26
    v_perm_b32 v27, v220, v216, s34
    v_accvgpr_write_b32 a75, v27
    v_perm_b32 v28, v196, v192, s35
    v_accvgpr_write_b32 a76, v28
    v_perm_b32 v29, v204, v200, s35
    v_accvgpr_write_b32 a77, v29
    v_perm_b32 v30, v212, v208, s35
    v_accvgpr_write_b32 a78, v30
    v_perm_b32 v31, v220, v216, s35
    v_accvgpr_write_b32 a79, v31
    v_perm_b32 v24, v197, v193, s34
    v_accvgpr_write_b32 a80, v24
    v_perm_b32 v25, v205, v201, s34
    v_accvgpr_write_b32 a81, v25
    v_perm_b32 v26, v213, v209, s34
    v_accvgpr_write_b32 a82, v26
    v_perm_b32 v27, v221, v217, s34
    v_accvgpr_write_b32 a83, v27
    v_perm_b32 v28, v197, v193, s35
    v_accvgpr_write_b32 a84, v28
    v_perm_b32 v29, v205, v201, s35
    v_accvgpr_write_b32 a85, v29
    v_perm_b32 v30, v213, v209, s35
    v_accvgpr_write_b32 a86, v30
    v_perm_b32 v31, v221, v217, s35
    v_accvgpr_write_b32 a87, v31
    v_perm_b32 v24, v198, v194, s34
    v_accvgpr_write_b32 a88, v24
    v_perm_b32 v25, v206, v202, s34
    v_accvgpr_write_b32 a89, v25
    v_perm_b32 v26, v214, v210, s34
    v_accvgpr_write_b32 a90, v26
    v_perm_b32 v27, v222, v218, s34
    v_accvgpr_write_b32 a91, v27
    v_perm_b32 v28, v198, v194, s35
    v_accvgpr_write_b32 a92, v28
    v_perm_b32 v29, v206, v202, s35
    v_accvgpr_write_b32 a93, v29
    v_perm_b32 v30, v214, v210, s35
    v_accvgpr_write_b32 a94, v30
    v_perm_b32 v31, v222, v218, s35
    v_accvgpr_write_b32 a95, v31
    v_perm_b32 v24, v199, v195, s34
    v_accvgpr_write_b32 a96, v24
    v_perm_b32 v25, v207, v203, s34
    v_accvgpr_write_b32 a97, v25
    v_perm_b32 v26, v215, v211, s34
    v_accvgpr_write_b32 a98, v26
    v_perm_b32 v27, v223, v219, s34
    v_accvgpr_write_b32 a99, v27
    v_perm_b32 v28, v199, v195, s35
    v_accvgpr_write_b32 a100, v28
    v_perm_b32 v29, v207, v203, s35
    v_accvgpr_write_b32 a101, v29
    v_perm_b32 v30, v215, v211, s35
    v_accvgpr_write_b32 a102, v30
    v_perm_b32 v31, v223, v219, s35
    v_accvgpr_write_b32 a103, v31
    v_lshl_or_b32 v24, v225, 16, v224
    v_accvgpr_write_b32 a104, v24
    v_lshl_or_b32 v25, v227, 16, v226
    v_accvgpr_write_b32 a105, v25
    v_lshl_or_b32 v26, v229, 16, v228
    v_accvgpr_write_b32 a106, v26
    v_lshl_or_b32 v27, v231, 16, v230
    v_accvgpr_write_b32 a107, v27
    s_waitcnt vmcnt(0)
    v_perm_b32 v24, v116, v112, s34
    v_accvgpr_write_b32 a108, v24
    v_perm_b32 v25, v124, v120, s34
    v_accvgpr_write_b32 a109, v25
    v_perm_b32 v26, v132, v128, s34
    v_accvgpr_write_b32 a110, v26
    v_perm_b32 v27, v140, v136, s34
    v_accvgpr_write_b32 a111, v27
    v_perm_b32 v28, v116, v112, s35
    v_accvgpr_write_b32 a112, v28
    v_perm_b32 v29, v124, v120, s35
    v_accvgpr_write_b32 a113, v29
    v_perm_b32 v30, v132, v128, s35
    v_accvgpr_write_b32 a114, v30
    v_perm_b32 v31, v140, v136, s35
    v_accvgpr_write_b32 a115, v31
    v_perm_b32 v24, v117, v113, s34
    v_accvgpr_write_b32 a116, v24
    v_perm_b32 v25, v125, v121, s34
    v_accvgpr_write_b32 a117, v25
    v_perm_b32 v26, v133, v129, s34
    v_accvgpr_write_b32 a118, v26
    v_perm_b32 v27, v141, v137, s34
    v_accvgpr_write_b32 a119, v27
    v_perm_b32 v28, v117, v113, s35
    v_accvgpr_write_b32 a120, v28
    v_perm_b32 v29, v125, v121, s35
    v_accvgpr_write_b32 a121, v29
    v_perm_b32 v30, v133, v129, s35
    v_accvgpr_write_b32 a122, v30
    v_perm_b32 v31, v141, v137, s35
    v_accvgpr_write_b32 a123, v31
    v_perm_b32 v24, v118, v114, s34
    v_accvgpr_write_b32 a124, v24
    v_perm_b32 v25, v126, v122, s34
    v_accvgpr_write_b32 a125, v25
    v_perm_b32 v26, v134, v130, s34
    v_accvgpr_write_b32 a126, v26
    v_perm_b32 v27, v142, v138, s34
    v_accvgpr_write_b32 a127, v27
    v_perm_b32 v28, v118, v114, s35
    v_accvgpr_write_b32 a128, v28
    v_perm_b32 v29, v126, v122, s35
    v_accvgpr_write_b32 a129, v29
    v_perm_b32 v30, v134, v130, s35
    v_accvgpr_write_b32 a130, v30
    v_perm_b32 v31, v142, v138, s35
    v_accvgpr_write_b32 a131, v31
    v_perm_b32 v24, v119, v115, s34
    v_accvgpr_write_b32 a132, v24
    v_perm_b32 v25, v127, v123, s34
    v_accvgpr_write_b32 a133, v25
    v_perm_b32 v26, v135, v131, s34
    v_accvgpr_write_b32 a134, v26
    v_perm_b32 v27, v143, v139, s34
    v_accvgpr_write_b32 a135, v27
    v_perm_b32 v28, v119, v115, s35
    v_accvgpr_write_b32 a136, v28
    v_perm_b32 v29, v127, v123, s35
    v_accvgpr_write_b32 a137, v29
    v_perm_b32 v30, v135, v131, s35
    v_accvgpr_write_b32 a138, v30
    v_perm_b32 v31, v143, v139, s35
    v_accvgpr_write_b32 a139, v31
    v_lshl_or_b32 v24, v145, 16, v144
    v_accvgpr_write_b32 a140, v24
    v_lshl_or_b32 v25, v147, 16, v146
    v_accvgpr_write_b32 a141, v25
    v_lshl_or_b32 v26, v149, 16, v148
    v_accvgpr_write_b32 a142, v26
    v_lshl_or_b32 v27, v151, 16, v150
    v_accvgpr_write_b32 a143, v27
    s_lshl_b32 s36, s4, 11
    s_add_u32 m0, s36, 0
    s_mov_b32 s36, 0
    buffer_load_dwordx4 v10, s[20:23], s36 offen nt lds
    s_add_u32 m0, m0, 1024
    s_mov_b32 s36, 36864
    buffer_load_dwordx4 v10, s[20:23], s36 offen nt lds
    s_lshl_b32 s36, s4, 11
    s_add_u32 m0, s36, 8192
    s_mov_b32 s36, 0
    buffer_load_dwordx4 v10, s[24:27], s36 offen nt lds
    s_add_u32 m0, m0, 1024
    s_mov_b32 s36, 36864
    buffer_load_dwordx4 v10, s[24:27], s36 offen nt lds
    s_lshl_b32 s36, s4, 11
    s_add_u32 m0, s36, 16384
    s_mov_b32 s36, 294912
    buffer_load_dwordx4 v10, s[20:23], s36 offen nt lds
    s_add_u32 m0, m0, 1024
    s_mov_b32 s36, 331776
    buffer_load_dwordx4 v10, s[20:23], s36 offen nt lds
    s_lshl_b32 s36, s4, 11
    s_add_u32 m0, s36, 24576
    s_mov_b32 s36, 294912
    buffer_load_dwordx4 v10, s[24:27], s36 offen nt lds
    s_add_u32 m0, m0, 1024
    s_mov_b32 s36, 331776
    buffer_load_dwordx4 v10, s[24:27], s36 offen nt lds
    s_lshl_b32 s36, s4, 11
    s_add_u32 m0, s36, 32768
    s_mov_b32 s36, 589824
    buffer_load_dwordx4 v10, s[20:23], s36 offen nt lds
    s_add_u32 m0, m0, 1024
    s_mov_b32 s36, 626688
    buffer_load_dwordx4 v10, s[20:23], s36 offen nt lds
    s_lshl_b32 s36, s4, 11
    s_add_u32 m0, s36, 40960
    s_mov_b32 s36, 589824
    buffer_load_dwordx4 v10, s[24:27], s36 offen nt lds
    s_add_u32 m0, m0, 1024
    s_mov_b32 s36, 626688
    buffer_load_dwordx4 v10, s[24:27], s36 offen nt lds
    s_lshl_b32 s36, s4, 11
    s_add_u32 m0, s36, 49152
    s_mov_b32 s36, 884736
    buffer_load_dwordx4 v10, s[20:23], s36 offen nt lds
    s_add_u32 m0, m0, 1024
    s_mov_b32 s36, 921600
    buffer_load_dwordx4 v10, s[20:23], s36 offen nt lds
    s_lshl_b32 s36, s4, 11
    s_add_u32 m0, s36, 57344
    s_mov_b32 s36, 884736
    buffer_load_dwordx4 v10, s[24:27], s36 offen nt lds
    s_add_u32 m0, m0, 1024
    s_mov_b32 s36, 921600
    buffer_load_dwordx4 v10, s[24:27], s36 offen nt lds
    s_lshl_b32 s36, s4, 11
    s_add_u32 m0, s36, 65536
    s_mov_b32 s36, 1179648
    buffer_load_dwordx4 v10, s[20:23], s36 offen nt lds
    s_add_u32 m0, m0, 1024
    s_mov_b32 s36, 1216512
    buffer_load_dwordx4 v10, s[20:23], s36 offen nt lds
    s_lshl_b32 s36, s4, 11
    s_add_u32 m0, s36, 73728
    s_mov_b32 s36, 1179648
    buffer_load_dwordx4 v10, s[24:27], s36 offen nt lds
    s_add_u32 m0, m0, 1024
    s_mov_b32 s36, 1216512
    buffer_load_dwordx4 v10, s[24:27], s36 offen nt lds
    s_lshl_b32 s36, s4, 11
    s_add_u32 m0, s36, 81920
    s_mov_b32 s36, 1474560
    buffer_load_dwordx4 v10, s[20:23], s36 offen nt lds
    s_add_u32 m0, m0, 1024
    s_mov_b32 s36, 1511424
    buffer_load_dwordx4 v10, s[20:23], s36 offen nt lds
    s_lshl_b32 s36, s4, 11
    s_add_u32 m0, s36, 90112
    s_mov_b32 s36, 1474560
    buffer_load_dwordx4 v10, s[24:27], s36 offen nt lds
    s_add_u32 m0, m0, 1024
    s_mov_b32 s36, 1511424
    buffer_load_dwordx4 v10, s[24:27], s36 offen nt lds
    s_lshl_b32 s36, s4, 11
    s_add_u32 m0, s36, 98304
    s_mov_b32 s36, 1769472
    buffer_load_dwordx4 v10, s[20:23], s36 offen nt lds
    s_add_u32 m0, m0, 1024
    s_mov_b32 s36, 1806336
    buffer_load_dwordx4 v10, s[20:23], s36 offen nt lds
    s_lshl_b32 s36, s4, 11
    s_add_u32 m0, s36, 106496
    s_mov_b32 s36, 1769472
    buffer_load_dwordx4 v10, s[24:27], s36 offen nt lds
    s_add_u32 m0, m0, 1024
    s_mov_b32 s36, 1806336
    buffer_load_dwordx4 v10, s[24:27], s36 offen nt lds
    s_lshl_b32 s36, s4, 11
    s_add_u32 m0, s36, 114688
    s_mov_b32 s36, 2064384
    buffer_load_dwordx4 v10, s[20:23], s36 offen nt lds
    s_add_u32 m0, m0, 1024
    s_mov_b32 s36, 2101248
    buffer_load_dwordx4 v10, s[20:23], s36 offen nt lds
    s_lshl_b32 s36, s4, 11
    s_add_u32 m0, s36, 122880
    s_mov_b32 s36, 2064384
    buffer_load_dwordx4 v10, s[24:27], s36 offen nt lds
    s_add_u32 m0, m0, 1024
    s_mov_b32 s36, 2101248
    buffer_load_dwordx4 v10, s[24:27], s36 offen nt lds
    s_waitcnt vmcnt(28)
    s_barrier
    s_lshl_b32 s36, s4, 11
    s_add_u32 m0, s36, 131072
    s_mov_b32 s36, 2359296
    buffer_load_dwordx4 v10, s[20:23], s36 offen nt lds
    s_add_u32 m0, m0, 1024
    s_mov_b32 s36, 2396160
    buffer_load_dwordx4 v10, s[20:23], s36 offen nt lds
    s_lshl_b32 s36, s4, 11
    s_add_u32 m0, s36, 139264
    s_mov_b32 s36, 2359296
    buffer_load_dwordx4 v10, s[24:27], s36 offen nt lds
    s_add_u32 m0, m0, 1024
    s_mov_b32 s36, 2396160
    buffer_load_dwordx4 v10, s[24:27], s36 offen nt lds
    v_add_u32 v9, 0, v11
    ds_read_b32 v32, v9 offset:0
    ds_read_b32 v33, v9 offset:256
    ds_read_b32 v34, v9 offset:512
    ds_read_b32 v35, v9 offset:768
    ds_read_b32 v36, v9 offset:1024
    ds_read_b32 v37, v9 offset:1280
    ds_read_b32 v38, v9 offset:1536
    ds_read_b32 v39, v9 offset:1792
    v_add_u32 v9, 0, v12
    ds_read_b32 v40, v9 offset:0
    ds_read_b32 v41, v9 offset:256
    ds_read_b32 v42, v9 offset:512
    ds_read_b32 v43, v9 offset:768
    ds_read_b32 v44, v9 offset:1024
    ds_read_b32 v45, v9 offset:1280
    ds_read_b32 v46, v9 offset:1536
    ds_read_b32 v47, v9 offset:1792
    s_waitcnt lgkmcnt(8)
    v_perm_b32 v24, v33, v32, s34
    v_accvgpr_write_b32 a144, v24
    v_perm_b32 v25, v35, v34, s34
    v_accvgpr_write_b32 a145, v25
    v_perm_b32 v26, v37, v36, s34
    v_accvgpr_write_b32 a146, v26
    v_perm_b32 v27, v39, v38, s34
    v_accvgpr_write_b32 a147, v27
    v_perm_b32 v28, v33, v32, s35
    v_accvgpr_write_b32 a148, v28
    v_perm_b32 v29, v35, v34, s35
    v_accvgpr_write_b32 a149, v29
    v_perm_b32 v30, v37, v36, s35
    v_accvgpr_write_b32 a150, v30
    v_perm_b32 v31, v39, v38, s35
    v_accvgpr_write_b32 a151, v31
    s_waitcnt lgkmcnt(0)
    v_perm_b32 v112, v41, v40, s34
    v_perm_b32 v113, v43, v42, s34
    v_perm_b32 v114, v45, v44, s34
    v_perm_b32 v115, v47, v46, s34
    v_perm_b32 v116, v41, v40, s35
    v_perm_b32 v117, v43, v42, s35
    v_perm_b32 v118, v45, v44, s35
    v_perm_b32 v119, v47, v46, s35
    s_waitcnt vmcnt(28)
    s_barrier
    s_lshl_b32 s36, s4, 11
    s_add_u32 m0, s36, 0
    s_mov_b32 s36, 2654208
    buffer_load_dwordx4 v10, s[20:23], s36 offen nt lds
    s_add_u32 m0, m0, 1024
    s_mov_b32 s36, 2691072
    buffer_load_dwordx4 v10, s[20:23], s36 offen nt lds
    s_lshl_b32 s36, s4, 11
    s_add_u32 m0, s36, 8192
    s_mov_b32 s36, 2654208
    buffer_load_dwordx4 v10, s[24:27], s36 offen nt lds
    s_add_u32 m0, m0, 1024
    s_mov_b32 s36, 2691072
    buffer_load_dwordx4 v10, s[24:27], s36 offen nt lds
    v_add_u32 v9, 16384, v11
    ds_read_b32 v32, v9 offset:0
    ds_read_b32 v33, v9 offset:256
    ds_read_b32 v34, v9 offset:512
    ds_read_b32 v35, v9 offset:768
    ds_read_b32 v36, v9 offset:1024
    ds_read_b32 v37, v9 offset:1280
    ds_read_b32 v38, v9 offset:1536
    ds_read_b32 v39, v9 offset:1792
    v_add_u32 v9, 16384, v12
    ds_read_b32 v40, v9 offset:0
    ds_read_b32 v41, v9 offset:256
    ds_read_b32 v42, v9 offset:512
    ds_read_b32 v43, v9 offset:768
    ds_read_b32 v44, v9 offset:1024
    ds_read_b32 v45, v9 offset:1280
    ds_read_b32 v46, v9 offset:1536
    ds_read_b32 v47, v9 offset:1792
    s_waitcnt lgkmcnt(8)
    v_perm_b32 v24, v33, v32, s34
    v_accvgpr_write_b32 a152, v24
    v_perm_b32 v25, v35, v34, s34
    v_accvgpr_write_b32 a153, v25
    v_perm_b32 v26, v37, v36, s34
    v_accvgpr_write_b32 a154, v26
    v_perm_b32 v27, v39, v38, s34
    v_accvgpr_write_b32 a155, v27
    v_perm_b32 v28, v33, v32, s35
    v_accvgpr_write_b32 a156, v28
    v_perm_b32 v29, v35, v34, s35
    v_accvgpr_write_b32 a157, v29
    v_perm_b32 v30, v37, v36, s35
    v_accvgpr_write_b32 a158, v30
    v_perm_b32 v31, v39, v38, s35
    v_accvgpr_write_b32 a159, v31
    s_waitcnt lgkmcnt(0)
    v_perm_b32 v120, v41, v40, s34
    v_perm_b32 v121, v43, v42, s34
    v_perm_b32 v122, v45, v44, s34
    v_perm_b32 v123, v47, v46, s34
    v_perm_b32 v124, v41, v40, s35
    v_perm_b32 v125, v43, v42, s35
    v_perm_b32 v126, v45, v44, s35
    v_perm_b32 v127, v47, v46, s35
    s_waitcnt vmcnt(28)
    s_barrier
    s_lshl_b32 s36, s4, 11
    s_add_u32 m0, s36, 16384
    s_mov_b32 s36, 2949120
    buffer_load_dwordx4 v10, s[20:23], s36 offen nt lds
    s_add_u32 m0, m0, 1024
    s_mov_b32 s36, 2985984
    buffer_load_dwordx4 v10, s[20:23], s36 offen nt lds
    s_lshl_b32 s36, s4, 11
    s_add_u32 m0, s36, 24576
    s_mov_b32 s36, 2949120
    buffer_load_dwordx4 v10, s[24:27], s36 offen nt lds
    s_add_u32 m0, m0, 1024
    s_mov_b32 s36, 2985984
    buffer_load_dwordx4 v10, s[24:27], s36 offen nt lds
    v_add_u32 v9, 32768, v11
    ds_read_b32 v32, v9 offset:0
    ds_read_b32 v33, v9 offset:256
    ds_read_b32 v34, v9 offset:512
    ds_read_b32 v35, v9 offset:768
    ds_read_b32 v36, v9 offset:1024
    ds_read_b32 v37, v9 offset:1280
    ds_read_b32 v38, v9 offset:1536
    ds_read_b32 v39, v9 offset:1792
    v_add_u32 v9, 32768, v12
    ds_read_b32 v40, v9 offset:0
    ds_read_b32 v41, v9 offset:256
    ds_read_b32 v42, v9 offset:512
    ds_read_b32 v43, v9 offset:768
    ds_read_b32 v44, v9 offset:1024
    ds_read_b32 v45, v9 offset:1280
    ds_read_b32 v46, v9 offset:1536
    ds_read_b32 v47, v9 offset:1792
    s_waitcnt lgkmcnt(8)
    v_perm_b32 v24, v33, v32, s34
    v_accvgpr_write_b32 a160, v24
    v_perm_b32 v25, v35, v34, s34
    v_accvgpr_write_b32 a161, v25
    v_perm_b32 v26, v37, v36, s34
    v_accvgpr_write_b32 a162, v26
    v_perm_b32 v27, v39, v38, s34
    v_accvgpr_write_b32 a163, v27
    v_perm_b32 v28, v33, v32, s35
    v_accvgpr_write_b32 a164, v28
    v_perm_b32 v29, v35, v34, s35
    v_accvgpr_write_b32 a165, v29
    v_perm_b32 v30, v37, v36, s35
    v_accvgpr_write_b32 a166, v30
    v_perm_b32 v31, v39, v38, s35
    v_accvgpr_write_b32 a167, v31
    s_waitcnt lgkmcnt(0)
    v_perm_b32 v128, v41, v40, s34
    v_perm_b32 v129, v43, v42, s34
    v_perm_b32 v130, v45, v44, s34
    v_perm_b32 v131, v47, v46, s34
    v_perm_b32 v132, v41, v40, s35
    v_perm_b32 v133, v43, v42, s35
    v_perm_b32 v134, v45, v44, s35
    v_perm_b32 v135, v47, v46, s35
    s_waitcnt vmcnt(28)
    s_barrier
    s_lshl_b32 s36, s4, 11
    s_add_u32 m0, s36, 32768
    s_mov_b32 s36, 3244032
    buffer_load_dwordx4 v10, s[20:23], s36 offen nt lds
    s_add_u32 m0, m0, 1024
    s_mov_b32 s36, 3280896
    buffer_load_dwordx4 v10, s[20:23], s36 offen nt lds
    s_lshl_b32 s36, s4, 11
    s_add_u32 m0, s36, 40960
    s_mov_b32 s36, 3244032
    buffer_load_dwordx4 v10, s[24:27], s36 offen nt lds
    s_add_u32 m0, m0, 1024
    s_mov_b32 s36, 3280896
    buffer_load_dwordx4 v10, s[24:27], s36 offen nt lds
    v_add_u32 v9, 49152, v11
    ds_read_b32 v32, v9 offset:0
    ds_read_b32 v33, v9 offset:256
    ds_read_b32 v34, v9 offset:512
    ds_read_b32 v35, v9 offset:768
    ds_read_b32 v36, v9 offset:1024
    ds_read_b32 v37, v9 offset:1280
    ds_read_b32 v38, v9 offset:1536
    ds_read_b32 v39, v9 offset:1792
    v_add_u32 v9, 49152, v12
    ds_read_b32 v40, v9 offset:0
    ds_read_b32 v41, v9 offset:256
    ds_read_b32 v42, v9 offset:512
    ds_read_b32 v43, v9 offset:768
    ds_read_b32 v44, v9 offset:1024
    ds_read_b32 v45, v9 offset:1280
    ds_read_b32 v46, v9 offset:1536
    ds_read_b32 v47, v9 offset:1792
    s_waitcnt lgkmcnt(8)
    v_perm_b32 v24, v33, v32, s34
    v_accvgpr_write_b32 a168, v24
    v_perm_b32 v25, v35, v34, s34
    v_accvgpr_write_b32 a169, v25
    v_perm_b32 v26, v37, v36, s34
    v_accvgpr_write_b32 a170, v26
    v_perm_b32 v27, v39, v38, s34
    v_accvgpr_write_b32 a171, v27
    v_perm_b32 v28, v33, v32, s35
    v_accvgpr_write_b32 a172, v28
    v_perm_b32 v29, v35, v34, s35
    v_accvgpr_write_b32 a173, v29
    v_perm_b32 v30, v37, v36, s35
    v_accvgpr_write_b32 a174, v30
    v_perm_b32 v31, v39, v38, s35
    v_accvgpr_write_b32 a175, v31
    s_waitcnt lgkmcnt(0)
    v_perm_b32 v136, v41, v40, s34
    v_perm_b32 v137, v43, v42, s34
    v_perm_b32 v138, v45, v44, s34
    v_perm_b32 v139, v47, v46, s34
    v_perm_b32 v140, v41, v40, s35
    v_perm_b32 v141, v43, v42, s35
    v_perm_b32 v142, v45, v44, s35
    v_perm_b32 v143, v47, v46, s35
    s_waitcnt vmcnt(28)
    s_barrier
    s_lshl_b32 s36, s4, 11
    s_add_u32 m0, s36, 49152
    s_mov_b32 s36, 3538944
    buffer_load_dwordx4 v10, s[20:23], s36 offen nt lds
    s_add_u32 m0, m0, 1024
    s_mov_b32 s36, 3575808
    buffer_load_dwordx4 v10, s[20:23], s36 offen nt lds
    s_lshl_b32 s36, s4, 11
    s_add_u32 m0, s36, 57344
    s_mov_b32 s36, 3538944
    buffer_load_dwordx4 v10, s[24:27], s36 offen nt lds
    s_add_u32 m0, m0, 1024
    s_mov_b32 s36, 3575808
    buffer_load_dwordx4 v10, s[24:27], s36 offen nt lds
    v_add_u32 v9, 65536, v11
    ds_read_b32 v32, v9 offset:0
    ds_read_b32 v33, v9 offset:256
    ds_read_b32 v34, v9 offset:512
    ds_read_b32 v35, v9 offset:768
    ds_read_b32 v36, v9 offset:1024
    ds_read_b32 v37, v9 offset:1280
    ds_read_b32 v38, v9 offset:1536
    ds_read_b32 v39, v9 offset:1792
    v_add_u32 v9, 65536, v12
    ds_read_b32 v40, v9 offset:0
    ds_read_b32 v41, v9 offset:256
    ds_read_b32 v42, v9 offset:512
    ds_read_b32 v43, v9 offset:768
    ds_read_b32 v44, v9 offset:1024
    ds_read_b32 v45, v9 offset:1280
    ds_read_b32 v46, v9 offset:1536
    ds_read_b32 v47, v9 offset:1792
    s_waitcnt lgkmcnt(8)
    v_perm_b32 v24, v33, v32, s34
    v_accvgpr_write_b32 a176, v24
    v_perm_b32 v25, v35, v34, s34
    v_accvgpr_write_b32 a177, v25
    v_perm_b32 v26, v37, v36, s34
    v_accvgpr_write_b32 a178, v26
    v_perm_b32 v27, v39, v38, s34
    v_accvgpr_write_b32 a179, v27
    v_perm_b32 v28, v33, v32, s35
    v_accvgpr_write_b32 a180, v28
    v_perm_b32 v29, v35, v34, s35
    v_accvgpr_write_b32 a181, v29
    v_perm_b32 v30, v37, v36, s35
    v_accvgpr_write_b32 a182, v30
    v_perm_b32 v31, v39, v38, s35
    v_accvgpr_write_b32 a183, v31
    s_waitcnt lgkmcnt(0)
    v_perm_b32 v144, v41, v40, s34
    v_perm_b32 v145, v43, v42, s34
    v_perm_b32 v146, v45, v44, s34
    v_perm_b32 v147, v47, v46, s34
    v_perm_b32 v148, v41, v40, s35
    v_perm_b32 v149, v43, v42, s35
    v_perm_b32 v150, v45, v44, s35
    v_perm_b32 v151, v47, v46, s35
    s_waitcnt vmcnt(28)
    s_barrier
    s_lshl_b32 s36, s4, 11
    s_add_u32 m0, s36, 65536
    s_mov_b32 s36, 3833856
    buffer_load_dwordx4 v10, s[20:23], s36 offen nt lds
    s_add_u32 m0, m0, 1024
    s_mov_b32 s36, 3870720
    buffer_load_dwordx4 v10, s[20:23], s36 offen nt lds
    s_lshl_b32 s36, s4, 11
    s_add_u32 m0, s36, 73728
    s_mov_b32 s36, 3833856
    buffer_load_dwordx4 v10, s[24:27], s36 offen nt lds
    s_add_u32 m0, m0, 1024
    s_mov_b32 s36, 3870720
    buffer_load_dwordx4 v10, s[24:27], s36 offen nt lds
    v_add_u32 v9, 81920, v11
    ds_read_b32 v32, v9 offset:0
    ds_read_b32 v33, v9 offset:256
    ds_read_b32 v34, v9 offset:512
    ds_read_b32 v35, v9 offset:768
    ds_read_b32 v36, v9 offset:1024
    ds_read_b32 v37, v9 offset:1280
    ds_read_b32 v38, v9 offset:1536
    ds_read_b32 v39, v9 offset:1792
    v_add_u32 v9, 81920, v12
    ds_read_b32 v40, v9 offset:0
    ds_read_b32 v41, v9 offset:256
    ds_read_b32 v42, v9 offset:512
    ds_read_b32 v43, v9 offset:768
    ds_read_b32 v44, v9 offset:1024
    ds_read_b32 v45, v9 offset:1280
    ds_read_b32 v46, v9 offset:1536
    ds_read_b32 v47, v9 offset:1792
    s_waitcnt lgkmcnt(8)
    v_perm_b32 v24, v33, v32, s34
    v_accvgpr_write_b32 a184, v24
    v_perm_b32 v25, v35, v34, s34
    v_accvgpr_write_b32 a185, v25
    v_perm_b32 v26, v37, v36, s34
    v_accvgpr_write_b32 a186, v26
    v_perm_b32 v27, v39, v38, s34
    v_accvgpr_write_b32 a187, v27
    v_perm_b32 v28, v33, v32, s35
    v_accvgpr_write_b32 a188, v28
    v_perm_b32 v29, v35, v34, s35
    v_accvgpr_write_b32 a189, v29
    v_perm_b32 v30, v37, v36, s35
    v_accvgpr_write_b32 a190, v30
    v_perm_b32 v31, v39, v38, s35
    v_accvgpr_write_b32 a191, v31
    s_waitcnt lgkmcnt(0)
    v_perm_b32 v152, v41, v40, s34
    v_perm_b32 v153, v43, v42, s34
    v_perm_b32 v154, v45, v44, s34
    v_perm_b32 v155, v47, v46, s34
    v_perm_b32 v156, v41, v40, s35
    v_perm_b32 v157, v43, v42, s35
    v_perm_b32 v158, v45, v44, s35
    v_perm_b32 v159, v47, v46, s35
    s_waitcnt vmcnt(28)
    s_barrier
    s_lshl_b32 s36, s4, 11
    s_add_u32 m0, s36, 81920
    s_mov_b32 s36, 4128768
    buffer_load_dwordx4 v10, s[20:23], s36 offen nt lds
    s_add_u32 m0, m0, 1024
    s_mov_b32 s36, 4165632
    buffer_load_dwordx4 v10, s[20:23], s36 offen nt lds
    s_lshl_b32 s36, s4, 11
    s_add_u32 m0, s36, 90112
    s_mov_b32 s36, 4128768
    buffer_load_dwordx4 v10, s[24:27], s36 offen nt lds
    s_add_u32 m0, m0, 1024
    s_mov_b32 s36, 4165632
    buffer_load_dwordx4 v10, s[24:27], s36 offen nt lds
    v_add_u32 v9, 98304, v11
    ds_read_b32 v32, v9 offset:0
    ds_read_b32 v33, v9 offset:256
    ds_read_b32 v34, v9 offset:512
    ds_read_b32 v35, v9 offset:768
    ds_read_b32 v36, v9 offset:1024
    ds_read_b32 v37, v9 offset:1280
    ds_read_b32 v38, v9 offset:1536
    ds_read_b32 v39, v9 offset:1792
    v_add_u32 v9, 98304, v12
    ds_read_b32 v40, v9 offset:0
    ds_read_b32 v41, v9 offset:256
    ds_read_b32 v42, v9 offset:512
    ds_read_b32 v43, v9 offset:768
    ds_read_b32 v44, v9 offset:1024
    ds_read_b32 v45, v9 offset:1280
    ds_read_b32 v46, v9 offset:1536
    ds_read_b32 v47, v9 offset:1792
    s_waitcnt lgkmcnt(8)
    v_perm_b32 v24, v33, v32, s34
    v_accvgpr_write_b32 a192, v24
    v_perm_b32 v25, v35, v34, s34
    v_accvgpr_write_b32 a193, v25
    v_perm_b32 v26, v37, v36, s34
    v_accvgpr_write_b32 a194, v26
    v_perm_b32 v27, v39, v38, s34
    v_accvgpr_write_b32 a195, v27
    v_perm_b32 v28, v33, v32, s35
    v_accvgpr_write_b32 a196, v28
    v_perm_b32 v29, v35, v34, s35
    v_accvgpr_write_b32 a197, v29
    v_perm_b32 v30, v37, v36, s35
    v_accvgpr_write_b32 a198, v30
    v_perm_b32 v31, v39, v38, s35
    v_accvgpr_write_b32 a199, v31
    s_waitcnt lgkmcnt(0)
    v_perm_b32 v160, v41, v40, s34
    v_perm_b32 v161, v43, v42, s34
    v_perm_b32 v162, v45, v44, s34
    v_perm_b32 v163, v47, v46, s34
    v_perm_b32 v164, v41, v40, s35
    v_perm_b32 v165, v43, v42, s35
    v_perm_b32 v166, v45, v44, s35
    v_perm_b32 v167, v47, v46, s35
    s_waitcnt vmcnt(28)
    s_barrier
    s_lshl_b32 s36, s4, 11
    s_add_u32 m0, s36, 98304
    s_mov_b32 s36, 4423680
    buffer_load_dwordx4 v10, s[20:23], s36 offen nt lds
    s_add_u32 m0, m0, 1024
    s_mov_b32 s36, 4460544
    buffer_load_dwordx4 v10, s[20:23], s36 offen nt lds
    s_lshl_b32 s36, s4, 11
    s_add_u32 m0, s36, 106496
    s_mov_b32 s36, 4423680
    buffer_load_dwordx4 v10, s[24:27], s36 offen nt lds
    s_add_u32 m0, m0, 1024
    s_mov_b32 s36, 4460544
    buffer_load_dwordx4 v10, s[24:27], s36 offen nt lds
    v_add_u32 v9, 114688, v11
    ds_read_b32 v32, v9 offset:0
    ds_read_b32 v33, v9 offset:256
    ds_read_b32 v34, v9 offset:512
    ds_read_b32 v35, v9 offset:768
    ds_read_b32 v36, v9 offset:1024
    ds_read_b32 v37, v9 offset:1280
    ds_read_b32 v38, v9 offset:1536
    ds_read_b32 v39, v9 offset:1792
    v_add_u32 v9, 114688, v12
    ds_read_b32 v40, v9 offset:0
    ds_read_b32 v41, v9 offset:256
    ds_read_b32 v42, v9 offset:512
    ds_read_b32 v43, v9 offset:768
    ds_read_b32 v44, v9 offset:1024
    ds_read_b32 v45, v9 offset:1280
    ds_read_b32 v46, v9 offset:1536
    ds_read_b32 v47, v9 offset:1792
    s_waitcnt lgkmcnt(8)
    v_perm_b32 v24, v33, v32, s34
    v_accvgpr_write_b32 a200, v24
    v_perm_b32 v25, v35, v34, s34
    v_accvgpr_write_b32 a201, v25
    v_perm_b32 v26, v37, v36, s34
    v_accvgpr_write_b32 a202, v26
    v_perm_b32 v27, v39, v38, s34
    v_accvgpr_write_b32 a203, v27
    v_perm_b32 v28, v33, v32, s35
    v_accvgpr_write_b32 a204, v28
    v_perm_b32 v29, v35, v34, s35
    v_accvgpr_write_b32 a205, v29
    v_perm_b32 v30, v37, v36, s35
    v_accvgpr_write_b32 a206, v30
    v_perm_b32 v31, v39, v38, s35
    v_accvgpr_write_b32 a207, v31
    s_waitcnt lgkmcnt(0)
    v_perm_b32 v168, v41, v40, s34
    v_perm_b32 v169, v43, v42, s34
    v_perm_b32 v170, v45, v44, s34
    v_perm_b32 v171, v47, v46, s34
    v_perm_b32 v172, v41, v40, s35
    v_perm_b32 v173, v43, v42, s35
    v_perm_b32 v174, v45, v44, s35
    v_perm_b32 v175, v47, v46, s35
    s_waitcnt vmcnt(28)
    s_barrier
    s_lshl_b32 s36, s4, 11
    s_add_u32 m0, s36, 114688
    s_mov_b32 s36, 4718592
    buffer_load_dwordx4 v10, s[20:23], s36 offen nt lds
    s_add_u32 m0, m0, 1024
    s_mov_b32 s36, 4755456
    buffer_load_dwordx4 v10, s[20:23], s36 offen nt lds
    s_lshl_b32 s36, s4, 11
    s_add_u32 m0, s36, 122880
    s_mov_b32 s36, 4718592
    buffer_load_dwordx4 v10, s[24:27], s36 offen nt lds
    s_add_u32 m0, m0, 1024
    s_mov_b32 s36, 4755456
    buffer_load_dwordx4 v10, s[24:27], s36 offen nt lds
    v_add_u32 v9, 131072, v11
    ds_read_b32 v32, v9 offset:0
    ds_read_b32 v33, v9 offset:256
    ds_read_b32 v34, v9 offset:512
    ds_read_b32 v35, v9 offset:768
    ds_read_b32 v36, v9 offset:1024
    ds_read_b32 v37, v9 offset:1280
    ds_read_b32 v38, v9 offset:1536
    ds_read_b32 v39, v9 offset:1792
    v_add_u32 v9, 131072, v12
    ds_read_b32 v40, v9 offset:0
    ds_read_b32 v41, v9 offset:256
    ds_read_b32 v42, v9 offset:512
    ds_read_b32 v43, v9 offset:768
    ds_read_b32 v44, v9 offset:1024
    ds_read_b32 v45, v9 offset:1280
    ds_read_b32 v46, v9 offset:1536
    ds_read_b32 v47, v9 offset:1792
    s_waitcnt lgkmcnt(8)
    v_perm_b32 v24, v33, v32, s34
    v_accvgpr_write_b32 a208, v24
    v_perm_b32 v25, v35, v34, s34
    v_accvgpr_write_b32 a209, v25
    v_perm_b32 v26, v37, v36, s34
    v_accvgpr_write_b32 a210, v26
    v_perm_b32 v27, v39, v38, s34
    v_accvgpr_write_b32 a211, v27
    v_perm_b32 v28, v33, v32, s35
    v_accvgpr_write_b32 a212, v28
    v_perm_b32 v29, v35, v34, s35
    v_accvgpr_write_b32 a213, v29
    v_perm_b32 v30, v37, v36, s35
    v_accvgpr_write_b32 a214, v30
    v_perm_b32 v31, v39, v38, s35
    v_accvgpr_write_b32 a215, v31
    s_waitcnt lgkmcnt(0)
    v_perm_b32 v176, v41, v40, s34
    v_perm_b32 v177, v43, v42, s34
    v_perm_b32 v178, v45, v44, s34
    v_perm_b32 v179, v47, v46, s34
    v_perm_b32 v180, v41, v40, s35
    v_perm_b32 v181, v43, v42, s35
    v_perm_b32 v182, v45, v44, s35
    v_perm_b32 v183, v47, v46, s35
    s_waitcnt vmcnt(28)
    s_barrier
    s_lshl_b32 s36, s4, 11
    s_add_u32 m0, s36, 131072
    s_mov_b32 s36, 5013504
    buffer_load_dwordx4 v10, s[20:23], s36 offen nt lds
    s_add_u32 m0, m0, 1024
    s_mov_b32 s36, 5050368
    buffer_load_dwordx4 v10, s[20:23], s36 offen nt lds
    s_lshl_b32 s36, s4, 11
    s_add_u32 m0, s36, 139264
    s_mov_b32 s36, 5013504
    buffer_load_dwordx4 v10, s[24:27], s36 offen nt lds
    s_add_u32 m0, m0, 1024
    s_mov_b32 s36, 5050368
    buffer_load_dwordx4 v10, s[24:27], s36 offen nt lds
    v_add_u32 v9, 0, v11
    ds_read_b32 v32, v9 offset:0
    ds_read_b32 v33, v9 offset:256
    ds_read_b32 v34, v9 offset:512
    ds_read_b32 v35, v9 offset:768
    ds_read_b32 v36, v9 offset:1024
    ds_read_b32 v37, v9 offset:1280
    ds_read_b32 v38, v9 offset:1536
    ds_read_b32 v39, v9 offset:1792
    v_add_u32 v9, 0, v12
    ds_read_b32 v40, v9 offset:0
    ds_read_b32 v41, v9 offset:256
    ds_read_b32 v42, v9 offset:512
    ds_read_b32 v43, v9 offset:768
    ds_read_b32 v44, v9 offset:1024
    ds_read_b32 v45, v9 offset:1280
    ds_read_b32 v46, v9 offset:1536
    ds_read_b32 v47, v9 offset:1792
    s_waitcnt lgkmcnt(8)
    v_perm_b32 v24, v33, v32, s34
    v_accvgpr_write_b32 a216, v24
    v_perm_b32 v25, v35, v34, s34
    v_accvgpr_write_b32 a217, v25
    v_perm_b32 v26, v37, v36, s34
    v_accvgpr_write_b32 a218, v26
    v_perm_b32 v27, v39, v38, s34
    v_accvgpr_write_b32 a219, v27
    v_perm_b32 v28, v33, v32, s35
    v_accvgpr_write_b32 a220, v28
    v_perm_b32 v29, v35, v34, s35
    v_accvgpr_write_b32 a221, v29
    v_perm_b32 v30, v37, v36, s35
    v_accvgpr_write_b32 a222, v30
    v_perm_b32 v31, v39, v38, s35
    v_accvgpr_write_b32 a223, v31
    s_waitcnt lgkmcnt(0)
    v_perm_b32 v184, v41, v40, s34
    v_perm_b32 v185, v43, v42, s34
    v_perm_b32 v186, v45, v44, s34
    v_perm_b32 v187, v47, v46, s34
    v_perm_b32 v188, v41, v40, s35
    v_perm_b32 v189, v43, v42, s35
    v_perm_b32 v190, v45, v44, s35
    v_perm_b32 v191, v47, v46, s35
    s_waitcnt vmcnt(28)
    s_barrier
    v_add_u32 v9, 16384, v11
    ds_read_b32 v32, v9 offset:0
    ds_read_b32 v33, v9 offset:256
    ds_read_b32 v34, v9 offset:512
    ds_read_b32 v35, v9 offset:768
    ds_read_b32 v36, v9 offset:1024
    ds_read_b32 v37, v9 offset:1280
    ds_read_b32 v38, v9 offset:1536
    ds_read_b32 v39, v9 offset:1792
    v_add_u32 v9, 16384, v12
    ds_read_b32 v40, v9 offset:0
    ds_read_b32 v41, v9 offset:256
    ds_read_b32 v42, v9 offset:512
    ds_read_b32 v43, v9 offset:768
    ds_read_b32 v44, v9 offset:1024
    ds_read_b32 v45, v9 offset:1280
    ds_read_b32 v46, v9 offset:1536
    ds_read_b32 v47, v9 offset:1792
    s_waitcnt lgkmcnt(8)
    v_perm_b32 v24, v33, v32, s34
    v_accvgpr_write_b32 a224, v24
    v_perm_b32 v25, v35, v34, s34
    v_accvgpr_write_b32 a225, v25
    v_perm_b32 v26, v37, v36, s34
    v_accvgpr_write_b32 a226, v26
    v_perm_b32 v27, v39, v38, s34
    v_accvgpr_write_b32 a227, v27
    v_perm_b32 v28, v33, v32, s35
    v_accvgpr_write_b32 a228, v28
    v_perm_b32 v29, v35, v34, s35
    v_accvgpr_write_b32 a229, v29
    v_perm_b32 v30, v37, v36, s35
    v_accvgpr_write_b32 a230, v30
    v_perm_b32 v31, v39, v38, s35
    v_accvgpr_write_b32 a231, v31
    s_waitcnt lgkmcnt(0)
    v_perm_b32 v192, v41, v40, s34
    v_perm_b32 v193, v43, v42, s34
    v_perm_b32 v194, v45, v44, s34
    v_perm_b32 v195, v47, v46, s34
    v_perm_b32 v196, v41, v40, s35
    v_perm_b32 v197, v43, v42, s35
    v_perm_b32 v198, v45, v44, s35
    v_perm_b32 v199, v47, v46, s35
    s_waitcnt vmcnt(24)
    s_barrier
    v_add_u32 v9, 32768, v11
    ds_read_b32 v32, v9 offset:0
    ds_read_b32 v33, v9 offset:256
    ds_read_b32 v34, v9 offset:512
    ds_read_b32 v35, v9 offset:768
    ds_read_b32 v36, v9 offset:1024
    ds_read_b32 v37, v9 offset:1280
    ds_read_b32 v38, v9 offset:1536
    ds_read_b32 v39, v9 offset:1792
    v_add_u32 v9, 32768, v12
    ds_read_b32 v40, v9 offset:0
    ds_read_b32 v41, v9 offset:256
    ds_read_b32 v42, v9 offset:512
    ds_read_b32 v43, v9 offset:768
    ds_read_b32 v44, v9 offset:1024
    ds_read_b32 v45, v9 offset:1280
    ds_read_b32 v46, v9 offset:1536
    ds_read_b32 v47, v9 offset:1792
    s_waitcnt lgkmcnt(8)
    v_perm_b32 v24, v33, v32, s34
    v_accvgpr_write_b32 a232, v24
    v_perm_b32 v25, v35, v34, s34
    v_accvgpr_write_b32 a233, v25
    v_perm_b32 v26, v37, v36, s34
    v_accvgpr_write_b32 a234, v26
    v_perm_b32 v27, v39, v38, s34
    v_accvgpr_write_b32 a235, v27
    v_perm_b32 v28, v33, v32, s35
    v_accvgpr_write_b32 a236, v28
    v_perm_b32 v29, v35, v34, s35
    v_accvgpr_write_b32 a237, v29
    v_perm_b32 v30, v37, v36, s35
    v_accvgpr_write_b32 a238, v30
    v_perm_b32 v31, v39, v38, s35
    v_accvgpr_write_b32 a239, v31
    s_waitcnt lgkmcnt(0)
    v_perm_b32 v200, v41, v40, s34
    v_perm_b32 v201, v43, v42, s34
    v_perm_b32 v202, v45, v44, s34
    v_perm_b32 v203, v47, v46, s34
    v_perm_b32 v204, v41, v40, s35
    v_perm_b32 v205, v43, v42, s35
    v_perm_b32 v206, v45, v44, s35
    v_perm_b32 v207, v47, v46, s35
    s_waitcnt vmcnt(20)
    s_barrier
    v_add_u32 v9, 49152, v11
    ds_read_b32 v32, v9 offset:0
    ds_read_b32 v33, v9 offset:256
    ds_read_b32 v34, v9 offset:512
    ds_read_b32 v35, v9 offset:768
    ds_read_b32 v36, v9 offset:1024
    ds_read_b32 v37, v9 offset:1280
    ds_read_b32 v38, v9 offset:1536
    ds_read_b32 v39, v9 offset:1792
    v_add_u32 v9, 49152, v12
    ds_read_b32 v40, v9 offset:0
    ds_read_b32 v41, v9 offset:256
    ds_read_b32 v42, v9 offset:512
    ds_read_b32 v43, v9 offset:768
    ds_read_b32 v44, v9 offset:1024
    ds_read_b32 v45, v9 offset:1280
    ds_read_b32 v46, v9 offset:1536
    ds_read_b32 v47, v9 offset:1792
    s_waitcnt lgkmcnt(8)
    v_perm_b32 v24, v33, v32, s34
    v_accvgpr_write_b32 a240, v24
    v_perm_b32 v25, v35, v34, s34
    v_accvgpr_write_b32 a241, v25
    v_perm_b32 v26, v37, v36, s34
    v_accvgpr_write_b32 a242, v26
    v_perm_b32 v27, v39, v38, s34
    v_accvgpr_write_b32 a243, v27
    v_perm_b32 v28, v33, v32, s35
    v_accvgpr_write_b32 a244, v28
    v_perm_b32 v29, v35, v34, s35
    v_accvgpr_write_b32 a245, v29
    v_perm_b32 v30, v37, v36, s35
    v_accvgpr_write_b32 a246, v30
    v_perm_b32 v31, v39, v38, s35
    v_accvgpr_write_b32 a247, v31
    s_waitcnt lgkmcnt(0)
    v_perm_b32 v208, v41, v40, s34
    v_perm_b32 v209, v43, v42, s34
    v_perm_b32 v210, v45, v44, s34
    v_perm_b32 v211, v47, v46, s34
    v_perm_b32 v212, v41, v40, s35
    v_perm_b32 v213, v43, v42, s35
    v_perm_b32 v214, v45, v44, s35
    v_perm_b32 v215, v47, v46, s35
    s_waitcnt vmcnt(16)
    s_barrier
    v_add_u32 v9, 65536, v11
    ds_read_b32 v32, v9 offset:0
    ds_read_b32 v33, v9 offset:256
    ds_read_b32 v34, v9 offset:512
    ds_read_b32 v35, v9 offset:768
    ds_read_b32 v36, v9 offset:1024
    ds_read_b32 v37, v9 offset:1280
    ds_read_b32 v38, v9 offset:1536
    ds_read_b32 v39, v9 offset:1792
    v_add_u32 v9, 65536, v12
    ds_read_b32 v40, v9 offset:0
    ds_read_b32 v41, v9 offset:256
    ds_read_b32 v42, v9 offset:512
    ds_read_b32 v43, v9 offset:768
    ds_read_b32 v44, v9 offset:1024
    ds_read_b32 v45, v9 offset:1280
    ds_read_b32 v46, v9 offset:1536
    ds_read_b32 v47, v9 offset:1792
    s_waitcnt lgkmcnt(8)
    v_perm_b32 v24, v33, v32, s34
    v_accvgpr_write_b32 a248, v24
    v_perm_b32 v25, v35, v34, s34
    v_accvgpr_write_b32 a249, v25
    v_perm_b32 v26, v37, v36, s34
    v_accvgpr_write_b32 a250, v26
    v_perm_b32 v27, v39, v38, s34
    v_accvgpr_write_b32 a251, v27
    v_perm_b32 v28, v33, v32, s35
    v_accvgpr_write_b32 a252, v28
    v_perm_b32 v29, v35, v34, s35
    v_accvgpr_write_b32 a253, v29
    v_perm_b32 v30, v37, v36, s35
    v_accvgpr_write_b32 a254, v30
    v_perm_b32 v31, v39, v38, s35
    v_accvgpr_write_b32 a255, v31
    s_waitcnt lgkmcnt(0)
    v_perm_b32 v216, v41, v40, s34
    v_perm_b32 v217, v43, v42, s34
    v_perm_b32 v218, v45, v44, s34
    v_perm_b32 v219, v47, v46, s34
    v_perm_b32 v220, v41, v40, s35
    v_perm_b32 v221, v43, v42, s35
    v_perm_b32 v222, v45, v44, s35
    v_perm_b32 v223, v47, v46, s35
    s_waitcnt vmcnt(12)
    s_barrier
    v_add_u32 v9, 81920, v11
    ds_read_b32 v32, v9 offset:0
    ds_read_b32 v33, v9 offset:256
    ds_read_b32 v34, v9 offset:512
    ds_read_b32 v35, v9 offset:768
    ds_read_b32 v36, v9 offset:1024
    ds_read_b32 v37, v9 offset:1280
    ds_read_b32 v38, v9 offset:1536
    ds_read_b32 v39, v9 offset:1792
    v_add_u32 v9, 81920, v12
    ds_read_b32 v40, v9 offset:0
    ds_read_b32 v41, v9 offset:256
    ds_read_b32 v42, v9 offset:512
    ds_read_b32 v43, v9 offset:768
    ds_read_b32 v44, v9 offset:1024
    ds_read_b32 v45, v9 offset:1280
    ds_read_b32 v46, v9 offset:1536
    ds_read_b32 v47, v9 offset:1792
    s_waitcnt lgkmcnt(8)
    v_perm_b32 v80, v33, v32, s34
    v_perm_b32 v81, v35, v34, s34
    v_perm_b32 v82, v37, v36, s34
    v_perm_b32 v83, v39, v38, s34
    v_perm_b32 v84, v33, v32, s35
    v_perm_b32 v85, v35, v34, s35
    v_perm_b32 v86, v37, v36, s35
    v_perm_b32 v87, v39, v38, s35
    s_waitcnt lgkmcnt(0)
    v_perm_b32 v224, v41, v40, s34
    v_perm_b32 v225, v43, v42, s34
    v_perm_b32 v226, v45, v44, s34
    v_perm_b32 v227, v47, v46, s34
    v_perm_b32 v228, v41, v40, s35
    v_perm_b32 v229, v43, v42, s35
    v_perm_b32 v230, v45, v44, s35
    v_perm_b32 v231, v47, v46, s35
    s_waitcnt vmcnt(8)
    s_barrier
    v_add_u32 v9, 98304, v11
    ds_read_b32 v32, v9 offset:0
    ds_read_b32 v33, v9 offset:256
    ds_read_b32 v34, v9 offset:512
    ds_read_b32 v35, v9 offset:768
    ds_read_b32 v36, v9 offset:1024
    ds_read_b32 v37, v9 offset:1280
    ds_read_b32 v38, v9 offset:1536
    ds_read_b32 v39, v9 offset:1792
    v_add_u32 v9, 98304, v12
    ds_read_b32 v40, v9 offset:0
    ds_read_b32 v41, v9 offset:256
    ds_read_b32 v42, v9 offset:512
    ds_read_b32 v43, v9 offset:768
    ds_read_b32 v44, v9 offset:1024
    ds_read_b32 v45, v9 offset:1280
    ds_read_b32 v46, v9 offset:1536
    ds_read_b32 v47, v9 offset:1792
    s_waitcnt lgkmcnt(8)
    v_perm_b32 v88, v33, v32, s34
    v_perm_b32 v89, v35, v34, s34
    v_perm_b32 v90, v37, v36, s34
    v_perm_b32 v91, v39, v38, s34
    v_perm_b32 v92, v33, v32, s35
    v_perm_b32 v93, v35, v34, s35
    v_perm_b32 v94, v37, v36, s35
    v_perm_b32 v95, v39, v38, s35
    s_waitcnt lgkmcnt(0)
    v_perm_b32 v232, v41, v40, s34
    v_perm_b32 v233, v43, v42, s34
    v_perm_b32 v234, v45, v44, s34
    v_perm_b32 v235, v47, v46, s34
    v_perm_b32 v236, v41, v40, s35
    v_perm_b32 v237, v43, v42, s35
    v_perm_b32 v238, v45, v44, s35
    v_perm_b32 v239, v47, v46, s35
    s_waitcnt vmcnt(4)
    s_barrier
    v_add_u32 v9, 114688, v11
    ds_read_b32 v32, v9 offset:0
    ds_read_b32 v33, v9 offset:256
    ds_read_b32 v34, v9 offset:512
    ds_read_b32 v35, v9 offset:768
    ds_read_b32 v36, v9 offset:1024
    ds_read_b32 v37, v9 offset:1280
    ds_read_b32 v38, v9 offset:1536
    ds_read_b32 v39, v9 offset:1792
    v_add_u32 v9, 114688, v12
    ds_read_b32 v40, v9 offset:0
    ds_read_b32 v41, v9 offset:256
    ds_read_b32 v42, v9 offset:512
    ds_read_b32 v43, v9 offset:768
    ds_read_b32 v44, v9 offset:1024
    ds_read_b32 v45, v9 offset:1280
    ds_read_b32 v46, v9 offset:1536
    ds_read_b32 v47, v9 offset:1792
    s_waitcnt lgkmcnt(8)
    v_perm_b32 v96, v33, v32, s34
    v_perm_b32 v97, v35, v34, s34
    v_perm_b32 v98, v37, v36, s34
    v_perm_b32 v99, v39, v38, s34
    v_perm_b32 v100, v33, v32, s35
    v_perm_b32 v101, v35, v34, s35
    v_perm_b32 v102, v37, v36, s35
    v_perm_b32 v103, v39, v38, s35
    s_waitcnt lgkmcnt(0)
    v_perm_b32 v240, v41, v40, s34
    v_perm_b32 v241, v43, v42, s34
    v_perm_b32 v242, v45, v44, s34
    v_perm_b32 v243, v47, v46, s34
    v_perm_b32 v244, v41, v40, s35
    v_perm_b32 v245, v43, v42, s35
    v_perm_b32 v246, v45, v44, s35
    v_perm_b32 v247, v47, v46, s35
    s_waitcnt vmcnt(0)
    s_barrier
    v_add_u32 v9, 131072, v11
    ds_read_b32 v32, v9 offset:0
    ds_read_b32 v33, v9 offset:256
    ds_read_b32 v34, v9 offset:512
    ds_read_b32 v35, v9 offset:768
    ds_read_b32 v36, v9 offset:1024
    ds_read_b32 v37, v9 offset:1280
    ds_read_b32 v38, v9 offset:1536
    ds_read_b32 v39, v9 offset:1792
    v_add_u32 v9, 131072, v12
    ds_read_b32 v40, v9 offset:0
    ds_read_b32 v41, v9 offset:256
    ds_read_b32 v42, v9 offset:512
    ds_read_b32 v43, v9 offset:768
    ds_read_b32 v44, v9 offset:1024
    ds_read_b32 v45, v9 offset:1280
    ds_read_b32 v46, v9 offset:1536
    ds_read_b32 v47, v9 offset:1792
    s_waitcnt lgkmcnt(8)
    v_perm_b32 v104, v33, v32, s34
    v_perm_b32 v105, v35, v34, s34
    v_perm_b32 v106, v37, v36, s34
    v_perm_b32 v107, v39, v38, s34
    v_perm_b32 v108, v33, v32, s35
    v_perm_b32 v109, v35, v34, s35
    v_perm_b32 v110, v37, v36, s35
    v_perm_b32 v111, v39, v38, s35
    s_waitcnt lgkmcnt(0)
    v_perm_b32 v248, v41, v40, s34
    v_perm_b32 v249, v43, v42, s34
    v_perm_b32 v250, v45, v44, s34
    v_perm_b32 v251, v47, v46, s34
    v_perm_b32 v252, v41, v40, s35
    v_perm_b32 v253, v43, v42, s35
    v_perm_b32 v254, v45, v44, s35
    v_perm_b32 v255, v47, v46, s35
    s_barrier
    s_mov_b32 s29, 0
    s_mul_i32 s30, s49, 36864
    s_add_u32 s30, s30, 0x500000
    s_mul_i32 s31, s49, 1179648
    s_lshl_b32 s36, s48, 10
    s_add_u32 s31, s31, s36
    s_add_u32 s31, s31, 0x7000000
    s_lshl_b32 s59, s28, 12
    s_lshl_b32 s36, s4, 10
    s_add_u32 s59, s59, s36
    s_add_u32 s59, s59, 0xb800000
    s_mul_i32 s32, s49, 4608
    s_lshl_b32 s36, s48, 7
    s_add_u32 s32, s32, s36
    s_add_u32 s32, s32, 0x201a6000
    s_mov_b32 s57, 0xe0000000
    s_lshl_b32 s42, s49, 12
    s_lshl_b32 s36, s4, 10
    s_add_u32 s42, s42, s36
    s_add_u32 s42, s42, 0x166000
    s_mov_b32 s40, 8192
    v_add_u32 v3, 8192, v3
    v_add_u32 v4, 8192, v4
    s_mov_b32 s41, 1
    v_mov_b32 v8, 81920
    v_mov_b32 v9, 0
    ds_write_b32 v8, v9
    s_waitcnt lgkmcnt(0)
    s_barrier
    s_mov_b32 s50, 0
DE_loop:
    s_cmp_eq_u32 s50, 1
    s_cbranch_scc1 DE_have
    s_cmp_eq_u32 s50, 2
    s_cbranch_scc1 DE_have2
    v_lshlrev_b32 v9, 3, v1
    s_mov_b32 exec_lo, 0xff
    s_mov_b32 exec_hi, 0x0
    buffer_load_dword v8, v9, s[8:11], s42 offen sc1
    s_mov_b64 exec, -1
    s_waitcnt vmcnt(0)
    v_mov_b32 v10, 1
    v_mov_b32 v11, 81920
    s_mov_b64 exec, 1
    ds_add_rtn_u32 v11, v11, v10
    s_waitcnt lgkmcnt(0)
    v_readfirstlane_b32 s36, v11
    s_nop 0
    s_and_b32 s36, s36, 3
    s_cmp_lg_u32 s36, 3
    s_cbranch_scc1 notlast_57
    buffer_store_dword v10, off, s[8:11], s32 sc1
notlast_57:
    s_mov_b64 exec, -1
    s_mov_b32 exec_lo, 0xff
    s_mov_b32 exec_hi, 0x0
    s_branch pollchk_56
poll_54:
    buffer_load_dword v8, v9, s[8:11], s42 offen sc1
    s_waitcnt vmcnt(0)
pollchk_56:
    v_cmp_gt_u32 vcc, s41, v8
    s_cbranch_vccz pollok_55
    s_sleep 1
    s_sub_u32 s33, s33, 1
    s_cmp_gt_i32 s33, 0
    s_cbranch_scc1 poll_54
pollok_55:
    s_mov_b64 exec, -1
    s_lshl_b32 s36, s4, 10
    s_add_u32 m0, s36, s40
    s_nop 0
    buffer_load_dwordx4 v2, s[8:11], s30 offen offset:0 sc1 lds
    s_add_u32 m0, m0, 3968
    s_nop 0
    buffer_load_dwordx4 v2, s[8:11], s30 offen offset:128 sc1 lds
    s_add_u32 m0, m0, 3968
    s_nop 0
    buffer_load_dwordx4 v2, s[8:11], s30 offen offset:256 sc1 lds
    s_add_u32 m0, m0, 3968
    s_nop 0
    buffer_load_dwordx4 v2, s[8:11], s30 offen offset:384 sc1 lds
    s_add_u32 m0, m0, 3968
    s_nop 0
    buffer_load_dwordx4 v2, s[8:11], s30 offen offset:512 sc1 lds
    s_add_u32 m0, m0, 3968
    s_nop 0
    buffer_load_dwordx4 v2, s[8:11], s30 offen offset:640 sc1 lds
    s_add_u32 m0, m0, 3968
    s_nop 0
    buffer_load_dwordx4 v2, s[8:11], s30 offen offset:768 sc1 lds
    s_add_u32 m0, m0, 3968
    s_nop 0
    buffer_load_dwordx4 v2, s[8:11], s30 offen offset:896 sc1 lds
    s_add_u32 m0, m0, 3968
    s_nop 0
    buffer_load_dwordx4 v2, s[8:11], s30 offen offset:1024 sc1 lds
    s_waitcnt vmcnt(0)
    s_branch DE_have
DE_have2:
    s_waitcnt vmcnt(9)
    v_mov_b32 v10, 1
    v_mov_b32 v11, 81920
    s_mov_b64 exec, 1
    ds_add_rtn_u32 v11, v11, v10
    s_waitcnt lgkmcnt(0)
    v_readfirstlane_b32 s36, v11
    s_nop 0
    s_and_b32 s36, s36, 3
    s_cmp_lg_u32 s36, 3
    s_cbranch_scc1 notlast_58
    buffer_store_dword v10, off, s[8:11], s32 sc1
notlast_58:
    s_mov_b64 exec, -1
    s_waitcnt vmcnt(1)
    s_cmp_lg_u32 s36, 3
    s_cbranch_scc0 DE_have
    s_waitcnt vmcnt(0)
DE_have:
    s_waitcnt vmcnt(10)
    s_barrier
    s_add_u32 s42, s42, 8192
    s_add_u32 s30, s30, 73728
    ds_read_b128 v[8:11], v3 offset:0
    ds_read_b128 v[12:15], v3 offset:2048
    ds_read_b128 v[16:19], v4 offset:0
    ds_read_b128 v[20:23], v4 offset:2048
    s_waitcnt lgkmcnt(2)
    v_mfma_f32_16x16x32_bf16 v[24:27], a[144:147], v[8:11], 0
    v_mfma_f32_16x16x32_bf16 v[28:31], a[148:151], v[8:11], 0
    v_mfma_f32_16x16x32_bf16 v[32:35], v[112:115], v[8:11], 0
    v_mfma_f32_16x16x32_bf16 v[36:39], v[116:119], v[8:11], 0
    v_mfma_f32_16x16x32_bf16 v[40:43], a[144:147], v[12:15], 0
    v_mfma_f32_16x16x32_bf16 v[44:47], a[148:151], v[12:15], 0
    v_mfma_f32_16x16x32_bf16 v[48:51], v[112:115], v[12:15], 0
    v_mfma_f32_16x16x32_bf16 v[52:55], v[116:119], v[12:15], 0
    ds_read_b128 v[8:11], v3 offset:4096
    ds_read_b128 v[12:15], v3 offset:6144
    s_waitcnt lgkmcnt(2)
    v_mfma_f32_16x16x32_bf16 v[24:27], a[152:155], v[16:19], v[24:27]
    v_mfma_f32_16x16x32_bf16 v[28:31], a[156:159], v[16:19], v[28:31]
    v_mfma_f32_16x16x32_bf16 v[32:35], v[120:123], v[16:19], v[32:35]
    v_mfma_f32_16x16x32_bf16 v[36:39], v[124:127], v[16:19], v[36:39]
    v_mfma_f32_16x16x32_bf16 v[40:43], a[152:155], v[20:23], v[40:43]
    v_mfma_f32_16x16x32_bf16 v[44:47], a[156:159], v[20:23], v[44:47]
    v_mfma_f32_16x16x32_bf16 v[48:51], v[120:123], v[20:23], v[48:51]
    v_mfma_f32_16x16x32_bf16 v[52:55], v[124:127], v[20:23], v[52:55]
    ds_read_b128 v[16:19], v4 offset:4096
    ds_read_b128 v[20:23], v4 offset:6144
    s_waitcnt lgkmcnt(2)
    v_mfma_f32_16x16x32_bf16 v[24:27], a[160:163], v[8:11], v[24:27]
    v_mfma_f32_16x16x32_bf16 v[28:31], a[164:167], v[8:11], v[28:31]
    v_mfma_f32_16x16x32_bf16 v[32:35], v[128:131], v[8:11], v[32:35]
    v_mfma_f32_16x16x32_bf16 v[36:39], v[132:135], v[8:11], v[36:39]
    v_mfma_f32_16x16x32_bf16 v[40:43], a[160:163], v[12:15], v[40:43]
    v_mfma_f32_16x16x32_bf16 v[44:47], a[164:167], v[12:15], v[44:47]
    v_mfma_f32_16x16x32_bf16 v[48:51], v[128:131], v[12:15], v[48:51]
    v_mfma_f32_16x16x32_bf16 v[52:55], v[132:135], v[12:15], v[52:55]
    ds_read_b128 v[8:11], v3 offset:8192
    ds_read_b128 v[12:15], v3 offset:10240
    s_waitcnt lgkmcnt(2)
    v_mfma_f32_16x16x32_bf16 v[24:27], a[168:171], v[16:19], v[24:27]
    v_mfma_f32_16x16x32_bf16 v[28:31], a[172:175], v[16:19], v[28:31]
    v_mfma_f32_16x16x32_bf16 v[32:35], v[136:139], v[16:19], v[32:35]
    v_mfma_f32_16x16x32_bf16 v[36:39], v[140:143], v[16:19], v[36:39]
    v_mfma_f32_16x16x32_bf16 v[40:43], a[168:171], v[20:23], v[40:43]
    v_mfma_f32_16x16x32_bf16 v[44:47], a[172:175], v[20:23], v[44:47]
    v_mfma_f32_16x16x32_bf16 v[48:51], v[136:139], v[20:23], v[48:51]
    v_mfma_f32_16x16x32_bf16 v[52:55], v[140:143], v[20:23], v[52:55]
    ds_read_b128 v[16:19], v4 offset:8192
    ds_read_b128 v[20:23], v4 offset:10240
    s_waitcnt lgkmcnt(2)
    v_mfma_f32_16x16x32_bf16 v[24:27], a[176:179], v[8:11], v[24:27]
    v_mfma_f32_16x16x32_bf16 v[28:31], a[180:183], v[8:11], v[28:31]
    v_mfma_f32_16x16x32_bf16 v[32:35], v[144:147], v[8:11], v[32:35]
    v_mfma_f32_16x16x32_bf16 v[36:39], v[148:151], v[8:11], v[36:39]
    v_mfma_f32_16x16x32_bf16 v[40:43], a[176:179], v[12:15], v[40:43]
    v_mfma_f32_16x16x32_bf16 v[44:47], a[180:183], v[12:15], v[44:47]
    v_mfma_f32_16x16x32_bf16 v[48:51], v[144:147], v[12:15], v[48:51]
    v_mfma_f32_16x16x32_bf16 v[52:55], v[148:151], v[12:15], v[52:55]
    ds_read_b128 v[8:11], v3 offset:12288
    ds_read_b128 v[12:15], v3 offset:14336
    s_waitcnt lgkmcnt(2)
    v_mfma_f32_16x16x32_bf16 v[24:27], a[184:187], v[16:19], v[24:27]
    v_mfma_f32_16x16x32_bf16 v[28:31], a[188:191], v[16:19], v[28:31]
    v_mfma_f32_16x16x32_bf16 v[32:35], v[152:155], v[16:19], v[32:35]
    v_mfma_f32_16x16x32_bf16 v[36:39], v[156:159], v[16:19], v[36:39]
    v_mfma_f32_16x16x32_bf16 v[40:43], a[184:187], v[20:23], v[40:43]
    v_mfma_f32_16x16x32_bf16 v[44:47], a[188:191], v[20:23], v[44:47]
    v_mfma_f32_16x16x32_bf16 v[48:51], v[152:155], v[20:23], v[48:51]
    v_mfma_f32_16x16x32_bf16 v[52:55], v[156:159], v[20:23], v[52:55]
    ds_read_b128 v[16:19], v4 offset:12288
    ds_read_b128 v[20:23], v4 offset:14336
    s_waitcnt vmcnt(0)
    s_cmp_lg_u32 s50, 1
    s_cbranch_scc1 DE_signalled
    v_mov_b32 v73, 1
    v_mov_b32 v74, 81920
    s_mov_b64 exec, 1
    ds_add_rtn_u32 v74, v74, v73
    s_waitcnt lgkmcnt(0)
    v_readfirstlane_b32 s36, v74
    s_nop 0
    s_and_b32 s36, s36, 3
    s_cmp_lg_u32 s36, 3
    s_cbranch_scc1 notlast_59
    buffer_store_dword v73, off, s[8:11], s32 sc1
notlast_59:
    s_mov_b64 exec, -1
DE_signalled:
    s_waitcnt lgkmcnt(2)
    v_mfma_f32_16x16x32_bf16 v[24:27], a[192:195], v[8:11], v[24:27]
    v_mfma_f32_16x16x32_bf16 v[28:31], a[196:199], v[8:11], v[28:31]
    v_mfma_f32_16x16x32_bf16 v[32:35], v[160:163], v[8:11], v[32:35]
    v_mfma_f32_16x16x32_bf16 v[36:39], v[164:167], v[8:11], v[36:39]
    v_mfma_f32_16x16x32_bf16 v[40:43], a[192:195], v[12:15], v[40:43]
    v_mfma_f32_16x16x32_bf16 v[44:47], a[196:199], v[12:15], v[44:47]
    v_mfma_f32_16x16x32_bf16 v[48:51], v[160:163], v[12:15], v[48:51]
    v_mfma_f32_16x16x32_bf16 v[52:55], v[164:167], v[12:15], v[52:55]
    ds_read_b128 v[8:11], v3 offset:16384
    ds_read_b128 v[12:15], v3 offset:18432
    s_waitcnt lgkmcnt(2)
    v_mfma_f32_16x16x32_bf16 v[24:27], a[200:203], v[16:19], v[24:27]
    v_mfma_f32_16x16x32_bf16 v[28:31], a[204:207], v[16:19], v[28:31]
    v_mfma_f32_16x16x32_bf16 v[32:35], v[168:171], v[16:19], v[32:35]
    v_mfma_f32_16x16x32_bf16 v[36:39], v[172:175], v[16:19], v[36:39]
    v_mfma_f32_16x16x32_bf16 v[40:43], a[200:203], v[20:23], v[40:43]
    v_mfma_f32_16x16x32_bf16 v[44:47], a[204:207], v[20:23], v[44:47]
    v_mfma_f32_16x16x32_bf16 v[48:51], v[168:171], v[20:23], v[48:51]
    v_mfma_f32_16x16x32_bf16 v[52:55], v[172:175], v[20:23], v[52:55]
    ds_read_b128 v[16:19], v4 offset:16384
    ds_read_b128 v[20:23], v4 offset:18432
    s_waitcnt lgkmcnt(2)
    v_mfma_f32_16x16x32_bf16 v[24:27], a[208:211], v[8:11], v[24:27]
    v_mfma_f32_16x16x32_bf16 v[28:31], a[212:215], v[8:11], v[28:31]
    v_mfma_f32_16x16x32_bf16 v[32:35], v[176:179], v[8:11], v[32:35]
    v_mfma_f32_16x16x32_bf16 v[36:39], v[180:183], v[8:11], v[36:39]
    v_mfma_f32_16x16x32_bf16 v[40:43], a[208:211], v[12:15], v[40:43]
    v_mfma_f32_16x16x32_bf16 v[44:47], a[212:215], v[12:15], v[44:47]
    v_mfma_f32_16x16x32_bf16 v[48:51], v[176:179], v[12:15], v[48:51]
    v_mfma_f32_16x16x32_bf16 v[52:55], v[180:183], v[12:15], v[52:55]
    ds_read_b128 v[8:11], v3 offset:20480
    ds_read_b128 v[12:15], v3 offset:22528
    s_waitcnt lgkmcnt(2)
    v_mfma_f32_16x16x32_bf16 v[24:27], a[216:219], v[16:19], v[24:27]
    v_mfma_f32_16x16x32_bf16 v[28:31], a[220:223], v[16:19], v[28:31]
    v_mfma_f32_16x16x32_bf16 v[32:35], v[184:187], v[16:19], v[32:35]
    v_mfma_f32_16x16x32_bf16 v[36:39], v[188:191], v[16:19], v[36:39]
    v_mfma_f32_16x16x32_bf16 v[40:43], a[216:219], v[20:23], v[40:43]
    v_mfma_f32_16x16x32_bf16 v[44:47], a[220:223], v[20:23], v[44:47]
    v_mfma_f32_16x16x32_bf16 v[48:51], v[184:187], v[20:23], v[48:51]
    v_mfma_f32_16x16x32_bf16 v[52:55], v[188:191], v[20:23], v[52:55]
    ds_read_b128 v[16:19], v4 offset:20480
    ds_read_b128 v[20:23], v4 offset:22528
    s_waitcnt lgkmcnt(2)
    v_mfma_f32_16x16x32_bf16 v[24:27], a[224:227], v[8:11], v[24:27]
    v_mfma_f32_16x16x32_bf16 v[28:31], a[228:231], v[8:11], v[28:31]
    v_mfma_f32_16x16x32_bf16 v[32:35], v[192:195], v[8:11], v[32:35]
    v_mfma_f32_16x16x32_bf16 v[36:39], v[196:199], v[8:11], v[36:39]
    v_mfma_f32_16x16x32_bf16 v[40:43], a[224:227], v[12:15], v[40:43]
    v_mfma_f32_16x16x32_bf16 v[44:47], a[228:231], v[12:15], v[44:47]
    v_mfma_f32_16x16x32_bf16 v[48:51], v[192:195], v[12:15], v[48:51]
    v_mfma_f32_16x16x32_bf16 v[52:55], v[196:199], v[12:15], v[52:55]
    ds_read_b128 v[8:11], v3 offset:24576
    ds_read_b128 v[12:15], v3 offset:26624
    s_waitcnt lgkmcnt(2)
    v_mfma_f32_16x16x32_bf16 v[24:27], a[232:235], v[16:19], v[24:27]
    v_mfma_f32_16x16x32_bf16 v[28:31], a[236:239], v[16:19], v[28:31]
    v_mfma_f32_16x16x32_bf16 v[32:35], v[200:203], v[16:19], v[32:35]
    v_mfma_f32_16x16x32_bf16 v[36:39], v[204:207], v[16:19], v[36:39]
    v_mfma_f32_16x16x32_bf16 v[40:43], a[232:235], v[20:23], v[40:43]
    v_mfma_f32_16x16x32_bf16 v[44:47], a[236:239], v[20:23], v[44:47]
    v_mfma_f32_16x16x32_bf16 v[48:51], v[200:203], v[20:23], v[48:51]
    v_mfma_f32_16x16x32_bf16 v[52:55], v[204:207], v[20:23], v[52:55]
    ds_read_b128 v[16:19], v4 offset:24576
    ds_read_b128 v[20:23], v4 offset:26624
    s_cmp_lt_u32 s29, 31
    s_cselect_b32 s51, s42, 0x20000000
    v_lshlrev_b32 v73, 3, v1
    v_and_b32 v73, 0x380, v73
    buffer_load_dword v72, v73, s[8:11], s51 offen sc1
    s_xor_b32 s40, s40, 36864
    s_waitcnt lgkmcnt(2)
    v_mfma_f32_16x16x32_bf16 v[24:27], a[240:243], v[8:11], v[24:27]
    v_mfma_f32_16x16x32_bf16 v[28:31], a[244:247], v[8:11], v[28:31]
    v_mfma_f32_16x16x32_bf16 v[32:35], v[208:211], v[8:11], v[32:35]
    v_mfma_f32_16x16x32_bf16 v[36:39], v[212:215], v[8:11], v[36:39]
    v_mfma_f32_16x16x32_bf16 v[40:43], a[240:243], v[12:15], v[40:43]
    v_mfma_f32_16x16x32_bf16 v[44:47], a[244:247], v[12:15], v[44:47]
    v_mfma_f32_16x16x32_bf16 v[48:51], v[208:211], v[12:15], v[48:51]
    v_mfma_f32_16x16x32_bf16 v[52:55], v[212:215], v[12:15], v[52:55]
    ds_read_b128 v[8:11], v3 offset:28672
    ds_read_b128 v[12:15], v3 offset:30720
    s_waitcnt lgkmcnt(2)
    v_mfma_f32_16x16x32_bf16 v[24:27], a[248:251], v[16:19], v[24:27]
    v_mfma_f32_16x16x32_bf16 v[28:31], a[252:255], v[16:19], v[28:31]
    v_mfma_f32_16x16x32_bf16 v[32:35], v[216:219], v[16:19], v[32:35]
    v_mfma_f32_16x16x32_bf16 v[36:39], v[220:223], v[16:19], v[36:39]
    v_mfma_f32_16x16x32_bf16 v[40:43], a[248:251], v[20:23], v[40:43]
    v_mfma_f32_16x16x32_bf16 v[44:47], a[252:255], v[20:23], v[44:47]
    v_mfma_f32_16x16x32_bf16 v[48:51], v[216:219], v[20:23], v[48:51]
    v_mfma_f32_16x16x32_bf16 v[52:55], v[220:223], v[20:23], v[52:55]
    ds_read_b128 v[16:19], v4 offset:28672
    ds_read_b128 v[20:23], v4 offset:30720
    s_waitcnt lgkmcnt(2)
    v_mfma_f32_16x16x32_bf16 v[24:27], v[80:83], v[8:11], v[24:27]
    v_mfma_f32_16x16x32_bf16 v[28:31], v[84:87], v[8:11], v[28:31]
    v_mfma_f32_16x16x32_bf16 v[32:35], v[224:227], v[8:11], v[32:35]
    v_mfma_f32_16x16x32_bf16 v[36:39], v[228:231], v[8:11], v[36:39]
    v_mfma_f32_16x16x32_bf16 v[40:43], v[80:83], v[12:15], v[40:43]
    v_mfma_f32_16x16x32_bf16 v[44:47], v[84:87], v[12:15], v[44:47]
    v_mfma_f32_16x16x32_bf16 v[48:51], v[224:227], v[12:15], v[48:51]
    v_mfma_f32_16x16x32_bf16 v[52:55], v[228:231], v[12:15], v[52:55]
    ds_read_b128 v[8:11], v3 offset:32768
    ds_read_b128 v[12:15], v3 offset:34816
    s_waitcnt lgkmcnt(2)
    v_mfma_f32_16x16x32_bf16 v[24:27], v[88:91], v[16:19], v[24:27]
    v_mfma_f32_16x16x32_bf16 v[28:31], v[92:95], v[16:19], v[28:31]
    v_mfma_f32_16x16x32_bf16 v[32:35], v[232:235], v[16:19], v[32:35]
    v_mfma_f32_16x16x32_bf16 v[36:39], v[236:239], v[16:19], v[36:39]
    v_mfma_f32_16x16x32_bf16 v[40:43], v[88:91], v[20:23], v[40:43]
    v_mfma_f32_16x16x32_bf16 v[44:47], v[92:95], v[20:23], v[44:47]
    v_mfma_f32_16x16x32_bf16 v[48:51], v[232:235], v[20:23], v[48:51]
    v_mfma_f32_16x16x32_bf16 v[52:55], v[236:239], v[20:23], v[52:55]
    ds_read_b128 v[16:19], v4 offset:32768
    ds_read_b128 v[20:23], v4 offset:34816
    s_waitcnt lgkmcnt(2)
    v_mfma_f32_16x16x32_bf16 v[24:27], v[96:99], v[8:11], v[24:27]
    v_mfma_f32_16x16x32_bf16 v[28:31], v[100:103], v[8:11], v[28:31]
    v_mfma_f32_16x16x32_bf16 v[32:35], v[240:243], v[8:11], v[32:35]
    v_mfma_f32_16x16x32_bf16 v[36:39], v[244:247], v[8:11], v[36:39]
    v_mfma_f32_16x16x32_bf16 v[40:43], v[96:99], v[12:15], v[40:43]
    v_mfma_f32_16x16x32_bf16 v[44:47], v[100:103], v[12:15], v[44:47]
    v_mfma_f32_16x16x32_bf16 v[48:51], v[240:243], v[12:15], v[48:51]
    v_mfma_f32_16x16x32_bf16 v[52:55], v[244:247], v[12:15], v[52:55]
    s_waitcnt lgkmcnt(0)
    v_mfma_f32_16x16x32_bf16 v[24:27], v[104:107], v[16:19], v[24:27]
    v_mfma_f32_16x16x32_bf16 v[28:31], v[108:111], v[16:19], v[28:31]
    v_mfma_f32_16x16x32_bf16 v[32:35], v[248:251], v[16:19], v[32:35]
    v_mfma_f32_16x16x32_bf16 v[36:39], v[252:255], v[16:19], v[36:39]
    v_mfma_f32_16x16x32_bf16 v[40:43], v[104:107], v[20:23], v[40:43]
    v_mfma_f32_16x16x32_bf16 v[44:47], v[108:111], v[20:23], v[44:47]
    v_mfma_f32_16x16x32_bf16 v[48:51], v[248:251], v[20:23], v[48:51]
    v_mfma_f32_16x16x32_bf16 v[52:55], v[252:255], v[20:23], v[52:55]
    s_lshl_b32 s36, s40, 1
    s_sub_u32 s36, s36, 53248
    v_add_u32 v3, s36, v3
    v_add_u32 v4, s36, v4
    v_cvt_pk_bf16_f32 v56, v24, v28
    v_lshlrev_b32 v24, 16, v56
    v_and_b32 v28, s45, v56
    v_cvt_pk_bf16_f32 v60, v32, v36
    v_lshlrev_b32 v32, 16, v60
    v_and_b32 v36, s45, v60
    v_cvt_pk_bf16_f32 v57, v25, v29
    v_lshlrev_b32 v25, 16, v57
    v_and_b32 v29, s45, v57
    v_cvt_pk_bf16_f32 v61, v33, v37
    v_lshlrev_b32 v33, 16, v61
    v_and_b32 v37, s45, v61
    v_cvt_pk_bf16_f32 v58, v26, v30
    v_lshlrev_b32 v26, 16, v58
    v_and_b32 v30, s45, v58
    v_cvt_pk_bf16_f32 v62, v34, v38
    v_lshlrev_b32 v34, 16, v62
    v_and_b32 v38, s45, v62
    v_cvt_pk_bf16_f32 v59, v27, v31
    v_lshlrev_b32 v27, 16, v59
    v_and_b32 v31, s45, v59
    v_cvt_pk_bf16_f32 v63, v35, v39
    v_lshlrev_b32 v35, 16, v63
    v_and_b32 v39, s45, v63
    v_mul_f32 v24, v24, v32
    v_mul_f32 v28, v28, v36
    v_mul_f32 v25, v25, v33
    v_mul_f32 v29, v29, v37
    v_mul_f32 v26, v26, v34
    v_mul_f32 v30, v30, v38
    v_mul_f32 v27, v27, v35
    v_mul_f32 v31, v31, v39
    v_cvt_pk_bf16_f32 v64, v24, v28
    v_cvt_pk_bf16_f32 v65, v25, v29
    v_cvt_pk_bf16_f32 v66, v26, v30
    v_cvt_pk_bf16_f32 v67, v27, v31
    ds_write_b128 v7, v[64:67] offset:0
    v_cvt_pk_bf16_f32 v56, v40, v44
    v_lshlrev_b32 v40, 16, v56
    v_and_b32 v44, s45, v56
    v_cvt_pk_bf16_f32 v60, v48, v52
    v_lshlrev_b32 v48, 16, v60
    v_and_b32 v52, s45, v60
    v_cvt_pk_bf16_f32 v57, v41, v45
    v_lshlrev_b32 v41, 16, v57
    v_and_b32 v45, s45, v57
    v_cvt_pk_bf16_f32 v61, v49, v53
    v_lshlrev_b32 v49, 16, v61
    v_and_b32 v53, s45, v61
    v_cvt_pk_bf16_f32 v58, v42, v46
    v_lshlrev_b32 v42, 16, v58
    v_and_b32 v46, s45, v58
    v_cvt_pk_bf16_f32 v62, v50, v54
    v_lshlrev_b32 v50, 16, v62
    v_and_b32 v54, s45, v62
    v_cvt_pk_bf16_f32 v59, v43, v47
    v_lshlrev_b32 v43, 16, v59
    v_and_b32 v47, s45, v59
    v_cvt_pk_bf16_f32 v63, v51, v55
    v_lshlrev_b32 v51, 16, v63
    v_and_b32 v55, s45, v63
    v_mul_f32 v40, v40, v48
    v_mul_f32 v44, v44, v52
    v_mul_f32 v41, v41, v49
    v_mul_f32 v45, v45, v53
    v_mul_f32 v42, v42, v50
    v_mul_f32 v46, v46, v54
    v_mul_f32 v43, v43, v51
    v_mul_f32 v47, v47, v55
    v_cvt_pk_bf16_f32 v68, v40, v44
    v_cvt_pk_bf16_f32 v69, v41, v45
    v_cvt_pk_bf16_f32 v70, v42, v46
    v_cvt_pk_bf16_f32 v71, v43, v47
    ds_write_b128 v7, v[68:71] offset:1024
    s_waitcnt vmcnt(0)
    s_mov_b32 s50, 0
    v_cmp_gt_u32 vcc, s41, v72
    s_cbranch_vccnz DE_nopf
    s_mov_b32 s50, 1
    s_lshl_b32 s36, s4, 10
    s_add_u32 m0, s36, s40
    s_nop 0
    buffer_load_dwordx4 v2, s[8:11], s30 offen offset:0 sc1 lds
    s_add_u32 m0, m0, 3968
    s_nop 0
    buffer_load_dwordx4 v2, s[8:11], s30 offen offset:128 sc1 lds
    s_add_u32 m0, m0, 3968
    s_nop 0
    buffer_load_dwordx4 v2, s[8:11], s30 offen offset:256 sc1 lds
    s_add_u32 m0, m0, 3968
    s_nop 0
    buffer_load_dwordx4 v2, s[8:11], s30 offen offset:384 sc1 lds
    s_add_u32 m0, m0, 3968
    s_nop 0
    buffer_load_dwordx4 v2, s[8:11], s30 offen offset:512 sc1 lds
    s_add_u32 m0, m0, 3968
    s_nop 0
    buffer_load_dwordx4 v2, s[8:11], s30 offen offset:640 sc1 lds
    s_add_u32 m0, m0, 3968
    s_nop 0
    buffer_load_dwordx4 v2, s[8:11], s30 offen offset:768 sc1 lds
    s_add_u32 m0, m0, 3968
    s_nop 0
    buffer_load_dwordx4 v2, s[8:11], s30 offen offset:896 sc1 lds
    s_add_u32 m0, m0, 3968
    s_nop 0
    buffer_load_dwordx4 v2, s[8:11], s30 offen offset:1024 sc1 lds
DE_nopf:
    s_waitcnt lgkmcnt(0)
    s_barrier
    ds_read_b128 v[8:11], v1 offset:0
    ds_read_b128 v[12:15], v1 offset:2048
    ds_read_b128 v[16:19], v1 offset:4096
    ds_read_b128 v[20:23], v1 offset:6144
    s_waitcnt lgkmcnt(3)
    v_mfma_f32_16x16x32_bf16 v[24:27], v[8:11], a[0:3], 0
    v_mfma_f32_16x16x32_bf16 v[28:31], v[8:11], a[4:7], 0
    v_mfma_f32_16x16x32_bf16 v[32:35], v[8:11], a[8:11], 0
    v_mfma_f32_16x16x32_bf16 v[36:39], v[8:11], a[12:15], 0
    v_mfma_f32_16x16x32_bf16 v[40:43], v[8:11], a[16:19], 0
    v_mfma_f32_16x16x32_bf16 v[44:47], v[8:11], a[20:23], 0
    v_mfma_f32_16x16x32_bf16 v[48:51], v[8:11], a[24:27], 0
    v_mfma_f32_16x16x32_bf16 v[52:55], v[8:11], a[28:31], 0
    v_mfma_f32_16x16x32_bf16 v[56:59], a[32:35], v[8:11], 0
    s_waitcnt lgkmcnt(2)
    v_mfma_f32_16x16x32_bf16 v[24:27], v[12:15], a[36:39], v[24:27]
    v_mfma_f32_16x16x32_bf16 v[28:31], v[12:15], a[40:43], v[28:31]
    v_mfma_f32_16x16x32_bf16 v[32:35], v[12:15], a[44:47], v[32:35]
    v_mfma_f32_16x16x32_bf16 v[36:39], v[12:15], a[48:51], v[36:39]
    v_mfma_f32_16x16x32_bf16 v[40:43], v[12:15], a[52:55], v[40:43]
    v_mfma_f32_16x16x32_bf16 v[44:47], v[12:15], a[56:59], v[44:47]
    v_mfma_f32_16x16x32_bf16 v[48:51], v[12:15], a[60:63], v[48:51]
    v_mfma_f32_16x16x32_bf16 v[52:55], v[12:15], a[64:67], v[52:55]
    v_mfma_f32_16x16x32_bf16 v[56:59], a[68:71], v[12:15], v[56:59]
    s_waitcnt lgkmcnt(1)
    v_mfma_f32_16x16x32_bf16 v[24:27], v[16:19], a[72:75], v[24:27]
    v_mfma_f32_16x16x32_bf16 v[28:31], v[16:19], a[76:79], v[28:31]
    v_mfma_f32_16x16x32_bf16 v[32:35], v[16:19], a[80:83], v[32:35]
    v_mfma_f32_16x16x32_bf16 v[36:39], v[16:19], a[84:87], v[36:39]
    v_mfma_f32_16x16x32_bf16 v[40:43], v[16:19], a[88:91], v[40:43]
    v_mfma_f32_16x16x32_bf16 v[44:47], v[16:19], a[92:95], v[44:47]
    v_mfma_f32_16x16x32_bf16 v[48:51], v[16:19], a[96:99], v[48:51]
    v_mfma_f32_16x16x32_bf16 v[52:55], v[16:19], a[100:103], v[52:55]
    v_mfma_f32_16x16x32_bf16 v[56:59], a[104:107], v[16:19], v[56:59]
    s_waitcnt lgkmcnt(0)
    v_mfma_f32_16x16x32_bf16 v[24:27], v[20:23], a[108:111], v[24:27]
    v_mfma_f32_16x16x32_bf16 v[28:31], v[20:23], a[112:115], v[28:31]
    v_mfma_f32_16x16x32_bf16 v[32:35], v[20:23], a[116:119], v[32:35]
    v_mfma_f32_16x16x32_bf16 v[36:39], v[20:23], a[120:123], v[36:39]
    v_mfma_f32_16x16x32_bf16 v[40:43], v[20:23], a[124:127], v[40:43]
    v_mfma_f32_16x16x32_bf16 v[44:47], v[20:23], a[128:131], v[44:47]
    v_mfma_f32_16x16x32_bf16 v[48:51], v[20:23], a[132:135], v[48:51]
    v_mfma_f32_16x16x32_bf16 v[52:55], v[20:23], a[136:139], v[52:55]
    v_mfma_f32_16x16x32_bf16 v[56:59], a[140:143], v[20:23], v[56:59]
    s_nop 0
    v_cvt_pk_bf16_f32 v60, v24, v28
    s_nop 0
    v_cvt_pk_bf16_f32 v61, v32, v36
    s_nop 0
    v_cvt_pk_bf16_f32 v62, v40, v44
    s_nop 0
    v_cvt_pk_bf16_f32 v63, v48, v52
    s_add_u32 s36, s31, 0
    buffer_store_dwordx4 v[60:63], v5, s[8:11], s36 offen sc1
    v_cvt_pk_bf16_f32 v64, v25, v29
    v_cvt_pk_bf16_f32 v65, v33, v37
    v_cvt_pk_bf16_f32 v66, v41, v45
    v_cvt_pk_bf16_f32 v67, v49, v53
    s_add_u32 s36, s31, 36864
    buffer_store_dwordx4 v[64:67], v5, s[8:11], s36 offen sc1
    v_cvt_pk_bf16_f32 v60, v26, v30
    v_cvt_pk_bf16_f32 v61, v34, v38
    v_cvt_pk_bf16_f32 v62, v42, v46
    v_cvt_pk_bf16_f32 v63, v50, v54
    s_add_u32 s36, s31, 73728
    buffer_store_dwordx4 v[60:63], v5, s[8:11], s36 offen sc1
    v_cvt_pk_bf16_f32 v64, v27, v31
    v_cvt_pk_bf16_f32 v65, v35, v39
    v_cvt_pk_bf16_f32 v66, v43, v47
    v_cvt_pk_bf16_f32 v67, v51, v55
    s_add_u32 s36, s31, 110592
    buffer_store_dwordx4 v[64:67], v5, s[8:11], s36 offen sc1
    v_cvt_pk_bf16_f32 v68, v56, v57
    v_cvt_pk_bf16_f32 v69, v58, v59
    ds_read_b128 v[8:11], v1 offset:1024
    ds_read_b128 v[12:15], v1 offset:3072
    ds_read_b128 v[16:19], v1 offset:5120
    ds_read_b128 v[20:23], v1 offset:7168
    buffer_load_dword v72, v73, s[8:11], s51 offen sc1
    s_waitcnt lgkmcnt(3)
    v_mfma_f32_16x16x32_bf16 v[24:27], v[8:11], a[0:3], 0
    v_mfma_f32_16x16x32_bf16 v[28:31], v[8:11], a[4:7], 0
    v_mfma_f32_16x16x32_bf16 v[32:35], v[8:11], a[8:11], 0
    v_mfma_f32_16x16x32_bf16 v[36:39], v[8:11], a[12:15], 0
    v_mfma_f32_16x16x32_bf16 v[40:43], v[8:11], a[16:19], 0
    v_mfma_f32_16x16x32_bf16 v[44:47], v[8:11], a[20:23], 0
    v_mfma_f32_16x16x32_bf16 v[48:51], v[8:11], a[24:27], 0
    v_mfma_f32_16x16x32_bf16 v[52:55], v[8:11], a[28:31], 0
    v_mfma_f32_16x16x32_bf16 v[56:59], a[32:35], v[8:11], 0
    s_waitcnt lgkmcnt(2)
    v_mfma_f32_16x16x32_bf16 v[24:27], v[12:15], a[36:39], v[24:27]
    v_mfma_f32_16x16x32_bf16 v[28:31], v[12:15], a[40:43], v[28:31]
    v_mfma_f32_16x16x32_bf16 v[32:35], v[12:15], a[44:47], v[32:35]
    v_mfma_f32_16x16x32_bf16 v[36:39], v[12:15], a[48:51], v[36:39]
    v_mfma_f32_16x16x32_bf16 v[40:43], v[12:15], a[52:55], v[40:43]
    v_mfma_f32_16x16x32_bf16 v[44:47], v[12:15], a[56:59], v[44:47]
    v_mfma_f32_16x16x32_bf16 v[48:51], v[12:15], a[60:63], v[48:51]
    v_mfma_f32_16x16x32_bf16 v[52:55], v[12:15], a[64:67], v[52:55]
    v_mfma_f32_16x16x32_bf16 v[56:59], a[68:71], v[12:15], v[56:59]
    s_waitcnt lgkmcnt(1)
    v_mfma_f32_16x16x32_bf16 v[24:27], v[16:19], a[72:75], v[24:27]
    v_mfma_f32_16x16x32_bf16 v[28:31], v[16:19], a[76:79], v[28:31]
    v_mfma_f32_16x16x32_bf16 v[32:35], v[16:19], a[80:83], v[32:35]
    v_mfma_f32_16x16x32_bf16 v[36:39], v[16:19], a[84:87], v[36:39]
    v_mfma_f32_16x16x32_bf16 v[40:43], v[16:19], a[88:91], v[40:43]
    v_mfma_f32_16x16x32_bf16 v[44:47], v[16:19], a[92:95], v[44:47]
    v_mfma_f32_16x16x32_bf16 v[48:51], v[16:19], a[96:99], v[48:51]
    v_mfma_f32_16x16x32_bf16 v[52:55], v[16:19], a[100:103], v[52:55]
    v_mfma_f32_16x16x32_bf16 v[56:59], a[104:107], v[16:19], v[56:59]
    s_waitcnt lgkmcnt(0)
    v_mfma_f32_16x16x32_bf16 v[24:27], v[20:23], a[108:111], v[24:27]
    v_mfma_f32_16x16x32_bf16 v[28:31], v[20:23], a[112:115], v[28:31]
    v_mfma_f32_16x16x32_bf16 v[32:35], v[20:23], a[116:119], v[32:35]
    v_mfma_f32_16x16x32_bf16 v[36:39], v[20:23], a[120:123], v[36:39]
    v_mfma_f32_16x16x32_bf16 v[40:43], v[20:23], a[124:127], v[40:43]
    v_mfma_f32_16x16x32_bf16 v[44:47], v[20:23], a[128:131], v[44:47]
    v_mfma_f32_16x16x32_bf16 v[48:51], v[20:23], a[132:135], v[48:51]
    v_mfma_f32_16x16x32_bf16 v[52:55], v[20:23], a[136:139], v[52:55]
    v_mfma_f32_16x16x32_bf16 v[56:59], a[140:143], v[20:23], v[56:59]
    s_nop 0
    v_cvt_pk_bf16_f32 v60, v24, v28
    s_nop 0
    v_cvt_pk_bf16_f32 v61, v32, v36
    s_nop 0
    v_cvt_pk_bf16_f32 v62, v40, v44
    s_nop 0
    v_cvt_pk_bf16_f32 v63, v48, v52
    s_add_u32 s36, s31, 589824
    buffer_store_dwordx4 v[60:63], v5, s[8:11], s36 offen sc1
    v_cvt_pk_bf16_f32 v64, v25, v29
    v_cvt_pk_bf16_f32 v65, v33, v37
    v_cvt_pk_bf16_f32 v66, v41, v45
    v_cvt_pk_bf16_f32 v67, v49, v53
    s_add_u32 s36, s31, 626688
    buffer_store_dwordx4 v[64:67], v5, s[8:11], s36 offen sc1
    v_cvt_pk_bf16_f32 v60, v26, v30
    v_cvt_pk_bf16_f32 v61, v34, v38
    v_cvt_pk_bf16_f32 v62, v42, v46
    v_cvt_pk_bf16_f32 v63, v50, v54
    s_add_u32 s36, s31, 663552
    buffer_store_dwordx4 v[60:63], v5, s[8:11], s36 offen sc1
    v_cvt_pk_bf16_f32 v64, v27, v31
    v_cvt_pk_bf16_f32 v65, v35, v39
    v_cvt_pk_bf16_f32 v66, v43, v47
    v_cvt_pk_bf16_f32 v67, v51, v55
    s_add_u32 s36, s31, 700416
    buffer_store_dwordx4 v[64:67], v5, s[8:11], s36 offen sc1
    v_cvt_pk_bf16_f32 v70, v56, v57
    v_cvt_pk_bf16_f32 v71, v58, v59
    s_nop 0
    v_permlane16_swap_b32 v68, v70
    v_permlane16_swap_b32 v69, v71
    buffer_store_dwordx4 v[68:71], v1, s[8:11], s59 offen sc1
    s_cmp_lg_u32 s50, 0
    s_cbranch_scc1 DE_nopf2
    s_waitcnt vmcnt(5)
    v_cmp_gt_u32 vcc, s41, v72
    s_cbranch_vccnz DE_nopf2
    s_mov_b32 s50, 2
    s_lshl_b32 s36, s4, 10
    s_add_u32 m0, s36, s40
    s_nop 0
    buffer_load_dwordx4 v2, s[8:11], s30 offen offset:0 sc1 lds
    s_add_u32 m0, m0, 3968
    s_nop 0
    buffer_load_dwordx4 v2, s[8:11], s30 offen offset:128 sc1 lds
    s_add_u32 m0, m0, 3968
    s_nop 0
    buffer_load_dwordx4 v2, s[8:11], s30 offen offset:256 sc1 lds
    s_add_u32 m0, m0, 3968
    s_nop 0
    buffer_load_dwordx4 v2, s[8:11], s30 offen offset:384 sc1 lds
    s_add_u32 m0, m0, 3968
    s_nop 0
    buffer_load_dwordx4 v2, s[8:11], s30 offen offset:512 sc1 lds
    s_add_u32 m0, m0, 3968
    s_nop 0
    buffer_load_dwordx4 v2, s[8:11], s30 offen offset:640 sc1 lds
    s_add_u32 m0, m0, 3968
    s_nop 0
    buffer_load_dwordx4 v2, s[8:11], s30 offen offset:768 sc1 lds
    s_add_u32 m0, m0, 3968
    s_nop 0
    buffer_load_dwordx4 v2, s[8:11], s30 offen offset:896 sc1 lds
    s_add_u32 m0, m0, 3968
    s_nop 0
    buffer_load_dwordx4 v2, s[8:11], s30 offen offset:1024 sc1 lds
DE_nopf2:
    s_add_u32 s29, s29, 1
    s_add_u32 s31, s31, 2359296
    s_add_u32 s59, s59, 294912
    s_add_u32 s32, s32, s57
    s_mov_b32 s57, 9216
    s_cmp_lt_u32 s29, 32
    s_cbranch_scc1 DE_loop
    s_waitcnt vmcnt(0)
    v_mov_b32 v10, 1
    v_mov_b32 v11, 81920
    s_mov_b64 exec, 1
    ds_add_rtn_u32 v11, v11, v10
    s_waitcnt lgkmcnt(0)
    v_readfirstlane_b32 s36, v11
    s_nop 0
    s_and_b32 s36, s36, 3
    s_cmp_lg_u32 s36, 3
    s_cbranch_scc1 notlast_60
    buffer_store_dword v10, off, s[8:11], s32 sc1
notlast_60:
    s_mov_b64 exec, -1
    s_waitcnt vmcnt(0)
    s_endpgm
.section .rodata,"a"
.p2align 6
.amdhsa_kernel adaLN_cond__memory_aug_recurrent_mem_tr__glu_gated_bilinear__prompt_kernel
  .amdhsa_next_free_vgpr 512
  .amdhsa_next_free_sgpr 102
  .amdhsa_accum_offset 256
  .amdhsa_group_segment_fixed_size 0
  .amdhsa_kernarg_size 128
  .amdhsa_user_sgpr_count 2
  .amdhsa_user_sgpr_kernarg_segment_ptr 1
  .amdhsa_system_sgpr_workgroup_id_x 1
  .amdhsa_float_denorm_mode_32 3
.end_amdhsa_kernel
```
